```python
import torch

def _softmax(x, axis=-1):
    return torch.softmax(x, dim=axis)
def _gelu(x):
    return torch.nn.functional.gelu(x, approximate="tanh")
def _silu(x):
    return torch.nn.functional.silu(x)
def _sigmoid(x):
    return torch.sigmoid(x)
def _layernorm(x, axis=-1, eps=1e-5):
    m = x.mean(dim=axis, keepdim=True)
    v = x.var(dim=axis, keepdim=True, unbiased=False)
    return (x - m) / torch.sqrt(v + eps)
def _scatter_add(tgt, idx, src, axis=0):
    return tgt.clone().index_add_(axis, idx, src)
def _segment_sum(src, seg, n):
    out = torch.zeros((n,) + src.shape[1:], dtype=src.dtype)
    return out.index_add_(0, seg, src)
def _pad(x, pw):
    flat = tuple(v for pair in reversed(pw) for v in pair)
    return torch.nn.functional.pad(x, flat)

kernel_name = 'parallel_sum__mha_block__glu_gated_glu__prompt'

def setup_inputs():

    _w = (lambda a: (lambda t: t.to(torch.bfloat16) if t.is_floating_point() else t)(torch.as_tensor(a)))
    def _A_setup():
        B, S, D, H = 1, 2048, 640, 32
        return {
            "x": _w((lambda *s: torch.randn(*s, dtype=torch.bfloat16) * 0.05)(B, S, D)),
            "wqkv": _w((lambda *s: torch.randn(*s, dtype=torch.bfloat16) * 0.05)(D, 3 * D)),
            "wo": _w((lambda *s: torch.randn(*s, dtype=torch.bfloat16) * 0.05)(D, D)),
        }
    _A_in = _A_setup()

    def _B_setup():
        B, S, D, F = 1, 2048, 640, 1536
        return {
            "x": _w((lambda *s: torch.randn(*s, dtype=torch.bfloat16) * 0.05)(B, S, D)),
            "w_gate": _w((lambda *s: torch.randn(*s, dtype=torch.bfloat16) * 0.05)(D, F)),
            "w_up": _w((lambda *s: torch.randn(*s, dtype=torch.bfloat16) * 0.05)(D, F)),
            "w_down": _w((lambda *s: torch.randn(*s, dtype=torch.bfloat16) * 0.05)(F, D)),
        }
    _B_in = _B_setup()

    return {
        "A_x": _A_in["x"],
        "A_wqkv": _A_in["wqkv"],
        "A_wo": _A_in["wo"],
        "B_x": _B_in["x"],
        "B_w_gate": _B_in["w_gate"],
        "B_w_up": _B_in["w_up"],
        "B_w_down": _B_in["w_down"],
    }

def reference(A_x, A_wqkv, A_wo, B_x, B_w_gate, B_w_up, B_w_down):
    def _A_ref(x, wqkv, wo):
        B, S, D = x.shape
        H = 32
        Dh = D // H
        qkv = (lambda x, *d: x.permute(*d))((x @ wqkv).reshape(B, S, 3, H, Dh), 2, 0, 3, 1, 4)
        q, k, v = qkv[0], qkv[1], qkv[2]
        scores = torch.einsum("bhqd,bhkd->bhqk", q, k) * (Dh ** -0.5)
        p = _softmax(scores, axis=-1)
        o = torch.einsum("bhqk,bhkd->bhqd", p, v)
        return (lambda x, *d: x.permute(*d))(o, 0, 2, 1, 3).reshape(B, S, D) @ wo

    def _B_ref(x, w_gate, w_up, w_down):
        g = torch.einsum("bsd,df->bsf", x, w_gate)
        u = torch.einsum("bsd,df->bsf", x, w_up)
        h = _sigmoid(g) * u
        return torch.einsum("bsf,fd->bsd", h, w_down)

    x = A_x
    xn = _layernorm(x, axis=-1)
    return x + _A_ref(xn, A_wqkv, A_wo) + _B_ref(xn, B_w_gate, B_w_up, B_w_down)
```

```asm
; @launch grid=(256,1,1) block=(256,1,1) lds=163840
.amdgcn_target "amdgcn-amd-amdhsa--gfx950"
.text
.globl parallel_sum__mha_block__glu_gated_glu__prompt_kernel
.p2align 8
.type parallel_sum__mha_block__glu_gated_glu__prompt_kernel,@function
parallel_sum__mha_block__glu_gated_glu__prompt_kernel:
    s_cmp_ge_u32 s2, 256
    s_cbranch_scc1 L_end
    s_load_dwordx16 s[64:79], s[0:1], 0
    s_load_dwordx4 s[80:83], s[0:1], 64
    s_getpc_b64 s[36:37]
L_pc0:
    s_lshr_b32 s5, s2, 3
    s_mov_b32 s38, L_codeend-L_pc0
    s_mov_b32 s39, 0x00020000
    s_lshl_b32 s6, s5, 12
    v_lshlrev_b32 v64, 4, v0
    buffer_load_dwordx4 a[200:203], v64, s[36:39], s6 offen
    v_and_b32 v1, 63, v0
    v_lshrrev_b32 v0, 6, v0
    s_and_b32 s4, s2, 7
    v_readfirstlane_b32 s3, v0
    s_and_b32 s6, s4, 1
    s_lshl_b32 s6, s6, 3
    s_and_b32 s7, s5, 7
    s_add_u32 s40, s6, s7
    v_lshrrev_b32 v64, 3, v1
    v_and_b32 v65, 7, v1
    v_xor_b32 v66, v64, v65
    v_lshlrev_b32 v66, 4, v66
    v_mul_u32_u24 v84, 1280, v64
    v_add_u32 v84, v84, v66
    v_add_u32 v85, 9216, v84
    v_xor_b32 v67, 1, v64
    v_xor_b32 v66, 16, v66
    v_mul_u32_u24 v67, 1280, v67
    v_add_u32 v67, v67, v66
    v_add_u32 v86, 18432, v67
    v_add_u32 v87, 27648, v67
    s_lshl_b32 s42, s3, 12
    s_lshl_b32 s98, s40, 2
    s_add_u32 s98, s98, s3
    s_mul_i32 s44, s98, 40960
    s_lshr_b32 s6, s4, 1
    s_lshl_b32 s6, s6, 2
    s_lshr_b32 s7, s5, 3
    s_add_u32 s41, s6, s7
    v_lshlrev_b32 v66, 4, v65
    v_lshlrev_b32 v67, 1, v64
    v_and_b32 v67, 4, v67
    v_xor_b32 v67, v65, v67
    v_lshlrev_b32 v67, 4, v67
    v_mul_u32_u24 v8, 3840, v64
    v_add_u32 v8, v8, v67
    v_add_u32 v9, 29696, v8
    s_min_u32 s6, s41, 14
    s_lshl_b32 s7, s6, 8
    s_mul_i32 s99, s3, 61440
    s_add_u32 s12, s7, s99
    s_add_u32 s53, s42, 131072
    s_add_u32 s47, s42, 0
    s_add_u32 s63, s42, 114688
    s_add_u32 s48, s42, 16384
    s_lshl_b32 s6, s5, 2
    s_add_u32 s6, s6, s3
    s_lshr_b32 s7, s4, 1
    s_lshl_b32 s100, s7, 10
    v_lshrrev_b32 v75, 2, v1
    v_and_b32 v74, 3, v1
    v_mul_u32_u24 v75, 245760, v75
    s_and_b32 s99, s6, 1
    s_lshl_b32 s99, s99, 9
    s_add_u32 s100, s100, s99
    v_lshl_add_u32 v74, v74, 7, s100
    v_min_u32 v74, 3712, v74
    s_lshr_b32 s99, s6, 1
    s_mul_i32 s99, s99, 3840
    s_add_u32 s99, s99, 491520
    v_add3_u32 v45, v74, v75, s99
    s_lshl_b32 s7, s7, 7
    s_add_u32 s6, s6, s7
    s_mul_i32 s6, s6, 2560
    s_and_b32 s7, s4, 1
    s_mul_i32 s7, s7, 1310720
    s_add_u32 s6, s6, s7
    v_and_b32 v75, 1, v1
    v_mul_u32_u24 v75, 1280, v75
    v_lshrrev_b32 v74, 1, v1
    v_lshl_add_u32 v74, v74, 7, v75
    v_add_u32 v44, s6, v74
    s_waitcnt lgkmcnt(0)
    s_add_u32 s44, s64, s44
    s_addc_u32 s45, s65, 0
    s_add_u32 s12, s66, s12
    s_addc_u32 s13, s67, 0
    s_mov_b64 exec, 1
    global_load_dword a211, v8, s[12:13]
    s_mov_b64 exec, -1
    s_mov_b32 m0, s53
    s_nop 0
    global_load_lds_dwordx4 v84, s[44:45] offset:0
    global_load_lds_dwordx4 v85, s[44:45] offset:1024
    global_load_lds_dwordx4 v86, s[44:45] offset:2048
    global_load_lds_dwordx4 v87, s[44:45] offset:3072
    v_add_u32 v84, 128, v84
    v_add_u32 v85, 128, v85
    v_add_u32 v86, 128, v86
    v_add_u32 v87, 128, v87
    s_sub_u32 s14, s12, 1920
    s_subb_u32 s15, s13, 0
    s_add_u32 s49, s42, 32768
    s_add_u32 s50, s42, 49152
    s_add_u32 s51, s42, 65536
    s_add_u32 s52, s42, 81920
    s_add_u32 s62, s42, 98304
    s_mov_b32 s55, 0x3F803F80
    v_lshrrev_b32 v70, 5, v1
    v_and_b32 v71, 31, v1
    v_and_b32 v72, 7, v71
    v_lshrrev_b32 v73, 3, v71
    v_lshrrev_b32 v74, 1, v73
    v_xor_b32 v74, v72, v74
    v_lshlrev_b32 v74, 7, v74
    v_lshl_add_u32 v73, v73, 10, v74
    s_add_u32 s6, s42, 32768
    v_add_u32 v73, s6, v73
    v_and_b32 v74, 15, v1
    v_lshrrev_b32 v75, 2, v74
    v_lshlrev_b32 v69, 6, v75
    v_lshl_add_u32 v69, v70, 9, v69
    v_lshlrev_b32 v75, 7, v75
    v_lshl_add_u32 v75, v70, 10, v75
    v_and_b32 v76, 3, v74
    v_lshlrev_b32 v76, 3, v76
    v_and_b32 v77, 16, v1
    v_lshl_add_u32 v76, v77, 1, v76
    v_add_u32 v69, v69, v76
    v_and_b32 v77, 8, v74
    v_lshlrev_b32 v77, 3, v77
    v_xor_b32 v76, v76, v77
    v_add_u32 v76, v75, v76
    s_add_u32 s6, s3, 0
    s_and_b32 s6, s6, 3
    s_lshl_b32 s7, s6, 12
    v_lshl_add_u32 v74, s6, 1, v70
    v_add_u32 v12, s7, v76
    s_and_b32 s7, s6, 1
    s_mul_i32 s7, s7, -1024
    v_xor_b32 v75, v72, v74
    s_lshl_b32 s6, s6, 11
    s_add_u32 s6, s6, s7
    s_add_u32 s6, s6, 65536
    v_xor_b32 v13, 64, v12
    v_lshl_add_u32 v88, v75, 4, v73
    v_add_u32 v40, s6, v69
    v_add_u32 v92, 65536, v88
    s_add_u32 s6, s3, 1
    s_and_b32 s6, s6, 3
    s_lshl_b32 s7, s6, 12
    v_lshl_add_u32 v74, s6, 1, v70
    v_add_u32 v14, s7, v76
    s_and_b32 s7, s6, 1
    s_mul_i32 s7, s7, -1024
    v_xor_b32 v75, v72, v74
    s_lshl_b32 s6, s6, 11
    s_add_u32 s6, s6, s7
    s_add_u32 s6, s6, 65536
    v_xor_b32 v15, 64, v14
    v_lshl_add_u32 v89, v75, 4, v73
    v_add_u32 v41, s6, v69
    v_add_u32 v93, 65536, v89
    s_add_u32 s6, s3, 2
    s_and_b32 s6, s6, 3
    s_lshl_b32 s7, s6, 12
    v_lshl_add_u32 v74, s6, 1, v70
    v_add_u32 v6, s7, v76
    s_and_b32 s7, s6, 1
    s_mul_i32 s7, s7, -1024
    v_xor_b32 v75, v72, v74
    s_lshl_b32 s6, s6, 11
    s_add_u32 s6, s6, s7
    s_add_u32 s6, s6, 65536
    v_xor_b32 v7, 64, v6
    v_lshl_add_u32 v90, v75, 4, v73
    v_add_u32 v42, s6, v69
    v_add_u32 v94, 65536, v90
    s_add_u32 s6, s3, 3
    s_and_b32 s6, s6, 3
    s_lshl_b32 s7, s6, 12
    v_lshl_add_u32 v74, s6, 1, v70
    v_add_u32 v2, s7, v76
    s_and_b32 s7, s6, 1
    s_mul_i32 s7, s7, -1024
    v_xor_b32 v75, v72, v74
    s_lshl_b32 s6, s6, 11
    s_add_u32 s6, s6, s7
    s_add_u32 s6, s6, 65536
    v_xor_b32 v3, 64, v2
    v_lshl_add_u32 v91, v75, 4, v73
    v_add_u32 v43, s6, v69
    v_add_u32 v95, 65536, v91
    v_mov_b32 v34, 0
    v_mov_b32 v35, 0
    v_mov_b32 v36, 0
    v_mov_b32 v37, 0
    v_lshrrev_b32 v74, 2, v1
    v_xor_b32 v74, v74, v1
    v_and_b32 v74, 8, v74
    v_and_b32 v75, 6, v1
    v_or_b32 v74, v74, v75
    v_mov_b32 v75, s55
    v_cmp_eq_u32 vcc, 0, v74
    v_and_b32 v17, 1, v1
    v_mul_u32_u24 v17, 0xaaaa, v17
    v_cndmask_b32 v77, 0, v75, vcc
    v_cmp_eq_u32 vcc, 4, v74
    v_add_u32 v17, 0x4444, v17
    v_accvgpr_write_b32 a242, v77
    v_cndmask_b32 v75, 0, v75, vcc
    v_accvgpr_write_b32 a243, v77
    v_accvgpr_write_b32 a244, v75
    v_accvgpr_write_b32 a245, v75
    v_accvgpr_write_b32 a250, 0
    v_accvgpr_write_b32 a251, 0
    v_accvgpr_write_b32 a252, 0
    v_accvgpr_write_b32 a253, 0
    v_accvgpr_write_b32 a216, 0
    v_accvgpr_write_b32 a217, 0
    v_accvgpr_write_b32 a218, 0
    v_accvgpr_write_b32 a219, 0
    v_accvgpr_write_b32 a220, 0
    v_accvgpr_write_b32 a221, 0
    v_accvgpr_write_b32 a222, 0
    v_accvgpr_write_b32 a223, 0
    s_lshl_b32 s6, s2, 2
    s_add_u32 s6, s6, s3
    s_mul_i32 s6, s6, 384
    v_lshlrev_b32 v46, 7, v1
    v_add_u32 v46, s6, v46
    s_mov_b32 s8, s64
    s_mov_b32 s9, s65
    s_mov_b32 s10, 2621440
    s_mov_b32 s11, 0x00020000
    s_add_u32 s0, s36, L_p1c-L_pc0
    s_addc_u32 s1, s37, 0
    s_mov_b32 s24, s82
    s_mov_b32 s25, s83
    s_mov_b32 s26, 21495808
    s_mov_b32 s27, 0x00020000
    s_mov_b32 s28, s78
    s_mov_b32 s29, s79
    s_mov_b32 s30, 2621440
    s_mov_b32 s31, 0x00020000
    s_mov_b32 s32, s80
    s_mov_b32 s33, s81
    s_mov_b32 s34, 256
    s_mov_b32 s35, 0x00020000
    v_mul_u32_u24 v10, 3072, v64
    v_add_u32 v10, v10, v67
    v_add_u32 v11, 23552, v10
    s_mov_b32 m0, s47
    s_nop 0
    global_load_lds_dwordx4 v8, s[12:13] offset:0
    global_load_lds_dwordx4 v9, s[12:13] offset:1024
    global_load_lds_dwordx4 v8, s[14:15] offset:2048
    global_load_lds_dwordx4 v9, s[14:15] offset:3072
    s_mov_b32 m0, s63
    s_nop 0
    global_load_lds_dwordx4 v84, s[44:45] offset:0
    global_load_lds_dwordx4 v85, s[44:45] offset:1024
    global_load_lds_dwordx4 v86, s[44:45] offset:2048
    global_load_lds_dwordx4 v87, s[44:45] offset:3072
    v_add_u32 v8, 245760, v8
    v_add_u32 v9, 245760, v9
    s_mov_b32 m0, s48
    s_nop 0
    global_load_lds_dwordx4 v8, s[12:13] offset:0
    global_load_lds_dwordx4 v9, s[12:13] offset:1024
    global_load_lds_dwordx4 v8, s[14:15] offset:2048
    global_load_lds_dwordx4 v9, s[14:15] offset:3072
    v_add_u32 v84, 128, v84
    v_add_u32 v85, 128, v85
    v_add_u32 v86, 128, v86
    v_add_u32 v87, 128, v87
    v_add_u32 v8, 245760, v8
    v_add_u32 v9, 245760, v9
    s_mov_b64 exec, 255
    global_load_dword a210, v44, s[64:65] offset:256
    s_mov_b64 exec, 65535
    global_load_dword a211, v45, s[66:67]
    s_mov_b64 exec, -1
    v_add_u32 v45, 983040, v45
    v_lshrrev_b32 v67, 2, v1
    v_mul_u32_u24 v67, 3072, v67
    v_and_b32 v68, 3, v1
    v_lshl_add_u32 v4, v68, 4, v67
    v_add_u32 v5, 48128, v4
    v_lshrrev_b32 v74, 4, v71
    v_mul_u32_u24 v74, 49152, v74
    v_and_b32 v75, 15, v71
    v_lshlrev_b32 v75, 4, v75
    v_lshl_add_u32 v75, v70, 8, v75
    v_add_u32 v18, v74, v75
    s_min_u32 s6, s41, 14
    s_lshl_b32 s7, s6, 19
    s_cmp_lt_u32 s41, 10
    s_cselect_b32 s99, 9, 8
    s_lshl_b32 s99, s98, s99
    s_add_u32 s56, s7, s99
    s_add_u32 s57, s56, 262144
    s_cmp_lt_u32 s41, 5
    s_cselect_b32 s61, 1051011932, 1.0
    s_and_b32 s6, s41, 3
    s_lshl_b32 s6, s6, 2
    s_lshr_b32 s7, s41, 2
    s_add_u32 s7, s6, s7
    s_lshr_b32 s6, s7, 1
    s_mul_i32 s6, s6, 3
    s_and_b32 s7, s7, 1
    s_mul_i32 s98, s98, 98304
    s_add_u32 s98, s98, 11534336
    s_add_u32 s85, s6, s7
    s_lshl_b32 s86, s85, 7
    s_mul_i32 s99, s3, 49152
    s_add_u32 s86, s86, s99
    s_add_u32 s20, s72, s86
    s_addc_u32 s21, s73, 0
    s_add_u32 s22, s74, s86
    s_addc_u32 s23, s75, 0
    s_sub_u32 s22, s22, 2048
    s_subb_u32 s23, s23, 0
    s_lshl_b32 s86, s85, 11
    s_add_u32 s60, s98, s86
    s_lshl_b32 s85, s6, 1
    s_add_u32 s85, s85, s7
    s_add_u32 s85, s85, 4
    s_lshl_b32 s86, s85, 6
    s_lshl_b32 s99, s99, 1
    s_add_u32 s86, s86, s99
    s_add_u32 s16, s72, s86
    s_addc_u32 s17, s73, 0
    s_add_u32 s18, s74, s86
    s_addc_u32 s19, s75, 0
    s_sub_u32 s18, s18, 2048
    s_subb_u32 s19, s19, 0
    s_lshl_b32 s86, s85, 10
    s_add_u32 s59, s98, s86
    v_lshrrev_b32 v74, 2, v71
    v_lshlrev_b32 v74, 14, v74
    v_and_b32 v75, 3, v71
    v_lshlrev_b32 v75, 4, v75
    v_lshl_add_u32 v75, v70, 6, v75
    v_add_u32 v74, v74, v75
    s_cmp_lt_u32 s41, 15
    s_cselect_b32 s6, 0, 1073741824
    v_add_u32 v74, s6, v74
    v_lshlrev_b32 v75, 4, v71
    v_lshl_add_u32 v75, v70, 15, v75
    s_cmp_lt_u32 s41, 10
    s_cselect_b64 vcc, -1, 0
    v_cndmask_b32 v16, v74, v75, vcc
    s_lshl_b32 s85, s2, 2
    s_add_u32 s85, s85, s3
    v_and_b32 v75, 3, v1
    s_sub_u32 s6, s85, 720
    s_cmp_lt_u32 s6, 32
    s_cselect_b32 s7, 0, 1073741824
    s_and_b32 s6, s6, 31
    s_lshl_b32 s6, s6, 10
    s_add_u32 s6, s6, s7
    s_add_u32 s6, s6, 7864320
    v_lshlrev_b32 v0, 4, v1
    v_add_u32 v25, s6, v0
    v_and_b32 v80, 3, v1
    v_cmp_eq_u32 vcc, 0, v80
    v_mov_b32 v81, s55
    s_lshr_b32 s6, s2, 4
    s_lshl_b32 s6, s6, 8
    v_cndmask_b32 v80, 0, v81, vcc
    v_mov_b32 v81, v80
    v_mov_b32 v82, v80
    v_mov_b32 v83, v80
    v_lshrrev_b32 v38, 2, v1
    v_lshlrev_b32 v38, 8, v38
    v_lshl_add_u32 v38, v75, 4, v38
    v_add_u32 v38, 20971520, v38
    s_and_b32 s7, s2, 15
    s_lshl_b32 s7, s7, 2
    s_add_u32 s6, s6, s7
    s_add_u32 s95, s6, 20971520
    s_lshl_b32 s6, s3, 2
    s_add_u32 s6, s6, 131072
    v_and_b32 v39, 511, v0
    v_add_u32 v0, s6, v0
    v_add_u32 v39, 131072, v39
    s_or_b32 s6, s2, s3
    s_cmp_lg_u32 s6, 0
    s_cbranch_scc1 L_non
    s_memrealtime s[6:7]
    s_waitcnt lgkmcnt(0)
    s_or_b32 s6, s6, 1
    v_mov_b32 v68, s6
    v_mov_b32 v69, 0
    buffer_store_dword v68, v69, s[32:35], 0 offen sc1
L_non:
    s_waitcnt vmcnt(14)
    ds_read_b128 a[0:3], v92 offset:32768
    ds_read_b128 a[4:7], v93 offset:32768
    ds_read_b128 a[8:11], v94 offset:32768
    ds_read_b128 a[12:15], v95 offset:32768
    ds_read_b128 v[160:163], v92 offset:32768
    ds_read_b128 v[164:167], v93 offset:32768
    ds_read_b128 v[168:171], v94 offset:32768
    ds_read_b128 v[172:175], v95 offset:32768
    s_mov_b32 m0, s62
    s_nop 0
    global_load_lds_dwordx4 v84, s[44:45] offset:0
    global_load_lds_dwordx4 v85, s[44:45] offset:1024
    global_load_lds_dwordx4 v86, s[44:45] offset:2048
    global_load_lds_dwordx4 v87, s[44:45] offset:3072
    v_add_u32 v84, 128, v84
    v_add_u32 v85, 128, v85
    v_add_u32 v86, 128, v86
    v_add_u32 v87, 128, v87
    s_waitcnt lgkmcnt(0)
    v_smfmac_f32_16x16x64_bf16 a[250:253], a[242:245], v[160:167], v17
    v_smfmac_f32_16x16x64_bf16 a[250:253], a[242:245], v[168:175], v17
    v_dot2_f32_bf16 v34, v160, v160, v34
    v_dot2_f32_bf16 v35, v161, v161, v35
    v_dot2_f32_bf16 v36, v162, v162, v36
    v_dot2_f32_bf16 v37, v163, v163, v37
    v_dot2_f32_bf16 v34, v164, v164, v34
    v_dot2_f32_bf16 v35, v165, v165, v35
    v_dot2_f32_bf16 v36, v166, v166, v36
    v_dot2_f32_bf16 v37, v167, v167, v37
    v_dot2_f32_bf16 v34, v168, v168, v34
    v_dot2_f32_bf16 v35, v169, v169, v35
    v_dot2_f32_bf16 v36, v170, v170, v36
    v_dot2_f32_bf16 v37, v171, v171, v37
    v_dot2_f32_bf16 v34, v172, v172, v34
    v_dot2_f32_bf16 v35, v173, v173, v35
    v_dot2_f32_bf16 v36, v174, v174, v36
    v_dot2_f32_bf16 v37, v175, v175, v37
    s_waitcnt vmcnt(14)
    s_barrier
    ds_read_b64_tr_b16 a[160:161], v12 offset:0
    ds_read_b64_tr_b16 a[162:163], v12 offset:512
    ds_read_b64_tr_b16 a[164:165], v13 offset:0
    ds_read_b64_tr_b16 a[166:167], v13 offset:512
    s_mov_b32 m0, s49
    s_nop 0
    global_load_lds_dwordx4 v8, s[12:13] offset:0
    ds_read_b64_tr_b16 a[168:169], v12 offset:2048
    ds_read_b64_tr_b16 a[170:171], v12 offset:2560
    ds_read_b64_tr_b16 a[172:173], v13 offset:2048
    ds_read_b64_tr_b16 a[174:175], v13 offset:2560
    global_load_lds_dwordx4 v9, s[12:13] offset:1024
    ds_read_b64_tr_b16 a[176:177], v14 offset:0
    ds_read_b64_tr_b16 a[178:179], v14 offset:512
    ds_read_b64_tr_b16 a[180:181], v15 offset:0
    ds_read_b64_tr_b16 a[182:183], v15 offset:512
    global_load_lds_dwordx4 v8, s[14:15] offset:2048
    ds_read_b64_tr_b16 a[184:185], v14 offset:2048
    ds_read_b64_tr_b16 a[186:187], v14 offset:2560
    ds_read_b64_tr_b16 a[188:189], v15 offset:2048
    ds_read_b64_tr_b16 a[190:191], v15 offset:2560
    global_load_lds_dwordx4 v9, s[14:15] offset:3072
    v_add_u32 v8, 245760, v8
    v_add_u32 v9, 245760, v9
    s_cmp_ge_u32 s41, 10
    s_waitcnt lgkmcnt(8)
    s_cbranch_scc1 L_clsV
    v_mfma_f32_32x32x16_bf16 v[96:111], a[160:163], a[0:3], 0
    s_mov_b32 m0, s53
    s_cmp_eq_u32 s3, 1
    s_cselect_b64 s[100:101], s[74:75], s[72:73]
    s_cmp_eq_u32 s3, 2
    ds_read_b64_tr_b16 a[192:193], v6 offset:0
    ds_read_b64_tr_b16 a[194:195], v6 offset:512
    global_load_lds_dwordx4 v84, s[44:45] offset:0
    v_mfma_f32_32x32x16_bf16 v[112:127], a[164:167], a[0:3], 0
    s_cselect_b64 s[100:101], s[66:67], s[100:101]
    s_cmp_eq_u32 s3, 3
    s_cselect_b64 s[100:101], s[64:65], s[100:101]
    s_lshr_b32 s99, s3, 1
    s_lshl_b32 s99, s99, 21
    s_load_dword s58, s[100:101], s99
    s_mul_i32 s86, s85, 6554
    ds_read_b64_tr_b16 a[196:197], v7 offset:0
    ds_read_b64_tr_b16 a[198:199], v7 offset:512
    v_smfmac_f32_16x16x64_bf16 a[216:219], a[242:245], a[160:167], v17
    v_mfma_f32_32x32x16_bf16 v[128:143], a[168:171], a[0:3], 0
    s_waitcnt vmcnt(15)
    s_lshr_b32 s86, s86, 16
    ds_read_b64_tr_b16 a[160:161], v6 offset:2048
    ds_read_b64_tr_b16 a[162:163], v6 offset:2560
    ds_read_b128 v[160:163], v92 offset:16384
    ds_read_b128 v[164:167], v93 offset:16384
    global_load_lds_dwordx4 v85, s[44:45] offset:1024
    v_mfma_f32_32x32x16_bf16 v[144:159], a[172:175], a[0:3], 0
    s_waitcnt lgkmcnt(8)
    s_mul_i32 s6, s86, 10
    s_sub_u32 s87, s85, s6
    s_cmp_lt_u32 s86, 48
    s_cselect_b32 s36, s76, s68
    ds_read_b64_tr_b16 a[164:165], v7 offset:2048
    ds_read_b64_tr_b16 a[166:167], v7 offset:2560
    ds_read_b128 v[168:171], v94 offset:16384
    ds_read_b128 v[172:175], v95 offset:16384
    v_smfmac_f32_16x16x64_bf16 a[220:223], a[242:245], a[168:175], v17
    v_mfma_f32_32x32x16_bf16 v[96:111], a[176:179], a[4:7], v[96:111]
    s_cselect_b32 s37, s77, s69
    s_mov_b32 s38, 819200
    s_cselect_b32 s38, 1966080, s38
    ds_read_b64_tr_b16 a[168:169], v2 offset:0
    ds_read_b64_tr_b16 a[170:171], v2 offset:512
    ds_read_b128 a[16:19], v92 offset:16384
    global_load_lds_dwordx4 v86, s[44:45] offset:2048
    v_mfma_f32_32x32x16_bf16 v[112:127], a[180:183], a[4:7], v[112:127]
    s_mov_b32 s39, 0x00020000
    ds_read_b64_tr_b16 a[172:173], v3 offset:0
    ds_read_b64_tr_b16 a[174:175], v3 offset:512
    v_lshrrev_b32 v74, 2, v64
    v_and_b32 v75, 3, v64
    v_lshl_add_u32 v75, v74, 3, v75
    v_mul_u32_u24 v75, 1280, v75
    v_mfma_f32_32x32x16_bf16 v[128:143], a[184:187], a[4:7], v[128:143]
    ds_read_b64_tr_b16 a[176:177], v2 offset:2048
    ds_read_b64_tr_b16 a[178:179], v2 offset:2560
    ds_read_b128 a[20:23], v93 offset:16384
    global_load_lds_dwordx4 v87, s[44:45] offset:3072
    v_add_u32 v84, 128, v84
    v_add_u32 v85, 128, v85
    v_mfma_f32_32x32x16_bf16 v[144:159], a[188:191], a[4:7], v[144:159]
    s_waitcnt lgkmcnt(10)
    ds_read_b64_tr_b16 a[180:181], v3 offset:2048
    ds_read_b64_tr_b16 a[182:183], v3 offset:2560
    v_add_u32 v86, 128, v86
    v_add_u32 v87, 128, v87
    v_add_u32 v75, v75, v66
    v_mul_u32_u24 v74, 15360, v74
    s_waitcnt lgkmcnt(10)
    v_smfmac_f32_16x16x64_bf16 a[250:253], a[242:245], v[160:167], v17
    v_smfmac_f32_16x16x64_bf16 a[250:253], a[242:245], v[168:175], v17
    v_dot2_f32_bf16 v34, v160, v160, v34
    v_dot2_f32_bf16 v35, v161, v161, v35
    v_dot2_f32_bf16 v36, v162, v162, v36
    v_dot2_f32_bf16 v37, v163, v163, v37
    v_dot2_f32_bf16 v34, v164, v164, v34
    v_dot2_f32_bf16 v35, v165, v165, v35
    v_dot2_f32_bf16 v36, v166, v166, v36
    v_dot2_f32_bf16 v37, v167, v167, v37
    v_dot2_f32_bf16 v34, v168, v168, v34
    v_dot2_f32_bf16 v35, v169, v169, v35
    v_dot2_f32_bf16 v36, v170, v170, v36
    v_dot2_f32_bf16 v37, v171, v171, v37
    v_dot2_f32_bf16 v34, v172, v172, v34
    v_dot2_f32_bf16 v35, v173, v173, v35
    v_dot2_f32_bf16 v36, v174, v174, v36
    v_dot2_f32_bf16 v37, v175, v175, v37
    v_mfma_f32_32x32x16_bf16 v[96:111], a[192:195], a[8:11], v[96:111]
    s_waitcnt vmcnt(14)
    s_barrier
    ds_read_b64_tr_b16 a[184:185], v12 offset:16384
    ds_read_b64_tr_b16 a[186:187], v12 offset:16896
    ds_read_b128 a[24:27], v94 offset:16384
    v_mfma_f32_32x32x16_bf16 v[112:127], a[196:199], a[8:11], v[112:127]
    s_mov_b32 m0, s50
    ds_read_b64_tr_b16 a[188:189], v13 offset:16384
    ds_read_b64_tr_b16 a[190:191], v13 offset:16896
    global_load_lds_dwordx4 v8, s[12:13] offset:0
    v_add_u32 v76, v75, v74
    v_mfma_f32_32x32x16_bf16 v[128:143], a[160:163], a[8:11], v[128:143]
    s_cmp_lt_u32 s85, 680
    s_cselect_b32 s6, 0, 1073741824
    ds_read_b64_tr_b16 a[192:193], v12 offset:18432
    ds_read_b64_tr_b16 a[194:195], v12 offset:18944
    ds_read_b128 a[28:31], v95 offset:16384
    v_lshlrev_b32 v23, 4, v1
    v_or_b32 v23, s6, v23
    v_mfma_f32_32x32x16_bf16 v[144:159], a[164:167], a[8:11], v[144:159]
    s_waitcnt lgkmcnt(8)
    ds_read_b64_tr_b16 a[196:197], v13 offset:18432
    ds_read_b64_tr_b16 a[198:199], v13 offset:18944
    global_load_lds_dwordx4 v9, s[12:13] offset:1024
    v_or_b32 v75, s6, v75
    v_or_b32 v76, s6, v76
    v_mfma_f32_32x32x16_bf16 v[96:111], a[168:171], a[12:15], v[96:111]
    s_cmp_eq_u32 s3, 1
    s_cselect_b64 s[100:101], s[68:69], s[76:77]
    s_cmp_eq_u32 s3, 2
    s_cselect_b64 s[100:101], s[80:81], s[100:101]
    s_cmp_eq_u32 s3, 3
    ds_read_b64_tr_b16 a[160:161], v14 offset:16384
    ds_read_b64_tr_b16 a[162:163], v14 offset:16896
    v_mfma_f32_32x32x16_bf16 v[112:127], a[172:175], a[12:15], v[112:127]
    s_cselect_b64 s[100:101], s[78:79], s[100:101]
    s_load_dword s58, s[100:101], 0
    s_lshl_b32 s6, s86, 2
    s_sub_u32 s6, s6, 192
    ds_read_b64_tr_b16 a[164:165], v15 offset:16384
    ds_read_b64_tr_b16 a[166:167], v15 offset:16896
    global_load_lds_dwordx4 v8, s[14:15] offset:2048
    v_mfma_f32_32x32x16_bf16 v[128:143], a[176:179], a[12:15], v[128:143]
    s_mul_i32 s7, s6, 205
    s_lshr_b32 s7, s7, 10
    s_mul_i32 s98, s7, 5
    s_sub_u32 s98, s6, s98
    s_mul_i32 s7, s7, 40
    ds_read_b64_tr_b16 a[168:169], v14 offset:18432
    ds_read_b64_tr_b16 a[170:171], v14 offset:18944
    v_mfma_f32_32x32x16_bf16 v[144:159], a[180:183], a[12:15], v[144:159]
    s_waitcnt lgkmcnt(6)
    s_lshl2_add_u32 s7, s98, s7
    ds_read_b64_tr_b16 a[172:173], v15 offset:18432
    ds_read_b64_tr_b16 a[174:175], v15 offset:18944
    global_load_lds_dwordx4 v9, s[14:15] offset:3072
    v_add_u32 v8, 245760, v8
    v_add_u32 v9, 245760, v9
    v_mfma_f32_32x32x16_bf16 v[96:111], a[184:187], a[16:19], v[96:111]
    s_mov_b32 m0, s63
    s_cmp_ge_u32 s98, 2
    s_cselect_b32 s99, 8, 0
    s_add_u32 s7, s7, s99
    s_cmp_eq_u32 s98, 2
    ds_read_b64_tr_b16 a[176:177], v6 offset:16384
    ds_read_b64_tr_b16 a[178:179], v6 offset:16896
    v_mfma_f32_32x32x16_bf16 v[112:127], a[188:191], a[16:19], v[112:127]
    ds_read_b64_tr_b16 a[180:181], v7 offset:16384
    ds_read_b64_tr_b16 a[182:183], v7 offset:16896
    global_load_lds_dwordx4 v84, s[44:45] offset:0
    s_mov_b64 exec, 255
    global_load_dword a210, v44, s[64:65] offset:768
    s_mov_b64 exec, 65535
    global_load_dword a211, v45, s[66:67]
    s_mov_b64 exec, -1
    v_smfmac_f32_16x16x64_bf16 a[216:219], a[242:245], a[184:191], v17
    v_mfma_f32_32x32x16_bf16 v[128:143], a[192:195], a[16:19], v[128:143]
    s_waitcnt vmcnt(15)
    s_cselect_b64 s[100:101], -1, 0
    s_lshl_b32 s6, s86, 5
    ds_read_b64_tr_b16 a[184:185], v6 offset:18432
    ds_read_b64_tr_b16 a[186:187], v6 offset:18944
    ds_read_b128 v[160:163], v92 offset:0
    ds_read_b128 v[164:167], v93 offset:0
    v_mfma_f32_32x32x16_bf16 v[144:159], a[196:199], a[16:19], v[144:159]
    s_waitcnt lgkmcnt(8)
    s_add_u32 s6, s6, 0
    s_cmp_lt_u32 s86, 48
    s_cselect_b32 s6, s6, s7
    ds_read_b64_tr_b16 a[188:189], v7 offset:18432
    ds_read_b64_tr_b16 a[190:191], v7 offset:18944
    ds_read_b128 v[168:171], v94 offset:0
    ds_read_b128 v[172:175], v95 offset:0
    global_load_lds_dwordx4 v85, s[44:45] offset:1024
    v_smfmac_f32_16x16x64_bf16 a[220:223], a[242:245], a[192:199], v17
    v_mfma_f32_32x32x16_bf16 v[96:111], a[160:163], a[20:23], v[96:111]
    s_cselect_b64 s[100:101], 0, s[100:101]
    s_mul_i32 s6, s6, 1280
    s_lshl_b32 s7, s87, 7
    s_add_u32 s91, s6, s7
    ds_read_b64_tr_b16 a[192:193], v2 offset:16384
    ds_read_b64_tr_b16 a[194:195], v2 offset:16896
    ds_read_b128 a[32:35], v92 offset:0
    v_mfma_f32_32x32x16_bf16 v[112:127], a[164:167], a[20:23], v[112:127]
    s_add_u32 s99, s3, 0
    s_min_u32 s99, s99, 10
    s_lshl_b32 s99, s99, 21
    s_load_dword s58, s[82:83], s99
    ds_read_b64_tr_b16 a[196:197], v3 offset:16384
    ds_read_b64_tr_b16 a[198:199], v3 offset:16896
    global_load_lds_dwordx4 v86, s[44:45] offset:2048
    v_mfma_f32_32x32x16_bf16 v[128:143], a[168:171], a[20:23], v[128:143]
    ds_read_b64_tr_b16 a[160:161], v2 offset:18432
    ds_read_b64_tr_b16 a[162:163], v2 offset:18944
    ds_read_b128 a[36:39], v93 offset:0
    v_cndmask_b32 v19, v75, v76, s[100:101]
    v_mfma_f32_32x32x16_bf16 v[144:159], a[172:175], a[20:23], v[144:159]
    s_waitcnt lgkmcnt(10)
    ds_read_b64_tr_b16 a[164:165], v3 offset:18432
    ds_read_b64_tr_b16 a[166:167], v3 offset:18944
    global_load_lds_dwordx4 v87, s[44:45] offset:3072
    v_add_u32 v84, 128, v84
    v_add_u32 v85, 128, v85
    v_add_u32 v86, 128, v86
    s_waitcnt lgkmcnt(10)
    v_smfmac_f32_16x16x64_bf16 a[250:253], a[242:245], v[160:167], v17
    v_smfmac_f32_16x16x64_bf16 a[250:253], a[242:245], v[168:175], v17
    v_dot2_f32_bf16 v34, v160, v160, v34
    v_dot2_f32_bf16 v35, v161, v161, v35
    v_dot2_f32_bf16 v36, v162, v162, v36
    v_dot2_f32_bf16 v37, v163, v163, v37
    v_dot2_f32_bf16 v34, v164, v164, v34
    v_dot2_f32_bf16 v35, v165, v165, v35
    v_dot2_f32_bf16 v36, v166, v166, v36
    v_dot2_f32_bf16 v37, v167, v167, v37
    v_dot2_f32_bf16 v34, v168, v168, v34
    v_dot2_f32_bf16 v35, v169, v169, v35
    v_dot2_f32_bf16 v36, v170, v170, v36
    v_dot2_f32_bf16 v37, v171, v171, v37
    v_dot2_f32_bf16 v34, v172, v172, v34
    v_dot2_f32_bf16 v35, v173, v173, v35
    v_dot2_f32_bf16 v36, v174, v174, v36
    v_dot2_f32_bf16 v37, v175, v175, v37
    v_mfma_f32_32x32x16_bf16 v[96:111], a[176:179], a[24:27], v[96:111]
    s_waitcnt vmcnt(14)
    s_barrier
    ds_read_b64_tr_b16 a[168:169], v12 offset:32768
    ds_read_b64_tr_b16 a[170:171], v12 offset:33280
    ds_read_b128 a[40:43], v94 offset:0
    v_mfma_f32_32x32x16_bf16 v[112:127], a[180:183], a[24:27], v[112:127]
    s_lshl_b32 s6, s86, 2
    s_sub_u32 s6, s6, 191
    s_mul_i32 s7, s6, 205
    s_lshr_b32 s7, s7, 10
    ds_read_b64_tr_b16 a[172:173], v13 offset:32768
    ds_read_b64_tr_b16 a[174:175], v13 offset:33280
    v_add_u32 v87, 128, v87
    v_mfma_f32_32x32x16_bf16 v[128:143], a[184:187], a[24:27], v[128:143]
    s_mov_b32 m0, s51
    s_mul_i32 s98, s7, 5
    s_sub_u32 s98, s6, s98
    ds_read_b64_tr_b16 a[176:177], v12 offset:34816
    ds_read_b64_tr_b16 a[178:179], v12 offset:35328
    ds_read_b128 a[44:47], v95 offset:0
    global_load_lds_dwordx4 v8, s[12:13] offset:0
    v_mfma_f32_32x32x16_bf16 v[144:159], a[188:191], a[24:27], v[144:159]
    s_waitcnt lgkmcnt(8)
    s_mul_i32 s7, s7, 40
    s_lshl2_add_u32 s7, s98, s7
    s_cmp_ge_u32 s98, 2
    s_cselect_b32 s99, 8, 0
    ds_read_b64_tr_b16 a[180:181], v13 offset:34816
    ds_read_b64_tr_b16 a[182:183], v13 offset:35328
    v_mfma_f32_32x32x16_bf16 v[96:111], a[192:195], a[28:31], v[96:111]
    s_add_u32 s7, s7, s99
    s_cmp_eq_u32 s98, 2
    s_cselect_b64 s[100:101], -1, 0
    s_lshl_b32 s6, s86, 5
    ds_read_b64_tr_b16 a[184:185], v14 offset:32768
    ds_read_b64_tr_b16 a[186:187], v14 offset:33280
    global_load_lds_dwordx4 v9, s[12:13] offset:1024
    v_mfma_f32_32x32x16_bf16 v[112:127], a[196:199], a[28:31], v[112:127]
    s_add_u32 s6, s6, 4
    s_cmp_lt_u32 s86, 48
    s_cselect_b32 s6, s6, s7
    s_cselect_b64 s[100:101], 0, s[100:101]
    s_mul_i32 s6, s6, 1280
    ds_read_b64_tr_b16 a[188:189], v15 offset:32768
    ds_read_b64_tr_b16 a[190:191], v15 offset:33280
    v_mfma_f32_32x32x16_bf16 v[128:143], a[160:163], a[28:31], v[128:143]
    s_lshl_b32 s7, s87, 7
    s_add_u32 s99, s3, 4
    s_min_u32 s99, s99, 10
    s_lshl_b32 s99, s99, 21
    ds_read_b64_tr_b16 a[192:193], v14 offset:34816
    ds_read_b64_tr_b16 a[194:195], v14 offset:35328
    global_load_lds_dwordx4 v8, s[14:15] offset:2048
    v_mfma_f32_32x32x16_bf16 v[144:159], a[164:167], a[28:31], v[144:159]
    s_waitcnt lgkmcnt(6)
    s_load_dword s58, s[82:83], s99
    s_add_u32 s92, s6, s7
    ds_read_b64_tr_b16 a[196:197], v15 offset:34816
    ds_read_b64_tr_b16 a[198:199], v15 offset:35328
    v_cndmask_b32 v20, v75, v76, s[100:101]
    v_mfma_f32_32x32x16_bf16 v[96:111], a[168:171], a[32:35], v[96:111]
    s_lshl_b32 s6, s86, 2
    s_sub_u32 s6, s6, 190
    ds_read_b64_tr_b16 a[160:161], v6 offset:32768
    ds_read_b64_tr_b16 a[162:163], v6 offset:33280
    global_load_lds_dwordx4 v9, s[14:15] offset:3072
    v_add_u32 v8, 245760, v8
    v_add_u32 v9, 245760, v9
    v_mfma_f32_32x32x16_bf16 v[112:127], a[172:175], a[32:35], v[112:127]
    s_mov_b32 m0, s62
    ds_read_b64_tr_b16 a[164:165], v7 offset:32768
    ds_read_b64_tr_b16 a[166:167], v7 offset:33280
    s_mov_b64 exec, 7
    global_load_dword a210, v46, s[72:73]
    global_load_dword a210, v46, s[74:75]
    s_mov_b64 exec, -1
    v_add_u32 v46, 393216, v46
    v_smfmac_f32_16x16x64_bf16 a[216:219], a[242:245], a[168:175], v17
    v_mfma_f32_32x32x16_bf16 v[128:143], a[176:179], a[32:35], v[128:143]
    s_waitcnt vmcnt(16)
    s_mul_i32 s7, s6, 205
    ds_read_b64_tr_b16 a[168:169], v6 offset:34816
    ds_read_b64_tr_b16 a[170:171], v6 offset:35328
    ds_read_b128 v[160:163], v92 offset:32768
    ds_read_b128 v[164:167], v93 offset:32768
    global_load_lds_dwordx4 v84, s[44:45] offset:0
    v_mfma_f32_32x32x16_bf16 v[144:159], a[180:183], a[32:35], v[144:159]
    s_waitcnt lgkmcnt(8)
    s_lshr_b32 s7, s7, 10
    s_mul_i32 s98, s7, 5
    s_sub_u32 s98, s6, s98
    s_mul_i32 s7, s7, 40
    ds_read_b64_tr_b16 a[172:173], v7 offset:34816
    ds_read_b64_tr_b16 a[174:175], v7 offset:35328
    ds_read_b128 v[168:171], v94 offset:32768
    ds_read_b128 v[172:175], v95 offset:32768
    v_smfmac_f32_16x16x64_bf16 a[220:223], a[242:245], a[176:183], v17
    v_mfma_f32_32x32x16_bf16 v[96:111], a[184:187], a[36:39], v[96:111]
    s_lshl2_add_u32 s7, s98, s7
    s_cmp_ge_u32 s98, 2
    s_cselect_b32 s99, 8, 0
    ds_read_b64_tr_b16 a[176:177], v2 offset:32768
    ds_read_b64_tr_b16 a[178:179], v2 offset:33280
    ds_read_b128 a[48:51], v92 offset:32768
    global_load_lds_dwordx4 v85, s[44:45] offset:1024
    v_mfma_f32_32x32x16_bf16 v[112:127], a[188:191], a[36:39], v[112:127]
    s_add_u32 s7, s7, s99
    s_cmp_eq_u32 s98, 2
    s_cselect_b64 s[100:101], -1, 0
    s_lshl_b32 s6, s86, 5
    s_add_u32 s6, s6, 16
    ds_read_b64_tr_b16 a[180:181], v3 offset:32768
    ds_read_b64_tr_b16 a[182:183], v3 offset:33280
    v_mfma_f32_32x32x16_bf16 v[128:143], a[192:195], a[36:39], v[128:143]
    s_cmp_lt_u32 s86, 48
    s_cselect_b32 s6, s6, s7
    s_cselect_b64 s[100:101], 0, s[100:101]
    ds_read_b64_tr_b16 a[184:185], v2 offset:34816
    ds_read_b64_tr_b16 a[186:187], v2 offset:35328
    ds_read_b128 a[52:55], v93 offset:32768
    global_load_lds_dwordx4 v86, s[44:45] offset:2048
    v_mfma_f32_32x32x16_bf16 v[144:159], a[196:199], a[36:39], v[144:159]
    s_waitcnt lgkmcnt(10)
    s_mul_i32 s6, s6, 1280
    s_add_u32 s99, s3, 8
    s_min_u32 s99, s99, 10
    s_lshl_b32 s99, s99, 21
    ds_read_b64_tr_b16 a[188:189], v3 offset:34816
    ds_read_b64_tr_b16 a[190:191], v3 offset:35328
    s_waitcnt lgkmcnt(10)
    v_smfmac_f32_16x16x64_bf16 a[250:253], a[242:245], v[160:167], v17
    v_smfmac_f32_16x16x64_bf16 a[250:253], a[242:245], v[168:175], v17
    v_dot2_f32_bf16 v34, v160, v160, v34
    v_dot2_f32_bf16 v35, v161, v161, v35
    v_dot2_f32_bf16 v36, v162, v162, v36
    v_dot2_f32_bf16 v37, v163, v163, v37
    v_dot2_f32_bf16 v34, v164, v164, v34
    v_dot2_f32_bf16 v35, v165, v165, v35
    v_dot2_f32_bf16 v36, v166, v166, v36
    v_dot2_f32_bf16 v37, v167, v167, v37
    v_dot2_f32_bf16 v34, v168, v168, v34
    v_dot2_f32_bf16 v35, v169, v169, v35
    v_dot2_f32_bf16 v36, v170, v170, v36
    v_dot2_f32_bf16 v37, v171, v171, v37
    v_dot2_f32_bf16 v34, v172, v172, v34
    v_dot2_f32_bf16 v35, v173, v173, v35
    v_dot2_f32_bf16 v36, v174, v174, v36
    v_dot2_f32_bf16 v37, v175, v175, v37
    v_mfma_f32_32x32x16_bf16 v[96:111], a[160:163], a[40:43], v[96:111]
    s_waitcnt vmcnt(15)
    s_barrier
    ds_read_b64_tr_b16 a[192:193], v12 offset:49152
    ds_read_b64_tr_b16 a[194:195], v12 offset:49664
    ds_read_b128 a[56:59], v94 offset:32768
    v_mfma_f32_32x32x16_bf16 v[112:127], a[164:167], a[40:43], v[112:127]
    s_load_dword s58, s[82:83], s99
    ds_read_b64_tr_b16 a[196:197], v13 offset:49152
    ds_read_b64_tr_b16 a[198:199], v13 offset:49664
    global_load_lds_dwordx4 v87, s[44:45] offset:3072
    v_add_u32 v84, 128, v84
    v_add_u32 v85, 128, v85
    v_add_u32 v86, 128, v86
    v_mfma_f32_32x32x16_bf16 v[128:143], a[168:171], a[40:43], v[128:143]
    s_lshl_b32 s7, s87, 7
    s_add_u32 s93, s6, s7
    ds_read_b64_tr_b16 a[160:161], v12 offset:51200
    ds_read_b64_tr_b16 a[162:163], v12 offset:51712
    ds_read_b128 a[60:63], v95 offset:32768
    v_xor_b32 v12, 0x10000, v12
    v_add_u32 v87, 128, v87
    v_mfma_f32_32x32x16_bf16 v[144:159], a[172:175], a[40:43], v[144:159]
    s_waitcnt lgkmcnt(8)
    s_mov_b32 m0, s52
    ds_read_b64_tr_b16 a[164:165], v13 offset:51200
    ds_read_b64_tr_b16 a[166:167], v13 offset:51712
    global_load_lds_dwordx4 v8, s[12:13] offset:0
    v_xor_b32 v13, 0x10000, v13
    v_cndmask_b32 v21, v75, v76, s[100:101]
    v_mfma_f32_32x32x16_bf16 v[96:111], a[176:179], a[44:47], v[96:111]
    s_lshl_b32 s6, s86, 2
    s_sub_u32 s6, s6, 189
    s_mul_i32 s7, s6, 205
    s_lshr_b32 s7, s7, 10
    s_mul_i32 s98, s7, 5
    ds_read_b64_tr_b16 a[168:169], v14 offset:49152
    ds_read_b64_tr_b16 a[170:171], v14 offset:49664
    v_mfma_f32_32x32x16_bf16 v[112:127], a[180:183], a[44:47], v[112:127]
    s_sub_u32 s98, s6, s98
    s_mul_i32 s7, s7, 40
    s_lshl2_add_u32 s7, s98, s7
    s_cmp_ge_u32 s98, 2
    ds_read_b64_tr_b16 a[172:173], v15 offset:49152
    ds_read_b64_tr_b16 a[174:175], v15 offset:49664
    global_load_lds_dwordx4 v9, s[12:13] offset:1024
    v_mfma_f32_32x32x16_bf16 v[128:143], a[184:187], a[44:47], v[128:143]
    s_cselect_b32 s99, 8, 0
    s_add_u32 s7, s7, s99
    s_cmp_eq_u32 s98, 2
    s_cselect_b64 s[100:101], -1, 0
    ds_read_b64_tr_b16 a[176:177], v14 offset:51200
    ds_read_b64_tr_b16 a[178:179], v14 offset:51712
    v_xor_b32 v14, 0x10000, v14
    v_mfma_f32_32x32x16_bf16 v[144:159], a[188:191], a[44:47], v[144:159]
    s_waitcnt lgkmcnt(6)
    s_lshl_b32 s6, s86, 5
    s_add_u32 s6, s6, 20
    ds_read_b64_tr_b16 a[180:181], v15 offset:51200
    ds_read_b64_tr_b16 a[182:183], v15 offset:51712
    global_load_lds_dwordx4 v8, s[14:15] offset:2048
    v_xor_b32 v15, 0x10000, v15
    v_mfma_f32_32x32x16_bf16 v[96:111], a[192:195], a[48:51], v[96:111]
    s_cmp_lt_u32 s86, 48
    s_cselect_b32 s6, s6, s7
    s_cselect_b64 s[100:101], 0, s[100:101]
    s_mov_b32 s99, 0x200000
    ds_read_b64_tr_b16 a[184:185], v6 offset:49152
    ds_read_b64_tr_b16 a[186:187], v6 offset:49664
    v_mfma_f32_32x32x16_bf16 v[112:127], a[196:199], a[48:51], v[112:127]
    ds_read_b64_tr_b16 a[188:189], v7 offset:49152
    ds_read_b64_tr_b16 a[190:191], v7 offset:49664
    global_load_lds_dwordx4 v9, s[14:15] offset:3072
    v_add_u32 v8, 245760, v8
    v_add_u32 v9, 245760, v9
    s_mov_b64 exec, 7
    global_load_dword a210, v46, s[72:73]
    global_load_dword a210, v46, s[74:75]
    s_mov_b64 exec, -1
    v_add_u32 v46, 393216, v46
    v_smfmac_f32_16x16x64_bf16 a[216:219], a[242:245], a[192:199], v17
    v_mfma_f32_32x32x16_bf16 v[128:143], a[160:163], a[48:51], v[128:143]
    s_waitcnt vmcnt(16)
    s_mov_b32 m0, s53
    ds_read_b64_tr_b16 a[192:193], v6 offset:51200
    ds_read_b64_tr_b16 a[194:195], v6 offset:51712
    ds_read_b128 v[160:163], v92 offset:16384
    ds_read_b128 v[164:167], v93 offset:16384
    v_xor_b32 v6, 0x10000, v6
    v_mfma_f32_32x32x16_bf16 v[144:159], a[164:167], a[48:51], v[144:159]
    s_waitcnt lgkmcnt(8)
    s_load_dword s58, s[78:79], s99
    s_mul_i32 s6, s6, 1280
    ds_read_b64_tr_b16 a[196:197], v7 offset:51200
    ds_read_b64_tr_b16 a[198:199], v7 offset:51712
    ds_read_b128 v[168:171], v94 offset:16384
    ds_read_b128 v[172:175], v95 offset:16384
    global_load_lds_dwordx4 v84, s[44:45] offset:0
    v_smfmac_f32_16x16x64_bf16 a[220:223], a[242:245], a[160:167], v17
    v_xor_b32 v7, 0x10000, v7
    v_mfma_f32_32x32x16_bf16 v[96:111], a[168:171], a[52:55], v[96:111]
    s_lshl_b32 s7, s87, 7
    s_add_u32 s94, s6, s7
    ds_read_b64_tr_b16 a[160:161], v2 offset:49152
    ds_read_b64_tr_b16 a[162:163], v2 offset:49664
    ds_read_b128 a[64:67], v92 offset:16384
    v_cndmask_b32 v22, v75, v76, s[100:101]
    v_mfma_f32_32x32x16_bf16 v[112:127], a[172:175], a[52:55], v[112:127]
    s_add_u32 s54, s42, 147456
    ds_read_b64_tr_b16 a[164:165], v3 offset:49152
    ds_read_b64_tr_b16 a[166:167], v3 offset:49664
    global_load_lds_dwordx4 v85, s[44:45] offset:1024
    v_lshrrev_b32 v74, 4, v1
    v_lshlrev_b32 v74, 10, v74
    v_and_b32 v75, 15, v1
    v_mfma_f32_32x32x16_bf16 v[128:143], a[176:179], a[52:55], v[128:143]
    ds_read_b64_tr_b16 a[168:169], v2 offset:51200
    ds_read_b64_tr_b16 a[170:171], v2 offset:51712
    ds_read_b128 a[68:71], v93 offset:16384
    v_xor_b32 v2, 0x10000, v2
    v_lshrrev_b32 v76, 2, v75
    v_lshl_add_u32 v74, v76, 7, v74
    v_mfma_f32_32x32x16_bf16 v[144:159], a[180:183], a[52:55], v[144:159]
    s_waitcnt lgkmcnt(10)
    ds_read_b64_tr_b16 a[172:173], v3 offset:51200
    ds_read_b64_tr_b16 a[174:175], v3 offset:51712
    global_load_lds_dwordx4 v86, s[44:45] offset:2048
    v_xor_b32 v3, 0x10000, v3
    v_and_b32 v75, 3, v75
    v_lshl_add_u32 v74, v75, 3, v74
    s_waitcnt lgkmcnt(10)
    v_smfmac_f32_16x16x64_bf16 a[250:253], a[242:245], v[160:167], v17
    v_smfmac_f32_16x16x64_bf16 a[250:253], a[242:245], v[168:175], v17
    v_dot2_f32_bf16 v34, v160, v160, v34
    v_dot2_f32_bf16 v35, v161, v161, v35
    v_dot2_f32_bf16 v36, v162, v162, v36
    v_dot2_f32_bf16 v37, v163, v163, v37
    v_dot2_f32_bf16 v34, v164, v164, v34
    v_dot2_f32_bf16 v35, v165, v165, v35
    v_dot2_f32_bf16 v36, v166, v166, v36
    v_dot2_f32_bf16 v37, v167, v167, v37
    v_dot2_f32_bf16 v34, v168, v168, v34
    v_dot2_f32_bf16 v35, v169, v169, v35
    v_dot2_f32_bf16 v36, v170, v170, v36
    v_dot2_f32_bf16 v37, v171, v171, v37
    v_dot2_f32_bf16 v34, v172, v172, v34
    v_dot2_f32_bf16 v35, v173, v173, v35
    v_dot2_f32_bf16 v36, v174, v174, v36
    v_dot2_f32_bf16 v37, v175, v175, v37
    v_mfma_f32_32x32x16_bf16 v[96:111], a[184:187], a[56:59], v[96:111]
    s_waitcnt vmcnt(15)
    s_barrier
    ds_read_b64_tr_b16 a[176:177], v12 offset:0
    ds_read_b64_tr_b16 a[178:179], v12 offset:512
    ds_read_b128 a[72:75], v94 offset:16384
    v_mfma_f32_32x32x16_bf16 v[112:127], a[188:191], a[56:59], v[112:127]
    ds_read_b64_tr_b16 a[180:181], v13 offset:0
    ds_read_b64_tr_b16 a[182:183], v13 offset:512
    global_load_lds_dwordx4 v87, s[44:45] offset:3072
    v_add_u32 v84, 128, v84
    v_add_u32 v85, 128, v85
    v_add_u32 v86, 128, v86
    v_mfma_f32_32x32x16_bf16 v[128:143], a[192:195], a[56:59], v[128:143]
    ds_read_b64_tr_b16 a[184:185], v12 offset:2048
    ds_read_b64_tr_b16 a[186:187], v12 offset:2560
    ds_read_b128 a[76:79], v95 offset:16384
    v_add_u32 v87, 128, v87
    v_add_u32 v24, s54, v74
    v_mfma_f32_32x32x16_bf16 v[144:159], a[196:199], a[56:59], v[144:159]
    s_waitcnt lgkmcnt(8)
    s_mov_b32 m0, s47
    s_lshl_b32 s88, s4, 2
    s_lshr_b32 s98, s5, 3
    ds_read_b64_tr_b16 a[188:189], v13 offset:2048
    ds_read_b64_tr_b16 a[190:191], v13 offset:2560
    global_load_lds_dwordx4 v8, s[12:13] offset:0
    v_mfma_f32_32x32x16_bf16 v[96:111], a[160:163], a[60:63], v[96:111]
    s_add_u32 s88, s88, s98
    s_and_b32 s89, s5, 7
    s_and_b32 s90, s3, 1
    s_lshr_b32 s98, s88, 1
    s_mul_i32 s98, s98, 5
    ds_read_b64_tr_b16 a[192:193], v14 offset:0
    ds_read_b64_tr_b16 a[194:195], v14 offset:512
    v_mfma_f32_32x32x16_bf16 v[112:127], a[164:167], a[60:63], v[112:127]
    s_and_b32 s99, s88, 1
    s_mul_i32 s100, s99, 3
    s_add_u32 s100, s100, s98
    s_lshl_b32 s100, s100, 15
    ds_read_b64_tr_b16 a[196:197], v15 offset:0
    ds_read_b64_tr_b16 a[198:199], v15 offset:512
    global_load_lds_dwordx4 v9, s[12:13] offset:1024
    v_mfma_f32_32x32x16_bf16 v[128:143], a[168:171], a[60:63], v[128:143]
    s_add_u32 s98, s98, 2
    s_lshl_b32 s98, s98, 15
    s_lshl_b32 s99, s99, 3
    s_add_u32 s99, s99, s98
    s_mul_i32 s98, s88, 81920
    ds_read_b64_tr_b16 a[160:161], v14 offset:2048
    ds_read_b64_tr_b16 a[162:163], v14 offset:2560
    v_mfma_f32_32x32x16_bf16 v[144:159], a[172:175], a[60:63], v[144:159]
    s_waitcnt lgkmcnt(6)
    ds_read_b64_tr_b16 a[164:165], v15 offset:2048
    ds_read_b64_tr_b16 a[166:167], v15 offset:2560
    global_load_lds_dwordx4 v8, s[14:15] offset:2048
    v_lshrrev_b32 v44, 5, v1
    v_and_b32 v45, 31, v1
    v_lshlrev_b32 v47, 4, v45
    v_mfma_f32_32x32x16_bf16 v[96:111], a[176:179], a[64:67], v[96:111]
    ds_read_b64_tr_b16 a[168:169], v6 offset:0
    ds_read_b64_tr_b16 a[170:171], v6 offset:512
    v_lshrrev_b32 v30, 1, v45
    v_lshl_add_u32 v59, v44, 15, v47
    v_xor_b32 v30, v30, v45
    v_add_u32 v59, s100, v59
    v_mfma_f32_32x32x16_bf16 v[112:127], a[180:183], a[64:67], v[112:127]
    ds_read_b64_tr_b16 a[172:173], v7 offset:0
    ds_read_b64_tr_b16 a[174:175], v7 offset:512
    global_load_lds_dwordx4 v9, s[14:15] offset:3072
    v_add_u32 v8, 245760, v8
    v_add_u32 v9, 245760, v9
    s_mov_b64 exec, 7
    global_load_dword a210, v46, s[72:73]
    global_load_dword a210, v46, s[74:75]
    s_mov_b64 exec, -1
    v_add_u32 v46, 393216, v46
    v_smfmac_f32_16x16x64_bf16 a[216:219], a[242:245], a[176:183], v17
    v_mfma_f32_32x32x16_bf16 v[128:143], a[184:187], a[64:67], v[128:143]
    s_waitcnt vmcnt(16)
    s_mov_b32 m0, s63
    ds_read_b64_tr_b16 a[176:177], v6 offset:2048
    ds_read_b64_tr_b16 a[178:179], v6 offset:2560
    ds_read_b128 v[160:163], v92 offset:0
    ds_read_b128 v[164:167], v93 offset:0
    v_and_b32 v30, 4, v30
    v_mfma_f32_32x32x16_bf16 v[144:159], a[188:191], a[64:67], v[144:159]
    s_waitcnt lgkmcnt(8)
    ds_read_b64_tr_b16 a[180:181], v7 offset:2048
    ds_read_b64_tr_b16 a[182:183], v7 offset:2560
    ds_read_b128 v[168:171], v94 offset:0
    ds_read_b128 v[172:175], v95 offset:0
    global_load_lds_dwordx4 v84, s[44:45] offset:0
    v_smfmac_f32_16x16x64_bf16 a[220:223], a[242:245], a[184:191], v17
    v_add_u32 v47, s99, v47
    v_mul_u32_u24 v30, 48, v30
    v_cmp_eq_u32 vcc, 0, v44
    v_mfma_f32_32x32x16_bf16 v[96:111], a[192:195], a[68:71], v[96:111]
    ds_read_b64_tr_b16 a[184:185], v2 offset:0
    ds_read_b64_tr_b16 a[186:187], v2 offset:512
    ds_read_b128 a[80:83], v92 offset:0
    v_xor_b32 v48, v59, v30
    v_xor_b32 v50, v47, v30
    v_mov_b32 v30, 5242880
    v_mfma_f32_32x32x16_bf16 v[112:127], a[196:199], a[68:71], v[112:127]
    ds_read_b64_tr_b16 a[188:189], v3 offset:0
    ds_read_b64_tr_b16 a[190:191], v3 offset:512
    global_load_lds_dwordx4 v85, s[44:45] offset:1024
    v_mov_b32 v51, 7864336
    v_mov_b32 v63, 0xdddd
    v_cndmask_b32 v50, v30, v50, vcc
    v_mfma_f32_32x32x16_bf16 v[128:143], a[160:163], a[68:71], v[128:143]
    ds_read_b64_tr_b16 a[192:193], v2 offset:2048
    ds_read_b64_tr_b16 a[194:195], v2 offset:2560
    ds_read_b128 a[84:87], v93 offset:0
    v_cndmask_b32 v51, v51, v47, vcc
    v_lshrrev_b32 v47, 2, v45
    v_lshlrev_b32 v47, 14, v47
    v_mfma_f32_32x32x16_bf16 v[144:159], a[164:167], a[68:71], v[144:159]
    s_waitcnt lgkmcnt(10)
    ds_read_b64_tr_b16 a[196:197], v3 offset:2048
    ds_read_b64_tr_b16 a[198:199], v3 offset:2560
    global_load_lds_dwordx4 v86, s[44:45] offset:2048
    v_add_u32 v47, s98, v47
    v_and_b32 v30, 3, v45
    v_lshlrev_b32 v30, 4, v30
    s_waitcnt lgkmcnt(10)
    v_smfmac_f32_16x16x64_bf16 a[250:253], a[242:245], v[160:167], v17
    v_smfmac_f32_16x16x64_bf16 a[250:253], a[242:245], v[168:175], v17
    v_dot2_f32_bf16 v34, v160, v160, v34
    v_dot2_f32_bf16 v35, v161, v161, v35
    v_dot2_f32_bf16 v36, v162, v162, v36
    v_dot2_f32_bf16 v37, v163, v163, v37
    v_dot2_f32_bf16 v34, v164, v164, v34
    v_dot2_f32_bf16 v35, v165, v165, v35
    v_dot2_f32_bf16 v36, v166, v166, v36
    v_dot2_f32_bf16 v37, v167, v167, v37
    v_dot2_f32_bf16 v34, v168, v168, v34
    v_dot2_f32_bf16 v35, v169, v169, v35
    v_dot2_f32_bf16 v36, v170, v170, v36
    v_dot2_f32_bf16 v37, v171, v171, v37
    v_dot2_f32_bf16 v34, v172, v172, v34
    v_dot2_f32_bf16 v35, v173, v173, v35
    v_dot2_f32_bf16 v36, v174, v174, v36
    v_dot2_f32_bf16 v37, v175, v175, v37
    v_mfma_f32_32x32x16_bf16 v[96:111], a[168:171], a[72:75], v[96:111]
    s_waitcnt vmcnt(15)
    s_barrier
    ds_read_b64_tr_b16 a[160:161], v12 offset:16384
    ds_read_b64_tr_b16 a[162:163], v12 offset:16896
    ds_read_b128 a[88:91], v94 offset:0
    v_mfma_f32_32x32x16_bf16 v[112:127], a[172:175], a[72:75], v[112:127]
    ds_read_b64_tr_b16 a[164:165], v13 offset:16384
    ds_read_b64_tr_b16 a[166:167], v13 offset:16896
    global_load_lds_dwordx4 v87, s[44:45] offset:3072
    v_add_u32 v84, 128, v84
    v_add_u32 v85, 128, v85
    v_add_u32 v86, 128, v86
    v_mfma_f32_32x32x16_bf16 v[128:143], a[176:179], a[72:75], v[128:143]
    ds_read_b64_tr_b16 a[168:169], v12 offset:18432
    ds_read_b64_tr_b16 a[170:171], v12 offset:18944
    ds_read_b128 a[92:95], v95 offset:0
    v_xor_b32 v12, 0x10000, v12
    v_add_u32 v87, 128, v87
    v_lshl_add_u32 v30, v44, 6, v30
    v_mfma_f32_32x32x16_bf16 v[144:159], a[180:183], a[72:75], v[144:159]
    s_waitcnt lgkmcnt(8)
    s_mov_b32 m0, s48
    ds_read_b64_tr_b16 a[172:173], v13 offset:18432
    ds_read_b64_tr_b16 a[174:175], v13 offset:18944
    global_load_lds_dwordx4 v8, s[12:13] offset:0
    v_xor_b32 v13, 0x10000, v13
    v_add_u32 v47, v47, v30
    v_mfma_f32_32x32x16_bf16 v[96:111], a[184:187], a[76:79], v[96:111]
    ds_read_b64_tr_b16 a[176:177], v14 offset:16384
    ds_read_b64_tr_b16 a[178:179], v14 offset:16896
    v_mov_b32 v30, 2621456
    v_cmp_gt_u32 vcc, 20, v45
    v_mfma_f32_32x32x16_bf16 v[112:127], a[188:191], a[76:79], v[112:127]
    s_lshl_b32 s98, s90, 14
    s_add_u32 s99, s98, 2625536
    s_lshr_b32 s98, s98, 1
    ds_read_b64_tr_b16 a[180:181], v15 offset:16384
    ds_read_b64_tr_b16 a[182:183], v15 offset:16896
    global_load_lds_dwordx4 v9, s[12:13] offset:1024
    v_cndmask_b32 v47, v30, v47, vcc
    v_mfma_f32_32x32x16_bf16 v[128:143], a[192:195], a[76:79], v[128:143]
    ds_read_b64_tr_b16 a[184:185], v14 offset:18432
    ds_read_b64_tr_b16 a[186:187], v14 offset:18944
    v_xor_b32 v14, 0x10000, v14
    v_mov_b32 v30, 2621440
    v_cmp_eq_u32 vcc, 20, v45
    v_mfma_f32_32x32x16_bf16 v[144:159], a[196:199], a[76:79], v[144:159]
    s_waitcnt lgkmcnt(6)
    s_add_u32 s64, s24, s99
    s_addc_u32 s65, s25, 0
    ds_read_b64_tr_b16 a[188:189], v15 offset:18432
    ds_read_b64_tr_b16 a[190:191], v15 offset:18944
    global_load_lds_dwordx4 v8, s[14:15] offset:2048
    v_xor_b32 v15, 0x10000, v15
    v_mfma_f32_32x32x16_bf16 v[96:111], a[160:163], a[80:83], v[96:111]
    ds_read_b64_tr_b16 a[192:193], v6 offset:16384
    ds_read_b64_tr_b16 a[194:195], v6 offset:16896
    v_cndmask_b32 v52, v47, v30, vcc
    v_mfma_f32_32x32x16_bf16 v[112:127], a[164:167], a[80:83], v[112:127]
    ds_read_b64_tr_b16 a[196:197], v7 offset:16384
    ds_read_b64_tr_b16 a[198:199], v7 offset:16896
    global_load_lds_dwordx4 v9, s[14:15] offset:3072
    v_add_u32 v8, 245760, v8
    v_add_u32 v9, 245760, v9
    s_mov_b64 exec, 7
    global_load_dword a210, v46, s[72:73]
    global_load_dword a210, v46, s[74:75]
    s_mov_b64 exec, -1
    v_add_u32 v46, 393216, v46
    v_smfmac_f32_16x16x64_bf16 a[216:219], a[242:245], a[160:167], v17
    v_mfma_f32_32x32x16_bf16 v[128:143], a[168:171], a[80:83], v[128:143]
    s_waitcnt vmcnt(16)
    s_mov_b32 m0, s62
    ds_read_b64_tr_b16 a[160:161], v6 offset:18432
    ds_read_b64_tr_b16 a[162:163], v6 offset:18944
    ds_read_b128 v[160:163], v92 offset:32768
    ds_read_b128 v[164:167], v93 offset:32768
    v_xor_b32 v6, 0x10000, v6
    v_mfma_f32_32x32x16_bf16 v[144:159], a[172:175], a[80:83], v[144:159]
    s_waitcnt lgkmcnt(8)
    s_add_u32 s99, s98, 5246976
    s_add_u32 s66, s24, s99
    ds_read_b64_tr_b16 a[164:165], v7 offset:18432
    ds_read_b64_tr_b16 a[166:167], v7 offset:18944
    ds_read_b128 v[168:171], v94 offset:32768
    ds_read_b128 v[172:175], v95 offset:32768
    global_load_lds_dwordx4 v84, s[44:45] offset:0
    v_smfmac_f32_16x16x64_bf16 a[220:223], a[242:245], a[168:175], v17
    v_xor_b32 v7, 0x10000, v7
    v_mfma_f32_32x32x16_bf16 v[96:111], a[176:179], a[84:87], v[96:111]
    s_addc_u32 s67, s25, 0
    s_lshl_b32 s98, s89, 1
    s_lshr_b32 s99, s3, 1
    s_add_u32 s98, s98, s99
    ds_read_b64_tr_b16 a[168:169], v2 offset:16384
    ds_read_b64_tr_b16 a[170:171], v2 offset:16896
    ds_read_b128 a[96:99], v92 offset:32768
    v_mfma_f32_32x32x16_bf16 v[112:127], a[180:183], a[84:87], v[112:127]
    s_lshl_b32 s98, s98, 11
    s_lshl_b32 s99, s90, 10
    s_add_u32 s100, s98, s99
    s_add_u32 s68, s24, s100
    ds_read_b64_tr_b16 a[172:173], v3 offset:16384
    ds_read_b64_tr_b16 a[174:175], v3 offset:16896
    global_load_lds_dwordx4 v85, s[44:45] offset:1024
    v_mfma_f32_32x32x16_bf16 v[128:143], a[184:187], a[84:87], v[128:143]
    s_addc_u32 s69, s25, 0
    s_xor_b32 s46, s100, 1024
    s_lshr_b32 s99, s88, 1
    ds_read_b64_tr_b16 a[176:177], v2 offset:18432
    ds_read_b64_tr_b16 a[178:179], v2 offset:18944
    ds_read_b128 a[100:103], v93 offset:32768
    v_xor_b32 v2, 0x10000, v2
    v_mfma_f32_32x32x16_bf16 v[144:159], a[188:191], a[84:87], v[144:159]
    s_waitcnt lgkmcnt(10)
    s_mul_i32 s99, s99, 163840
    s_add_u32 s77, s100, s99
    ds_read_b64_tr_b16 a[180:181], v3 offset:18432
    ds_read_b64_tr_b16 a[182:183], v3 offset:18944
    global_load_lds_dwordx4 v86, s[44:45] offset:2048
    v_xor_b32 v3, 0x10000, v3
    s_waitcnt lgkmcnt(10)
    v_smfmac_f32_16x16x64_bf16 a[250:253], a[242:245], v[160:167], v17
    v_smfmac_f32_16x16x64_bf16 a[250:253], a[242:245], v[168:175], v17
    v_dot2_f32_bf16 v34, v160, v160, v34
    v_dot2_f32_bf16 v35, v161, v161, v35
    v_dot2_f32_bf16 v36, v162, v162, v36
    v_dot2_f32_bf16 v37, v163, v163, v37
    v_dot2_f32_bf16 v34, v164, v164, v34
    v_dot2_f32_bf16 v35, v165, v165, v35
    v_dot2_f32_bf16 v36, v166, v166, v36
    v_dot2_f32_bf16 v37, v167, v167, v37
    v_dot2_f32_bf16 v34, v168, v168, v34
    v_dot2_f32_bf16 v35, v169, v169, v35
    v_dot2_f32_bf16 v36, v170, v170, v36
    v_dot2_f32_bf16 v37, v171, v171, v37
    v_dot2_f32_bf16 v34, v172, v172, v34
    v_dot2_f32_bf16 v35, v173, v173, v35
    v_dot2_f32_bf16 v36, v174, v174, v36
    v_dot2_f32_bf16 v37, v175, v175, v37
    v_mfma_f32_32x32x16_bf16 v[96:111], a[192:195], a[88:91], v[96:111]
    s_waitcnt vmcnt(15)
    s_barrier
    ds_read_b64_tr_b16 a[184:185], v12 offset:0
    ds_read_b64_tr_b16 a[186:187], v12 offset:512
    ds_read_b128 a[104:107], v94 offset:32768
    v_mfma_f32_32x32x16_bf16 v[112:127], a[196:199], a[88:91], v[112:127]
    s_add_u32 s77, s77, 8388608
    ds_read_b64_tr_b16 a[188:189], v13 offset:0
    ds_read_b64_tr_b16 a[190:191], v13 offset:512
    global_load_lds_dwordx4 v87, s[44:45] offset:3072
    v_add_u32 v84, 128, v84
    v_add_u32 v85, 128, v85
    v_add_u32 v86, 128, v86
    v_mfma_f32_32x32x16_bf16 v[128:143], a[160:163], a[88:91], v[128:143]
    s_and_b32 s99, s88, 1
    s_lshl3_add_u32 s83, s99, s77
    s_mul_i32 s99, s99, 98304
    ds_read_b64_tr_b16 a[192:193], v12 offset:2048
    ds_read_b64_tr_b16 a[194:195], v12 offset:2560
    ds_read_b128 a[108:111], v95 offset:32768
    v_add_u32 v87, 128, v87
    v_mfma_f32_32x32x16_bf16 v[144:159], a[164:167], a[88:91], v[144:159]
    s_waitcnt lgkmcnt(8)
    s_mov_b32 m0, s49
    s_add_u32 s77, s77, s99
    s_add_u32 s70, s24, s46
    ds_read_b64_tr_b16 a[196:197], v13 offset:2048
    ds_read_b64_tr_b16 a[198:199], v13 offset:2560
    global_load_lds_dwordx4 v8, s[12:13] offset:0
    v_mfma_f32_32x32x16_bf16 v[96:111], a[168:171], a[92:95], v[96:111]
    s_addc_u32 s71, s25, 0
    s_lshr_b32 s98, s4, 1
    s_lshl_b32 s98, s98, 3
    s_add_u32 s81, s98, s89
    s_and_b32 s98, s4, 1
    ds_read_b64_tr_b16 a[160:161], v14 offset:0
    ds_read_b64_tr_b16 a[162:163], v14 offset:512
    v_mfma_f32_32x32x16_bf16 v[112:127], a[172:175], a[92:95], v[112:127]
    s_lshl_b32 s98, s98, 2
    s_lshr_b32 s99, s5, 3
    s_add_u32 s82, s98, s99
    ds_read_b64_tr_b16 a[164:165], v15 offset:0
    ds_read_b64_tr_b16 a[166:167], v15 offset:512
    global_load_lds_dwordx4 v9, s[12:13] offset:1024
    v_lshlrev_b32 v47, 4, v45
    v_mfma_f32_32x32x16_bf16 v[128:143], a[176:179], a[92:95], v[128:143]
    ds_read_b64_tr_b16 a[168:169], v14 offset:2048
    ds_read_b64_tr_b16 a[170:171], v14 offset:2560
    v_lshl_add_u32 v58, v44, 15, v47
    v_lshlrev_b32 v53, 4, v1
    v_lshrrev_b32 v47, 4, v1
    v_and_b32 v30, 15, v1
    v_mfma_f32_32x32x16_bf16 v[144:159], a[180:183], a[92:95], v[144:159]
    s_waitcnt lgkmcnt(6)
    ds_read_b64_tr_b16 a[172:173], v15 offset:2048
    ds_read_b64_tr_b16 a[174:175], v15 offset:2560
    global_load_lds_dwordx4 v8, s[14:15] offset:2048
    v_lshlrev_b32 v30, 4, v30
    v_lshl_add_u32 v49, v47, 15, v30
    v_mfma_f32_32x32x16_bf16 v[96:111], a[184:187], a[96:99], v[96:111]
    s_mul_i32 s98, s3, 40960
    ds_read_b64_tr_b16 a[176:177], v6 offset:0
    ds_read_b64_tr_b16 a[178:179], v6 offset:512
    v_add_u32 v60, s98, v53
    v_mfma_f32_32x32x16_bf16 v[112:127], a[188:191], a[96:99], v[112:127]
    ds_read_b64_tr_b16 a[180:181], v7 offset:0
    ds_read_b64_tr_b16 a[182:183], v7 offset:512
    global_load_lds_dwordx4 v9, s[14:15] offset:3072
    v_add_u32 v8, 245760, v8
    v_add_u32 v9, 245760, v9
    s_mov_b64 exec, 7
    global_load_dword a210, v46, s[72:73]
    global_load_dword a210, v46, s[74:75]
    s_mov_b64 exec, -1
    v_smfmac_f32_16x16x64_bf16 a[216:219], a[242:245], a[184:191], v17
    v_mfma_f32_32x32x16_bf16 v[128:143], a[192:195], a[96:99], v[128:143]
    s_waitcnt vmcnt(16)
    s_mov_b32 m0, s53
    s_xor_b32 s99, s3, 1
    ds_read_b64_tr_b16 a[184:185], v6 offset:2048
    ds_read_b64_tr_b16 a[186:187], v6 offset:2560
    ds_read_b128 v[160:163], v92 offset:16384
    ds_read_b128 v[164:167], v93 offset:16384
    v_mfma_f32_32x32x16_bf16 v[144:159], a[196:199], a[96:99], v[144:159]
    s_waitcnt lgkmcnt(8)
    s_mul_i32 s98, s99, 40960
    ds_read_b64_tr_b16 a[188:189], v7 offset:2048
    ds_read_b64_tr_b16 a[190:191], v7 offset:2560
    ds_read_b128 v[168:171], v94 offset:16384
    ds_read_b128 v[172:175], v95 offset:16384
    global_load_lds_dwordx4 v84, s[44:45] offset:0
    v_smfmac_f32_16x16x64_bf16 a[220:223], a[242:245], a[192:199], v17
    v_add_u32 v61, s98, v53
    v_add_u32 v62, 8192, v38
    v_mfma_f32_32x32x16_bf16 v[96:111], a[160:163], a[100:103], v[96:111]
    s_lshl_b32 s98, s81, 10
    s_mul_i32 s99, s3, 655360
    s_add_u32 s76, s98, s99
    s_add_u32 s76, s76, 8388608
    ds_read_b64_tr_b16 a[192:193], v2 offset:0
    ds_read_b64_tr_b16 a[194:195], v2 offset:512
    ds_read_b128 a[112:115], v92 offset:16384
    v_mfma_f32_32x32x16_bf16 v[112:127], a[164:167], a[100:103], v[112:127]
    s_add_u32 s83, s83, 65536
    s_mov_b32 s43, 0
    s_add_u32 s98, s3, 1
    s_and_b32 s98, s98, 3
    ds_read_b64_tr_b16 a[196:197], v3 offset:0
    ds_read_b64_tr_b16 a[198:199], v3 offset:512
    global_load_lds_dwordx4 v85, s[44:45] offset:1024
    v_mfma_f32_32x32x16_bf16 v[128:143], a[168:171], a[100:103], v[128:143]
    s_mul_i32 s99, s98, 49152
    ds_read_b64_tr_b16 a[160:161], v2 offset:2048
    ds_read_b64_tr_b16 a[162:163], v2 offset:2560
    ds_read_b128 a[116:119], v93 offset:16384
    v_add_u32 v54, s99, v53
    v_mfma_f32_32x32x16_bf16 v[144:159], a[172:175], a[100:103], v[144:159]
    s_waitcnt lgkmcnt(10)
    s_add_u32 s98, s3, 2
    s_and_b32 s98, s98, 3
    s_mul_i32 s99, s98, 49152
    ds_read_b64_tr_b16 a[164:165], v3 offset:2048
    ds_read_b64_tr_b16 a[166:167], v3 offset:2560
    global_load_lds_dwordx4 v86, s[44:45] offset:2048
    s_waitcnt lgkmcnt(10)
    v_smfmac_f32_16x16x64_bf16 a[250:253], a[242:245], v[160:167], v17
    v_smfmac_f32_16x16x64_bf16 a[250:253], a[242:245], v[168:175], v17
    v_dot2_f32_bf16 v34, v160, v160, v34
    v_dot2_f32_bf16 v35, v161, v161, v35
    v_dot2_f32_bf16 v36, v162, v162, v36
    v_dot2_f32_bf16 v37, v163, v163, v37
    v_dot2_f32_bf16 v34, v164, v164, v34
    v_dot2_f32_bf16 v35, v165, v165, v35
    v_dot2_f32_bf16 v36, v166, v166, v36
    v_dot2_f32_bf16 v37, v167, v167, v37
    v_dot2_f32_bf16 v34, v168, v168, v34
    v_dot2_f32_bf16 v35, v169, v169, v35
    v_dot2_f32_bf16 v36, v170, v170, v36
    v_dot2_f32_bf16 v37, v171, v171, v37
    v_dot2_f32_bf16 v34, v172, v172, v34
    v_dot2_f32_bf16 v35, v173, v173, v35
    v_dot2_f32_bf16 v36, v174, v174, v36
    v_dot2_f32_bf16 v37, v175, v175, v37
    v_mfma_f32_32x32x16_bf16 v[96:111], a[176:179], a[104:107], v[96:111]
    s_waitcnt vmcnt(15)
    s_barrier
    ds_read_b64_tr_b16 a[168:169], v12 offset:16384
    ds_read_b64_tr_b16 a[170:171], v12 offset:16896
    ds_read_b128 a[120:123], v94 offset:16384
    v_mfma_f32_32x32x16_bf16 v[112:127], a[180:183], a[104:107], v[112:127]
    ds_read_b64_tr_b16 a[172:173], v13 offset:16384
    ds_read_b64_tr_b16 a[174:175], v13 offset:16896
    global_load_lds_dwordx4 v87, s[44:45] offset:3072
    v_add_u32 v55, s99, v53
    v_mfma_f32_32x32x16_bf16 v[128:143], a[184:187], a[104:107], v[128:143]
    s_mov_b32 m0, s50
    s_add_u32 s98, s3, 3
    s_and_b32 s98, s98, 3
    s_mul_i32 s99, s98, 49152
    ds_read_b64_tr_b16 a[176:177], v12 offset:18432
    ds_read_b64_tr_b16 a[178:179], v12 offset:18944
    ds_read_b128 a[124:127], v95 offset:16384
    v_mfma_f32_32x32x16_bf16 v[144:159], a[188:191], a[104:107], v[144:159]
    s_waitcnt lgkmcnt(8)
    ds_read_b64_tr_b16 a[180:181], v13 offset:18432
    ds_read_b64_tr_b16 a[182:183], v13 offset:18944
    global_load_lds_dwordx4 v8, s[12:13] offset:0
    v_add_u32 v56, s99, v53
    v_mfma_f32_32x32x16_bf16 v[96:111], a[192:195], a[108:111], v[96:111]
    s_add_u32 s98, s3, 4
    s_and_b32 s98, s98, 3
    s_mul_i32 s99, s98, 49152
    ds_read_b64_tr_b16 a[184:185], v14 offset:16384
    ds_read_b64_tr_b16 a[186:187], v14 offset:16896
    v_add_u32 v57, s99, v53
    v_mfma_f32_32x32x16_bf16 v[112:127], a[196:199], a[108:111], v[112:127]
    s_lshl_b32 s98, s87, 2
    s_add_u32 s98, s98, 0
    s_mul_i32 s99, s98, 52
    s_lshr_b32 s99, s99, 8
    ds_read_b64_tr_b16 a[188:189], v15 offset:16384
    ds_read_b64_tr_b16 a[190:191], v15 offset:16896
    global_load_lds_dwordx4 v9, s[12:13] offset:1024
    v_mfma_f32_32x32x16_bf16 v[128:143], a[160:163], a[108:111], v[128:143]
    s_mul_i32 s99, s99, 355
    s_add_u32 s98, s98, s99
    s_mul_i32 s99, s86, 5
    s_add_u32 s98, s98, s99
    s_lshl_b32 s98, s98, 10
    ds_read_b64_tr_b16 a[192:193], v14 offset:18432
    ds_read_b64_tr_b16 a[194:195], v14 offset:18944
    v_mfma_f32_32x32x16_bf16 v[144:159], a[164:167], a[108:111], v[144:159]
    s_waitcnt lgkmcnt(6)
    s_add_u32 s72, s98, 17825792
    s_lshl_b32 s98, s87, 2
    s_add_u32 s98, s98, 1
    ds_read_b64_tr_b16 a[196:197], v15 offset:18432
    ds_read_b64_tr_b16 a[198:199], v15 offset:18944
    global_load_lds_dwordx4 v8, s[14:15] offset:2048
    v_mfma_f32_32x32x16_bf16 v[96:111], a[168:171], a[112:115], v[96:111]
    s_mul_i32 s99, s98, 52
    s_lshr_b32 s99, s99, 8
    s_mul_i32 s99, s99, 355
    s_add_u32 s98, s98, s99
    s_mul_i32 s99, s86, 5
    ds_read_b64_tr_b16 a[160:161], v6 offset:16384
    ds_read_b64_tr_b16 a[162:163], v6 offset:16896
    v_mfma_f32_32x32x16_bf16 v[112:127], a[172:175], a[112:115], v[112:127]
    s_add_u32 s98, s98, s99
    s_lshl_b32 s98, s98, 10
    s_add_u32 s73, s98, 17825792
    s_lshl_b32 s98, s87, 2
    s_add_u32 s98, s98, 2
    s_mul_i32 s99, s98, 52
    ds_read_b64_tr_b16 a[164:165], v7 offset:16384
    ds_read_b64_tr_b16 a[166:167], v7 offset:16896
    global_load_lds_dwordx4 v9, s[14:15] offset:3072
    v_smfmac_f32_16x16x64_bf16 a[216:219], a[242:245], a[168:175], v17
    v_mfma_f32_32x32x16_bf16 v[128:143], a[176:179], a[112:115], v[128:143]
    s_waitcnt vmcnt(14)
    s_mov_b32 m0, s51
    s_lshr_b32 s99, s99, 8
    ds_read_b64_tr_b16 a[168:169], v6 offset:18432
    ds_read_b64_tr_b16 a[170:171], v6 offset:18944
    ds_read_b128 v[160:163], v92 offset:0
    ds_read_b128 v[164:167], v93 offset:0
    v_mfma_f32_32x32x16_bf16 v[144:159], a[180:183], a[112:115], v[144:159]
    s_waitcnt lgkmcnt(8)
    s_mul_i32 s99, s99, 355
    s_add_u32 s98, s98, s99
    s_mul_i32 s99, s86, 5
    s_add_u32 s98, s98, s99
    ds_read_b64_tr_b16 a[172:173], v7 offset:18432
    ds_read_b64_tr_b16 a[174:175], v7 offset:18944
    ds_read_b128 v[168:171], v94 offset:0
    ds_read_b128 v[172:175], v95 offset:0
    v_smfmac_f32_16x16x64_bf16 a[220:223], a[242:245], a[176:183], v17
    v_mfma_f32_32x32x16_bf16 v[96:111], a[184:187], a[116:119], v[96:111]
    s_lshl_b32 s98, s98, 10
    s_add_u32 s79, s98, 17825792
    s_lshl_b32 s98, s87, 2
    ds_read_b64_tr_b16 a[176:177], v2 offset:16384
    ds_read_b64_tr_b16 a[178:179], v2 offset:16896
    ds_read_b128 a[128:131], v92 offset:0
    global_load_lds_dwordx4 v4, s[16:17] offset:0
    v_mfma_f32_32x32x16_bf16 v[112:127], a[188:191], a[116:119], v[112:127]
    s_add_u32 s98, s98, 3
    s_mul_i32 s99, s98, 52
    s_lshr_b32 s99, s99, 8
    s_mul_i32 s99, s99, 355
    s_add_u32 s98, s98, s99
    ds_read_b64_tr_b16 a[180:181], v3 offset:16384
    ds_read_b64_tr_b16 a[182:183], v3 offset:16896
    v_mfma_f32_32x32x16_bf16 v[128:143], a[192:195], a[116:119], v[128:143]
    s_mul_i32 s99, s86, 5
    s_add_u32 s98, s98, s99
    s_lshl_b32 s98, s98, 10
    s_add_u32 s55, s98, 17825792
    ds_read_b64_tr_b16 a[184:185], v2 offset:18432
    ds_read_b64_tr_b16 a[186:187], v2 offset:18944
    ds_read_b128 a[132:135], v93 offset:0
    v_mfma_f32_32x32x16_bf16 v[144:159], a[196:199], a[116:119], v[144:159]
    s_waitcnt lgkmcnt(10)
    ds_read_b64_tr_b16 a[188:189], v3 offset:18432
    ds_read_b64_tr_b16 a[190:191], v3 offset:18944
    global_load_lds_dwordx4 v5, s[16:17] offset:1024
    s_waitcnt lgkmcnt(10)
    v_smfmac_f32_16x16x64_bf16 a[250:253], a[242:245], v[160:167], v17
    v_smfmac_f32_16x16x64_bf16 a[250:253], a[242:245], v[168:175], v17
    v_dot2_f32_bf16 v34, v160, v160, v34
    v_dot2_f32_bf16 v35, v161, v161, v35
    v_dot2_f32_bf16 v36, v162, v162, v36
    v_dot2_f32_bf16 v37, v163, v163, v37
    v_dot2_f32_bf16 v34, v164, v164, v34
    v_dot2_f32_bf16 v35, v165, v165, v35
    v_dot2_f32_bf16 v36, v166, v166, v36
    v_dot2_f32_bf16 v37, v167, v167, v37
    v_dot2_f32_bf16 v34, v168, v168, v34
    v_dot2_f32_bf16 v35, v169, v169, v35
    v_dot2_f32_bf16 v36, v170, v170, v36
    v_dot2_f32_bf16 v37, v171, v171, v37
    v_dot2_f32_bf16 v34, v172, v172, v34
    v_dot2_f32_bf16 v35, v173, v173, v35
    v_dot2_f32_bf16 v36, v174, v174, v36
    v_dot2_f32_bf16 v37, v175, v175, v37
    v_mfma_f32_32x32x16_bf16 v[96:111], a[160:163], a[120:123], v[96:111]
    s_waitcnt vmcnt(12)
    s_barrier
    ds_read_b64_tr_b16 a[192:193], v12 offset:32768
    ds_read_b64_tr_b16 a[194:195], v12 offset:33280
    ds_read_b128 a[136:139], v94 offset:0
    v_mfma_f32_32x32x16_bf16 v[112:127], a[164:167], a[120:123], v[112:127]
    s_mul_i32 s45, s3, 40960
    ds_read_b64_tr_b16 a[196:197], v13 offset:32768
    ds_read_b64_tr_b16 a[198:199], v13 offset:33280
    buffer_store_dwordx4 v[80:83], v25, s[24:27], 0 offen sc1
    v_mfma_f32_32x32x16_bf16 v[128:143], a[168:171], a[120:123], v[128:143]
    s_mul_i32 s98, s82, 368640
    ds_read_b64_tr_b16 a[160:161], v12 offset:34816
    ds_read_b64_tr_b16 a[162:163], v12 offset:35328
    ds_read_b128 a[140:143], v95 offset:0
    global_load_lds_dwordx4 v4, s[18:19] offset:2048
    v_accvgpr_write_b32 a212, 0
    v_accvgpr_write_b32 a213, 0
    v_mfma_f32_32x32x16_bf16 v[144:159], a[172:175], a[120:123], v[144:159]
    s_waitcnt lgkmcnt(8)
    ds_read_b64_tr_b16 a[164:165], v13 offset:34816
    ds_read_b64_tr_b16 a[166:167], v13 offset:35328
    v_accvgpr_write_b32 a214, 0
    v_accvgpr_write_b32 a215, 0
    v_mfma_f32_32x32x16_bf16 v[96:111], a[176:179], a[124:127], v[96:111]
    s_mul_i32 s99, s3, 61440
    ds_read_b64_tr_b16 a[168:169], v14 offset:32768
    ds_read_b64_tr_b16 a[170:171], v14 offset:33280
    v_mfma_f32_32x32x16_bf16 v[112:127], a[180:183], a[124:127], v[112:127]
    s_add_u32 s74, s98, s99
    ds_read_b64_tr_b16 a[172:173], v15 offset:32768
    ds_read_b64_tr_b16 a[174:175], v15 offset:33280
    global_load_lds_dwordx4 v5, s[18:19] offset:3072
    v_add_u32 v4, 393216, v4
    v_add_u32 v5, 393216, v5
    v_mfma_f32_32x32x16_bf16 v[128:143], a[184:187], a[124:127], v[128:143]
    s_mov_b32 m0, s52
    ds_read_b64_tr_b16 a[176:177], v14 offset:34816
    ds_read_b64_tr_b16 a[178:179], v14 offset:35328
    v_mfma_f32_32x32x16_bf16 v[144:159], a[188:191], a[124:127], v[144:159]
    s_waitcnt lgkmcnt(6)
    ds_read_b64_tr_b16 a[180:181], v15 offset:34816
    ds_read_b64_tr_b16 a[182:183], v15 offset:35328
    v_mfma_f32_32x32x16_bf16 v[96:111], a[192:195], a[128:131], v[96:111]
    s_add_u32 s74, s74, 17825792
    ds_read_b64_tr_b16 a[184:185], v6 offset:32768
    ds_read_b64_tr_b16 a[186:187], v6 offset:33280
    global_load_lds_dwordx4 v4, s[16:17] offset:0
    v_mfma_f32_32x32x16_bf16 v[112:127], a[196:199], a[128:131], v[112:127]
    s_mul_i32 s99, s3, 25600
    ds_read_b64_tr_b16 a[188:189], v7 offset:32768
    ds_read_b64_tr_b16 a[190:191], v7 offset:33280
    v_smfmac_f32_16x16x64_bf16 a[216:219], a[242:245], a[192:199], v17
    v_mfma_f32_32x32x16_bf16 v[128:143], a[160:163], a[128:131], v[128:143]
    s_waitcnt vmcnt(10)
    ds_read_b64_tr_b16 a[192:193], v6 offset:34816
    ds_read_b64_tr_b16 a[194:195], v6 offset:35328
    ds_read_b128 v[160:163], v92 offset:32768
    ds_read_b128 v[164:167], v93 offset:32768
    v_mfma_f32_32x32x16_bf16 v[144:159], a[164:167], a[128:131], v[144:159]
    s_waitcnt lgkmcnt(8)
    ds_read_b64_tr_b16 a[196:197], v7 offset:34816
    ds_read_b64_tr_b16 a[198:199], v7 offset:35328
    ds_read_b128 v[168:171], v94 offset:32768
    ds_read_b128 v[172:175], v95 offset:32768
    global_load_lds_dwordx4 v5, s[16:17] offset:1024
    v_smfmac_f32_16x16x64_bf16 a[220:223], a[242:245], a[160:167], v17
    v_mfma_f32_32x32x16_bf16 v[96:111], a[168:171], a[132:135], v[96:111]
    s_add_u32 s80, s98, s99
    ds_read_b64_tr_b16 a[160:161], v2 offset:32768
    ds_read_b64_tr_b16 a[162:163], v2 offset:33280
    ds_read_b128 a[144:147], v92 offset:32768
    v_mfma_f32_32x32x16_bf16 v[112:127], a[172:175], a[132:135], v[112:127]
    s_add_u32 s80, s80, 18071552
    ds_read_b64_tr_b16 a[164:165], v3 offset:32768
    ds_read_b64_tr_b16 a[166:167], v3 offset:33280
    v_mfma_f32_32x32x16_bf16 v[128:143], a[176:179], a[132:135], v[128:143]
    s_mul_i32 s98, s81, 196608
    ds_read_b64_tr_b16 a[168:169], v2 offset:34816
    ds_read_b64_tr_b16 a[170:171], v2 offset:35328
    ds_read_b128 a[148:151], v93 offset:32768
    global_load_lds_dwordx4 v4, s[18:19] offset:2048
    v_mfma_f32_32x32x16_bf16 v[144:159], a[180:183], a[132:135], v[144:159]
    s_waitcnt lgkmcnt(10)
    ds_read_b64_tr_b16 a[172:173], v3 offset:34816
    ds_read_b64_tr_b16 a[174:175], v3 offset:35328
    s_waitcnt lgkmcnt(10)
    v_smfmac_f32_16x16x64_bf16 a[250:253], a[242:245], v[160:167], v17
    v_smfmac_f32_16x16x64_bf16 a[250:253], a[242:245], v[168:175], v17
    v_dot2_f32_bf16 v34, v160, v160, v34
    v_dot2_f32_bf16 v35, v161, v161, v35
    v_dot2_f32_bf16 v36, v162, v162, v36
    v_dot2_f32_bf16 v37, v163, v163, v37
    v_dot2_f32_bf16 v34, v164, v164, v34
    v_dot2_f32_bf16 v35, v165, v165, v35
    v_dot2_f32_bf16 v36, v166, v166, v36
    v_dot2_f32_bf16 v37, v167, v167, v37
    v_dot2_f32_bf16 v34, v168, v168, v34
    v_dot2_f32_bf16 v35, v169, v169, v35
    v_dot2_f32_bf16 v36, v170, v170, v36
    v_dot2_f32_bf16 v37, v171, v171, v37
    v_dot2_f32_bf16 v34, v172, v172, v34
    v_dot2_f32_bf16 v35, v173, v173, v35
    v_dot2_f32_bf16 v36, v174, v174, v36
    v_dot2_f32_bf16 v37, v175, v175, v37
    v_mfma_f32_32x32x16_bf16 v[96:111], a[184:187], a[136:139], v[96:111]
    s_waitcnt vmcnt(8)
    s_barrier
    ds_read_b64_tr_b16 a[176:177], v12 offset:49152
    ds_read_b64_tr_b16 a[178:179], v12 offset:49664
    ds_read_b128 a[152:155], v94 offset:32768
    v_mfma_f32_32x32x16_bf16 v[112:127], a[188:191], a[136:139], v[112:127]
    s_mul_i32 s99, s3, 12288
    ds_read_b64_tr_b16 a[180:181], v13 offset:49152
    ds_read_b64_tr_b16 a[182:183], v13 offset:49664
    global_load_lds_dwordx4 v5, s[18:19] offset:3072
    v_add_u32 v4, 393216, v4
    v_add_u32 v5, 393216, v5
    v_accvgpr_read_b32 v26, a250
    v_mfma_f32_32x32x16_bf16 v[128:143], a[192:195], a[136:139], v[128:143]
    s_mov_b32 m0, s62
    ds_read_b64_tr_b16 a[184:185], v12 offset:51200
    ds_read_b64_tr_b16 a[186:187], v12 offset:51712
    ds_read_b128 a[156:159], v95 offset:32768
    v_accvgpr_read_b32 v27, a251
    v_add_f32 v34, v34, v35
    v_add_f32 v36, v36, v37
    v_mfma_f32_32x32x16_bf16 v[144:159], a[196:199], a[136:139], v[144:159]
    s_waitcnt lgkmcnt(8)
    ds_read_b64_tr_b16 a[188:189], v13 offset:51200
    ds_read_b64_tr_b16 a[190:191], v13 offset:51712
    v_add_f32 v26, v26, v27
    v_add_f32 v36, v36, v34
    v_mov_b32 v27, v26
    v_mov_b32 v37, v36
    v_mfma_f32_32x32x16_bf16 v[96:111], a[160:163], a[140:143], v[96:111]
    s_add_u32 s75, s98, s99
    ds_read_b64_tr_b16 a[192:193], v14 offset:49152
    ds_read_b64_tr_b16 a[194:195], v14 offset:49664
    global_load_lds_dwordx4 v4, s[16:17] offset:0
    v_cmp_gt_u32 vcc, 32, v1
    v_permlane32_swap_b32 v26, v27
    v_mfma_f32_32x32x16_bf16 v[112:127], a[164:167], a[140:143], v[112:127]
    s_add_u32 s75, s75, 11534336
    ds_read_b64_tr_b16 a[196:197], v15 offset:49152
    ds_read_b64_tr_b16 a[198:199], v15 offset:49664
    v_permlane32_swap_b32 v36, v37
    v_add_f32 v26, v26, v27
    v_add_f32 v36, v36, v37
    v_mfma_f32_32x32x16_bf16 v[128:143], a[168:171], a[140:143], v[128:143]
    s_add_u32 s78, s95, 8192
    ds_read_b64_tr_b16 a[160:161], v14 offset:51200
    ds_read_b64_tr_b16 a[162:163], v14 offset:51712
    v_mul_f32 v26, 3133983949, v26
    v_mul_f32 v36, 986500301, v36
    v_fma_f32 v36, -v26, v26, v36
    v_cvt_pk_bf16_f32 v26, v26, v26
    v_mfma_f32_32x32x16_bf16 v[144:159], a[172:175], a[140:143], v[144:159]
    s_waitcnt lgkmcnt(6)
    ds_read_b64_tr_b16 a[164:165], v15 offset:51200
    ds_read_b64_tr_b16 a[166:167], v15 offset:51712
    global_load_lds_dwordx4 v5, s[16:17] offset:1024
    v_max_f32 v36, 0, v36
    v_cndmask_b32 v26, 0, v26, vcc
    v_smfmac_f32_16x16x64_bf16 a[216:219], a[242:245], a[176:183], v17
    v_cvt_pk_bf16_f32 v36, v36, v36
    v_accvgpr_write_b32 a246, v26
    v_accvgpr_write_b32 a247, v26
    v_mfma_f32_32x32x16_bf16 v[96:111], a[176:179], a[144:147], v[96:111]
    s_add_u32 s98, s3, 1
    ds_read_b64_tr_b16 a[168:169], v6 offset:49152
    ds_read_b64_tr_b16 a[170:171], v6 offset:49664
    v_accvgpr_write_b32 a248, v26
    v_accvgpr_write_b32 a249, v26
    v_and_b32 v36, 0xffff0000, v36
    v_smfmac_f32_16x16x64_bf16 a[220:223], a[242:245], a[184:191], v17
    v_add_f32 v36, 925353388, v36
    v_cvt_pk_bf16_f32 v36, v36, v36
    v_lshlrev_b32 v36, 16, v36
    v_mfma_f32_32x32x16_bf16 v[112:127], a[180:183], a[144:147], v[112:127]
    s_and_b32 s98, s98, 3
    ds_read_b64_tr_b16 a[172:173], v7 offset:49152
    ds_read_b64_tr_b16 a[174:175], v7 offset:49664
    v_sqrt_f32 v36, v36
    v_mov_b32 v37, 0
    v_cvt_pk_bf16_f32 v36, v36, v36
    v_mfma_f32_32x32x16_bf16 v[128:143], a[184:187], a[144:147], v[128:143]
    s_lshl_b32 s98, s98, 8
    ds_read_b64_tr_b16 a[176:177], v6 offset:51200
    ds_read_b64_tr_b16 a[178:179], v6 offset:51712
    global_load_lds_dwordx4 v4, s[18:19] offset:2048
    v_accvgpr_read_b32 v68, a216
    v_accvgpr_read_b32 v69, a217
    v_add_f32 v68, v68, v69
    v_mfma_f32_32x32x16_bf16 v[144:159], a[188:191], a[144:147], v[144:159]
    s_waitcnt lgkmcnt(6)
    ds_read_b64_tr_b16 a[180:181], v7 offset:51200
    ds_read_b64_tr_b16 a[182:183], v7 offset:51712
    v_cvt_pk_bf16_f32 v69, v68, v68
    v_and_b32 v69, 0xffff0000, v69
    v_sub_f32 v68, v68, v69
    v_cvt_pk_bf16_f32 v68, v69, v68
    v_mfma_f32_32x32x16_bf16 v[96:111], a[192:195], a[148:151], v[96:111]
    s_add_u32 s12, s76, s98
    ds_read_b64_tr_b16 a[184:185], v2 offset:49152
    ds_read_b64_tr_b16 a[186:187], v2 offset:49664
    v_accvgpr_read_b32 v70, a220
    v_accvgpr_read_b32 v71, a221
    v_add_f32 v70, v70, v71
    v_cvt_pk_bf16_f32 v71, v70, v70
    v_mfma_f32_32x32x16_bf16 v[112:127], a[196:199], a[148:151], v[112:127]
    s_add_u32 s98, s3, 2
    ds_read_b64_tr_b16 a[188:189], v3 offset:49152
    ds_read_b64_tr_b16 a[190:191], v3 offset:49664
    global_load_lds_dwordx4 v5, s[18:19] offset:3072
    v_add_u32 v4, 393216, v4
    v_add_u32 v5, 393216, v5
    v_and_b32 v71, 0xffff0000, v71
    v_mfma_f32_32x32x16_bf16 v[128:143], a[160:163], a[148:151], v[128:143]
    s_mov_b32 m0, s63
    ds_read_b64_tr_b16 a[192:193], v2 offset:51200
    ds_read_b64_tr_b16 a[194:195], v2 offset:51712
    v_sub_f32 v70, v70, v71
    v_cvt_pk_bf16_f32 v70, v71, v70
    ds_write_b32 v0, v68 offset:1024
    ds_write_b32 v0, v70 offset:2048
    v_mfma_f32_32x32x16_bf16 v[144:159], a[164:167], a[148:151], v[144:159]
    s_waitcnt lgkmcnt(8)
    ds_read_b64_tr_b16 a[196:197], v3 offset:51200
    ds_read_b64_tr_b16 a[198:199], v3 offset:51712
    v_lshlrev_b32 v28, 16, v36
    v_rcp_f32 v27, v28
    s_nop 0
    v_mul_f32 v29, 3216550459, v27
    v_mfma_f32_32x32x16_bf16 v[96:111], a[168:171], a[152:155], v[96:111]
    s_waitcnt lgkmcnt(2)
    s_waitcnt vmcnt(8)
    s_barrier
    ds_read_b64_tr_b16 a[160:161], v40 offset:0
    ds_read_b64_tr_b16 a[162:163], v40 offset:256
    v_mfma_f32_32x32x16_bf16 v[112:127], a[172:175], a[152:155], v[112:127]
    ds_read_b64_tr_b16 a[164:165], v40 offset:2048
    ds_read_b64_tr_b16 a[166:167], v40 offset:2304
    global_load_lds_dwordx4 v4, s[16:17] offset:0
    ds_read_b128 a[224:227], v39 offset:1024
    ds_read_b128 a[228:231], v39 offset:1536
    ds_read_b128 a[232:235], v39 offset:2048
    ds_read_b128 a[236:239], v39 offset:2560
    v_mfma_f32_32x32x16_bf16 v[128:143], a[176:179], a[152:155], v[128:143]
    s_and_b32 s98, s98, 3
    ds_read_b64_tr_b16 a[168:169], v41 offset:0
    ds_read_b64_tr_b16 a[170:171], v41 offset:256
    v_mul_f32 v30, s61, v27
    v_mfma_f32_32x32x16_bf16 v[144:159], a[180:183], a[152:155], v[144:159]
    s_waitcnt lgkmcnt(10)
    ds_read_b64_tr_b16 a[172:173], v41 offset:2048
    ds_read_b64_tr_b16 a[174:175], v41 offset:2304
    buffer_load_dword v33, v37, s[32:35], 0 offen sc1
    v_mfma_f32_32x32x16_bf16 v[96:111], a[184:187], a[156:159], v[96:111]
    s_lshl_b32 s98, s98, 8
    ds_read_b64_tr_b16 a[176:177], v42 offset:0
    ds_read_b64_tr_b16 a[178:179], v42 offset:256
    global_load_lds_dwordx4 v5, s[16:17] offset:1024
    v_mfma_f32_32x32x16_bf16 v[112:127], a[188:191], a[156:159], v[112:127]
    s_add_u32 s13, s76, s98
    ds_read_b64_tr_b16 a[180:181], v42 offset:2048
    ds_read_b64_tr_b16 a[182:183], v42 offset:2304
    s_waitcnt lgkmcnt(11)
    v_mfma_f32_32x32x16_bf16 v[96:111], a[224:227], a[246:249], v[96:111]
    v_mfma_f32_32x32x16_bf16 v[128:143], a[192:195], a[156:159], v[128:143]
    s_add_u32 s98, s3, 3
    ds_read_b64_tr_b16 a[184:185], v43 offset:0
    ds_read_b64_tr_b16 a[186:187], v43 offset:256
    s_waitcnt lgkmcnt(12)
    v_mfma_f32_32x32x16_bf16 v[112:127], a[228:231], a[246:249], v[112:127]
    v_mfma_f32_32x32x16_bf16 v[144:159], a[196:199], a[156:159], v[144:159]
    s_waitcnt lgkmcnt(6)
    s_and_b32 s98, s98, 3
    s_lshl_b32 s98, s98, 8
    s_add_u32 s14, s76, s98
    s_add_u32 s98, s3, 4
    s_and_b32 s98, s98, 3
    s_lshl_b32 s98, s98, 8
    s_add_u32 s15, s76, s98
    ds_read_b64_tr_b16 a[188:189], v43 offset:2048
    ds_read_b64_tr_b16 a[190:191], v43 offset:2304
    global_load_lds_dwordx4 v4, s[18:19] offset:2048
    s_waitcnt lgkmcnt(13)
    v_mfma_f32_32x32x16_bf16 v[128:143], a[232:235], a[246:249], v[128:143]
    v_mfma_f32_32x32x16_bf16 v[160:175], a[160:163], a[0:3], 0
    ds_read_b64_tr_b16 a[192:193], v40 offset:8192
    ds_read_b64_tr_b16 a[194:195], v40 offset:8448
    s_waitcnt lgkmcnt(14)
    v_mfma_f32_32x32x16_bf16 v[144:159], a[236:239], a[246:249], v[144:159]
    v_mfma_f32_32x32x16_bf16 v[176:191], a[164:167], a[0:3], 0
    ds_read_b64_tr_b16 a[196:197], v40 offset:10240
    ds_read_b64_tr_b16 a[198:199], v40 offset:10496
    v_mul_f32 v64, v30, v96
    v_mul_f32 v65, v30, v97
    v_mul_f32 v66, v30, v98
    v_smfmac_f32_16x16x64_bf16 a[212:215], a[242:245], a[160:167], v17
    v_mul_f32 v67, v30, v99
    v_mul_f32 v68, v30, v100
    v_mul_f32 v69, v30, v101
    v_mfma_f32_32x32x16_bf16 v[160:175], a[168:171], a[4:7], v[160:175]
    ds_read_b64_tr_b16 a[160:161], v41 offset:8192
    ds_read_b64_tr_b16 a[162:163], v41 offset:8448
    global_load_lds_dwordx4 v5, s[18:19] offset:3072
    v_add_u32 v4, 393216, v4
    v_add_u32 v5, 393216, v5
    v_mul_f32 v70, v30, v102
    v_mfma_f32_32x32x16_bf16 v[176:191], a[172:175], a[4:7], v[176:191]
    s_waitcnt lgkmcnt(6)
    s_mov_b32 m0, s47
    ds_read_b64_tr_b16 a[164:165], v41 offset:10240
    ds_read_b64_tr_b16 a[166:167], v41 offset:10496
    v_mul_f32 v71, v30, v103
    v_cvt_pk_bf16_f32 v96, v64, v65
    v_cvt_pk_bf16_f32 v98, v68, v69
    v_mfma_f32_32x32x16_bf16 v[160:175], a[176:179], a[8:11], v[160:175]
    ds_read_b64_tr_b16 a[168:169], v42 offset:8192
    ds_read_b64_tr_b16 a[170:171], v42 offset:8448
    v_cvt_pk_bf16_f32 v97, v66, v67
    v_cvt_pk_bf16_f32 v99, v70, v71
    v_permlane32_swap_b32 v96, v98
    v_mfma_f32_32x32x16_bf16 v[176:191], a[180:183], a[8:11], v[176:191]
    ds_read_b64_tr_b16 a[172:173], v42 offset:10240
    ds_read_b64_tr_b16 a[174:175], v42 offset:10496
    global_load_lds_dwordx4 v4, s[16:17] offset:0
    v_permlane32_swap_b32 v97, v99
    v_mul_f32 v72, v30, v104
    v_mfma_f32_32x32x16_bf16 v[160:175], a[184:187], a[12:15], v[160:175]
    s_add_u32 s6, s56, 0
    ds_read_b64_tr_b16 a[176:177], v43 offset:8192
    ds_read_b64_tr_b16 a[178:179], v43 offset:8448
    buffer_store_dwordx4 v[96:99], v16, s[24:27], s6 offen sc1
    v_mfma_f32_32x32x16_bf16 v[176:191], a[188:191], a[12:15], v[176:191]
    s_waitcnt lgkmcnt(6)
    ds_read_b64_tr_b16 a[180:181], v43 offset:10240
    ds_read_b64_tr_b16 a[182:183], v43 offset:10496
    v_mul_f32 v73, v30, v105
    v_mul_f32 v74, v30, v106
    v_mul_f32 v75, v30, v107
    v_mul_f32 v76, v30, v108
    v_mfma_f32_32x32x16_bf16 v[160:175], a[192:195], a[16:19], v[160:175]
    s_waitcnt vmcnt(11)
    s_barrier
    ds_read_b64_tr_b16 a[184:185], v40 offset:16384
    ds_read_b64_tr_b16 a[186:187], v40 offset:16640
    v_mfma_f32_32x32x16_bf16 v[176:191], a[196:199], a[16:19], v[176:191]
    ds_read_b64_tr_b16 a[188:189], v40 offset:18432
    ds_read_b64_tr_b16 a[190:191], v40 offset:18688
    global_load_lds_dwordx4 v5, s[16:17] offset:1024
    v_mul_f32 v77, v30, v109
    v_mul_f32 v78, v30, v110
    v_smfmac_f32_16x16x64_bf16 a[212:215], a[242:245], a[192:199], v17
    v_mul_f32 v79, v30, v111
    v_cvt_pk_bf16_f32 v104, v72, v73
    v_cvt_pk_bf16_f32 v106, v76, v77
    v_mfma_f32_32x32x16_bf16 v[160:175], a[160:163], a[20:23], v[160:175]
    ds_read_b64_tr_b16 a[192:193], v41 offset:16384
    ds_read_b64_tr_b16 a[194:195], v41 offset:16640
    v_cvt_pk_bf16_f32 v105, v74, v75
    v_cvt_pk_bf16_f32 v107, v78, v79
    v_permlane32_swap_b32 v104, v106
    v_mfma_f32_32x32x16_bf16 v[176:191], a[164:167], a[20:23], v[176:191]
    s_waitcnt lgkmcnt(6)
    ds_read_b64_tr_b16 a[196:197], v41 offset:18432
    ds_read_b64_tr_b16 a[198:199], v41 offset:18688
    v_permlane32_swap_b32 v105, v107
    v_mul_f32 v64, v30, v112
    v_mul_f32 v65, v30, v113
    v_mfma_f32_32x32x16_bf16 v[160:175], a[168:171], a[24:27], v[160:175]
    ds_read_b64_tr_b16 a[160:161], v42 offset:16384
    ds_read_b64_tr_b16 a[162:163], v42 offset:16640
    global_load_lds_dwordx4 v4, s[18:19] offset:2048
    v_mul_f32 v66, v30, v114
    v_mul_f32 v67, v30, v115
    v_mul_f32 v68, v30, v116
    v_mfma_f32_32x32x16_bf16 v[176:191], a[172:175], a[24:27], v[176:191]
    ds_read_b64_tr_b16 a[164:165], v42 offset:18432
    ds_read_b64_tr_b16 a[166:167], v42 offset:18688
    v_mul_f32 v69, v30, v117
    v_mul_f32 v70, v30, v118
    v_mul_f32 v71, v30, v119
    v_cvt_pk_bf16_f32 v112, v64, v65
    v_mfma_f32_32x32x16_bf16 v[160:175], a[176:179], a[28:31], v[160:175]
    s_add_u32 s7, s56, 65536
    ds_read_b64_tr_b16 a[168:169], v43 offset:16384
    ds_read_b64_tr_b16 a[170:171], v43 offset:16640
    buffer_store_dwordx4 v[104:107], v16, s[24:27], s7 offen sc1
    v_mfma_f32_32x32x16_bf16 v[176:191], a[180:183], a[28:31], v[176:191]
    s_waitcnt lgkmcnt(6)
    ds_read_b64_tr_b16 a[172:173], v43 offset:18432
    ds_read_b64_tr_b16 a[174:175], v43 offset:18688
    global_load_lds_dwordx4 v5, s[18:19] offset:3072
    v_cvt_pk_bf16_f32 v114, v68, v69
    v_cvt_pk_bf16_f32 v113, v66, v67
    v_cvt_pk_bf16_f32 v115, v70, v71
    v_mfma_f32_32x32x16_bf16 v[160:175], a[184:187], a[32:35], v[160:175]
    s_mov_b32 m0, s48
    ds_read_b64_tr_b16 a[176:177], v40 offset:24576
    ds_read_b64_tr_b16 a[178:179], v40 offset:24832
    v_permlane32_swap_b32 v112, v114
    v_permlane32_swap_b32 v113, v115
    v_mfma_f32_32x32x16_bf16 v[176:191], a[188:191], a[32:35], v[176:191]
    ds_read_b64_tr_b16 a[180:181], v40 offset:26624
    ds_read_b64_tr_b16 a[182:183], v40 offset:26880
    v_mul_f32 v72, v30, v120
    v_mul_f32 v73, v30, v121
    v_mul_f32 v74, v30, v122
    v_smfmac_f32_16x16x64_bf16 a[212:215], a[242:245], a[184:191], v17
    v_mul_f32 v75, v30, v123
    v_mul_f32 v76, v30, v124
    v_mul_f32 v77, v30, v125
    v_mfma_f32_32x32x16_bf16 v[160:175], a[192:195], a[36:39], v[160:175]
    ds_read_b64_tr_b16 a[184:185], v41 offset:24576
    ds_read_b64_tr_b16 a[186:187], v41 offset:24832
    global_load_lds_dwordx4 v10, s[20:21] offset:0
    v_mul_f32 v78, v30, v126
    v_mul_f32 v79, v30, v127
    v_cvt_pk_bf16_f32 v120, v72, v73
    v_mfma_f32_32x32x16_bf16 v[176:191], a[196:199], a[36:39], v[176:191]
    s_waitcnt lgkmcnt(6)
    ds_read_b64_tr_b16 a[188:189], v41 offset:26624
    ds_read_b64_tr_b16 a[190:191], v41 offset:26880
    v_cvt_pk_bf16_f32 v122, v76, v77
    v_cvt_pk_bf16_f32 v121, v74, v75
    v_cvt_pk_bf16_f32 v123, v78, v79
    v_mfma_f32_32x32x16_bf16 v[160:175], a[160:163], a[40:43], v[160:175]
    ds_read_b64_tr_b16 a[192:193], v42 offset:24576
    ds_read_b64_tr_b16 a[194:195], v42 offset:24832
    v_permlane32_swap_b32 v120, v122
    v_permlane32_swap_b32 v121, v123
    v_mfma_f32_32x32x16_bf16 v[176:191], a[164:167], a[40:43], v[176:191]
    ds_read_b64_tr_b16 a[196:197], v42 offset:26624
    ds_read_b64_tr_b16 a[198:199], v42 offset:26880
    global_load_lds_dwordx4 v11, s[20:21] offset:1024
    v_mul_f32 v64, v30, v128
    v_mul_f32 v65, v30, v129
    v_mul_f32 v66, v30, v130
    v_mfma_f32_32x32x16_bf16 v[160:175], a[168:171], a[44:47], v[160:175]
    ds_read_b64_tr_b16 a[160:161], v43 offset:24576
    ds_read_b64_tr_b16 a[162:163], v43 offset:24832
    v_mul_f32 v67, v30, v131
    v_mul_f32 v68, v30, v132
    v_mul_f32 v69, v30, v133
    v_mul_f32 v70, v30, v134
    v_mfma_f32_32x32x16_bf16 v[176:191], a[172:175], a[44:47], v[176:191]
    s_waitcnt lgkmcnt(6)
    ds_read_b64_tr_b16 a[164:165], v43 offset:26624
    ds_read_b64_tr_b16 a[166:167], v43 offset:26880
    v_mul_f32 v71, v30, v135
    v_cvt_pk_bf16_f32 v128, v64, v65
    v_cvt_pk_bf16_f32 v130, v68, v69
    v_cvt_pk_bf16_f32 v129, v66, v67
    v_mfma_f32_32x32x16_bf16 v[160:175], a[176:179], a[48:51], v[160:175]
    s_waitcnt vmcnt(8)
    s_barrier
    ds_read_b64_tr_b16 a[168:169], v40 offset:32768
    ds_read_b64_tr_b16 a[170:171], v40 offset:33024
    v_mfma_f32_32x32x16_bf16 v[176:191], a[180:183], a[48:51], v[176:191]
    s_add_u32 s6, s56, 131072
    ds_read_b64_tr_b16 a[172:173], v40 offset:34816
    ds_read_b64_tr_b16 a[174:175], v40 offset:35072
    global_load_lds_dwordx4 v10, s[22:23] offset:2048
    buffer_store_dwordx4 v[112:115], v16, s[24:27], s6 offen sc1
    v_smfmac_f32_16x16x64_bf16 a[212:215], a[242:245], a[176:183], v17
    v_cvt_pk_bf16_f32 v131, v70, v71
    v_mfma_f32_32x32x16_bf16 v[160:175], a[184:187], a[52:55], v[160:175]
    ds_read_b64_tr_b16 a[176:177], v41 offset:32768
    ds_read_b64_tr_b16 a[178:179], v41 offset:33024
    v_permlane32_swap_b32 v128, v130
    v_permlane32_swap_b32 v129, v131
    v_mfma_f32_32x32x16_bf16 v[176:191], a[188:191], a[52:55], v[176:191]
    s_waitcnt lgkmcnt(6)
    ds_read_b64_tr_b16 a[180:181], v41 offset:34816
    ds_read_b64_tr_b16 a[182:183], v41 offset:35072
    v_mul_f32 v72, v30, v136
    v_mul_f32 v73, v30, v137
    v_mul_f32 v74, v30, v138
    v_mul_f32 v75, v30, v139
    v_mfma_f32_32x32x16_bf16 v[160:175], a[192:195], a[56:59], v[160:175]
    ds_read_b64_tr_b16 a[184:185], v42 offset:32768
    ds_read_b64_tr_b16 a[186:187], v42 offset:33024
    global_load_lds_dwordx4 v11, s[22:23] offset:3072
    v_add_u32 v10, 196608, v10
    v_add_u32 v11, 196608, v11
    v_mul_f32 v76, v30, v140
    v_mfma_f32_32x32x16_bf16 v[176:191], a[196:199], a[56:59], v[176:191]
    s_mov_b32 m0, s49
    ds_read_b64_tr_b16 a[188:189], v42 offset:34816
    ds_read_b64_tr_b16 a[190:191], v42 offset:35072
    v_mul_f32 v77, v30, v141
    v_mul_f32 v78, v30, v142
    v_mul_f32 v79, v30, v143
    v_cvt_pk_bf16_f32 v136, v72, v73
    v_mfma_f32_32x32x16_bf16 v[160:175], a[160:163], a[60:63], v[160:175]
    ds_read_b64_tr_b16 a[192:193], v43 offset:32768
    ds_read_b64_tr_b16 a[194:195], v43 offset:33024
    v_cvt_pk_bf16_f32 v138, v76, v77
    v_cvt_pk_bf16_f32 v137, v74, v75
    v_cvt_pk_bf16_f32 v139, v78, v79
    v_mfma_f32_32x32x16_bf16 v[176:191], a[164:167], a[60:63], v[176:191]
    s_waitcnt lgkmcnt(6)
    ds_read_b64_tr_b16 a[196:197], v43 offset:34816
    ds_read_b64_tr_b16 a[198:199], v43 offset:35072
    global_load_lds_dwordx4 v10, s[20:21] offset:0
    v_permlane32_swap_b32 v136, v138
    v_mfma_f32_32x32x16_bf16 v[160:175], a[168:171], a[64:67], v[160:175]
    ds_read_b64_tr_b16 a[160:161], v40 offset:40960
    ds_read_b64_tr_b16 a[162:163], v40 offset:41216
    v_permlane32_swap_b32 v137, v139
    v_mul_f32 v64, v30, v144
    v_mul_f32 v65, v30, v145
    v_mfma_f32_32x32x16_bf16 v[176:191], a[172:175], a[64:67], v[176:191]
    ds_read_b64_tr_b16 a[164:165], v40 offset:43008
    ds_read_b64_tr_b16 a[166:167], v40 offset:43264
    v_mul_f32 v66, v30, v146
    v_mul_f32 v67, v30, v147
    v_mul_f32 v68, v30, v148
    v_smfmac_f32_16x16x64_bf16 a[212:215], a[242:245], a[168:175], v17
    v_mul_f32 v69, v30, v149
    v_mul_f32 v70, v30, v150
    v_mul_f32 v71, v30, v151
    v_mfma_f32_32x32x16_bf16 v[160:175], a[176:179], a[68:71], v[160:175]
    s_add_u32 s7, s56, 196608
    ds_read_b64_tr_b16 a[168:169], v41 offset:40960
    ds_read_b64_tr_b16 a[170:171], v41 offset:41216
    global_load_lds_dwordx4 v11, s[20:21] offset:1024
    v_cvt_pk_bf16_f32 v144, v64, v65
    v_cvt_pk_bf16_f32 v146, v68, v69
    v_cvt_pk_bf16_f32 v145, v66, v67
    v_mfma_f32_32x32x16_bf16 v[176:191], a[180:183], a[68:71], v[176:191]
    s_waitcnt lgkmcnt(6)
    ds_read_b64_tr_b16 a[172:173], v41 offset:43008
    ds_read_b64_tr_b16 a[174:175], v41 offset:43264
    buffer_store_dwordx4 v[120:123], v16, s[24:27], s7 offen sc1
    v_mfma_f32_32x32x16_bf16 v[160:175], a[184:187], a[72:75], v[160:175]
    ds_read_b64_tr_b16 a[176:177], v42 offset:40960
    ds_read_b64_tr_b16 a[178:179], v42 offset:41216
    v_cvt_pk_bf16_f32 v147, v70, v71
    v_permlane32_swap_b32 v144, v146
    v_mfma_f32_32x32x16_bf16 v[176:191], a[188:191], a[72:75], v[176:191]
    ds_read_b64_tr_b16 a[180:181], v42 offset:43008
    ds_read_b64_tr_b16 a[182:183], v42 offset:43264
    global_load_lds_dwordx4 v10, s[22:23] offset:2048
    v_permlane32_swap_b32 v145, v147
    v_mul_f32 v72, v30, v152
    v_mfma_f32_32x32x16_bf16 v[160:175], a[192:195], a[76:79], v[160:175]
    ds_read_b64_tr_b16 a[184:185], v43 offset:40960
    ds_read_b64_tr_b16 a[186:187], v43 offset:41216
    v_mul_f32 v73, v30, v153
    v_mul_f32 v74, v30, v154
    v_mul_f32 v75, v30, v155
    v_mul_f32 v76, v30, v156
    v_mfma_f32_32x32x16_bf16 v[176:191], a[196:199], a[76:79], v[176:191]
    s_waitcnt lgkmcnt(6)
    ds_read_b64_tr_b16 a[188:189], v43 offset:43008
    ds_read_b64_tr_b16 a[190:191], v43 offset:43264
    v_mul_f32 v77, v30, v157
    v_mul_f32 v78, v30, v158
    v_mul_f32 v79, v30, v159
    v_cvt_pk_bf16_f32 v152, v72, v73
    v_mfma_f32_32x32x16_bf16 v[160:175], a[160:163], a[80:83], v[160:175]
    ds_read_b64_tr_b16 a[192:193], v40 offset:49152
    ds_read_b64_tr_b16 a[194:195], v40 offset:49408
    global_load_lds_dwordx4 v11, s[22:23] offset:3072
    v_add_u32 v10, 196608, v10
    v_add_u32 v11, 196608, v11
    v_cvt_pk_bf16_f32 v154, v76, v77
    v_mfma_f32_32x32x16_bf16 v[176:191], a[164:167], a[80:83], v[176:191]
    s_mov_b32 m0, s50
    ds_read_b64_tr_b16 a[196:197], v40 offset:51200
    ds_read_b64_tr_b16 a[198:199], v40 offset:51456
    v_cvt_pk_bf16_f32 v153, v74, v75
    v_cvt_pk_bf16_f32 v155, v78, v79
    v_permlane32_swap_b32 v152, v154
    v_smfmac_f32_16x16x64_bf16 a[212:215], a[242:245], a[160:167], v17
    v_permlane32_swap_b32 v153, v155
    v_mfma_f32_32x32x16_bf16 v[160:175], a[168:171], a[84:87], v[160:175]
    ds_read_b64_tr_b16 a[160:161], v41 offset:49152
    ds_read_b64_tr_b16 a[162:163], v41 offset:49408
    v_mov_b32 v100, 0
    v_mov_b32 v101, 0
    v_mov_b32 v102, 0
    v_mov_b32 v103, 0
    v_mfma_f32_32x32x16_bf16 v[176:191], a[172:175], a[84:87], v[176:191]
    s_waitcnt lgkmcnt(6)
    ds_read_b64_tr_b16 a[164:165], v41 offset:51200
    ds_read_b64_tr_b16 a[166:167], v41 offset:51456
    global_load_lds_dwordx4 v10, s[20:21] offset:0
    v_mov_b32 v108, 0
    v_mov_b32 v109, 0
    v_mov_b32 v110, 0
    v_mfma_f32_32x32x16_bf16 v[160:175], a[176:179], a[88:91], v[160:175]
    s_add_u32 s6, s57, 0
    ds_read_b64_tr_b16 a[168:169], v42 offset:49152
    ds_read_b64_tr_b16 a[170:171], v42 offset:49408
    buffer_store_dwordx4 v[128:131], v16, s[24:27], s6 offen sc1
    v_mfma_f32_32x32x16_bf16 v[176:191], a[180:183], a[88:91], v[176:191]
    ds_read_b64_tr_b16 a[172:173], v42 offset:51200
    ds_read_b64_tr_b16 a[174:175], v42 offset:51456
    v_mov_b32 v111, 0
    v_mfma_f32_32x32x16_bf16 v[160:175], a[184:187], a[92:95], v[160:175]
    ds_read_b64_tr_b16 a[176:177], v43 offset:49152
    ds_read_b64_tr_b16 a[178:179], v43 offset:49408
    global_load_lds_dwordx4 v11, s[20:21] offset:1024
    v_mfma_f32_32x32x16_bf16 v[176:191], a[188:191], a[92:95], v[176:191]
    s_waitcnt lgkmcnt(6)
    ds_read_b64_tr_b16 a[180:181], v43 offset:51200
    ds_read_b64_tr_b16 a[182:183], v43 offset:51456
    v_mfma_f32_32x32x16_bf16 v[160:175], a[192:195], a[96:99], v[160:175]
    ds_read_b64_tr_b16 a[184:185], v40 offset:57344
    ds_read_b64_tr_b16 a[186:187], v40 offset:57600
    v_mfma_f32_32x32x16_bf16 v[176:191], a[196:199], a[96:99], v[176:191]
    ds_read_b64_tr_b16 a[188:189], v40 offset:59392
    ds_read_b64_tr_b16 a[190:191], v40 offset:59648
    global_load_lds_dwordx4 v10, s[22:23] offset:2048
    v_xor_b32 v40, 0x10000, v40
    v_smfmac_f32_16x16x64_bf16 a[212:215], a[242:245], a[192:199], v17
    v_mfma_f32_32x32x16_bf16 v[160:175], a[160:163], a[100:103], v[160:175]
    ds_read_b64_tr_b16 a[192:193], v41 offset:57344
    ds_read_b64_tr_b16 a[194:195], v41 offset:57600
    v_mfma_f32_32x32x16_bf16 v[176:191], a[164:167], a[100:103], v[176:191]
    s_waitcnt lgkmcnt(6)
    ds_read_b64_tr_b16 a[196:197], v41 offset:59392
    ds_read_b64_tr_b16 a[198:199], v41 offset:59648
    v_xor_b32 v41, 0x10000, v41
    v_mfma_f32_32x32x16_bf16 v[160:175], a[168:171], a[104:107], v[160:175]
    ds_read_b64_tr_b16 a[160:161], v42 offset:57344
    ds_read_b64_tr_b16 a[162:163], v42 offset:57600
    global_load_lds_dwordx4 v11, s[22:23] offset:3072
    v_add_u32 v10, 196608, v10
    v_add_u32 v11, 196608, v11
    v_mfma_f32_32x32x16_bf16 v[176:191], a[172:175], a[104:107], v[176:191]
    ds_read_b64_tr_b16 a[164:165], v42 offset:59392
    ds_read_b64_tr_b16 a[166:167], v42 offset:59648
    v_xor_b32 v42, 0x10000, v42
    v_mfma_f32_32x32x16_bf16 v[160:175], a[176:179], a[108:111], v[160:175]
    s_add_u32 s7, s57, 65536
    ds_read_b64_tr_b16 a[168:169], v43 offset:57344
    ds_read_b64_tr_b16 a[170:171], v43 offset:57600
    buffer_store_dwordx4 v[136:139], v16, s[24:27], s7 offen sc1
    v_mfma_f32_32x32x16_bf16 v[176:191], a[180:183], a[108:111], v[176:191]
    s_waitcnt lgkmcnt(6)
    ds_read_b64_tr_b16 a[172:173], v43 offset:59392
    ds_read_b64_tr_b16 a[174:175], v43 offset:59648
    v_xor_b32 v43, 0x10000, v43
    v_mfma_f32_32x32x16_bf16 v[160:175], a[184:187], a[112:115], v[160:175]
    s_waitcnt vmcnt(11)
    s_barrier
    ds_read_b64_tr_b16 a[176:177], v40 offset:0
    ds_read_b64_tr_b16 a[178:179], v40 offset:256
    v_mfma_f32_32x32x16_bf16 v[176:191], a[188:191], a[112:115], v[176:191]
    s_mov_b32 m0, s51
    ds_read_b64_tr_b16 a[180:181], v40 offset:2048
    ds_read_b64_tr_b16 a[182:183], v40 offset:2304
    global_load_lds_dwordx4 v10, s[20:21] offset:0
    v_smfmac_f32_16x16x64_bf16 a[212:215], a[242:245], a[184:191], v17
    v_mfma_f32_32x32x16_bf16 v[160:175], a[192:195], a[116:119], v[160:175]
    ds_read_b64_tr_b16 a[184:185], v41 offset:0
    ds_read_b64_tr_b16 a[186:187], v41 offset:256
    v_mfma_f32_32x32x16_bf16 v[176:191], a[196:199], a[116:119], v[176:191]
    s_waitcnt lgkmcnt(6)
    ds_read_b64_tr_b16 a[188:189], v41 offset:2048
    ds_read_b64_tr_b16 a[190:191], v41 offset:2304
    v_mfma_f32_32x32x16_bf16 v[160:175], a[160:163], a[120:123], v[160:175]
    ds_read_b64_tr_b16 a[192:193], v42 offset:0
    ds_read_b64_tr_b16 a[194:195], v42 offset:256
    global_load_lds_dwordx4 v11, s[20:21] offset:1024
    v_mfma_f32_32x32x16_bf16 v[176:191], a[164:167], a[120:123], v[176:191]
    ds_read_b64_tr_b16 a[196:197], v42 offset:2048
    ds_read_b64_tr_b16 a[198:199], v42 offset:2304
    v_mfma_f32_32x32x16_bf16 v[160:175], a[168:171], a[124:127], v[160:175]
    ds_read_b64_tr_b16 a[160:161], v43 offset:0
    ds_read_b64_tr_b16 a[162:163], v43 offset:256
    v_mfma_f32_32x32x16_bf16 v[176:191], a[172:175], a[124:127], v[176:191]
    s_waitcnt lgkmcnt(6)
    ds_read_b64_tr_b16 a[164:165], v43 offset:2048
    ds_read_b64_tr_b16 a[166:167], v43 offset:2304
    global_load_lds_dwordx4 v10, s[22:23] offset:2048
    v_mfma_f32_32x32x16_bf16 v[160:175], a[176:179], a[128:131], v[160:175]
    s_add_u32 s6, s57, 131072
    ds_read_b64_tr_b16 a[168:169], v40 offset:8192
    ds_read_b64_tr_b16 a[170:171], v40 offset:8448
    buffer_store_dwordx4 v[144:147], v16, s[24:27], s6 offen sc1
    v_mfma_f32_32x32x16_bf16 v[176:191], a[180:183], a[128:131], v[176:191]
    ds_read_b64_tr_b16 a[172:173], v40 offset:10240
    ds_read_b64_tr_b16 a[174:175], v40 offset:10496
    v_smfmac_f32_16x16x64_bf16 a[212:215], a[242:245], a[176:183], v17
    v_mfma_f32_32x32x16_bf16 v[160:175], a[184:187], a[132:135], v[160:175]
    ds_read_b64_tr_b16 a[176:177], v41 offset:8192
    ds_read_b64_tr_b16 a[178:179], v41 offset:8448
    global_load_lds_dwordx4 v11, s[22:23] offset:3072
    v_add_u32 v10, 196608, v10
    v_add_u32 v11, 196608, v11
    v_mfma_f32_32x32x16_bf16 v[176:191], a[188:191], a[132:135], v[176:191]
    s_waitcnt lgkmcnt(6)
    s_mov_b32 m0, s52
    ds_read_b64_tr_b16 a[180:181], v41 offset:10240
    ds_read_b64_tr_b16 a[182:183], v41 offset:10496
    v_mfma_f32_32x32x16_bf16 v[160:175], a[192:195], a[136:139], v[160:175]
    ds_read_b64_tr_b16 a[184:185], v42 offset:8192
    ds_read_b64_tr_b16 a[186:187], v42 offset:8448
    v_mfma_f32_32x32x16_bf16 v[176:191], a[196:199], a[136:139], v[176:191]
    ds_read_b64_tr_b16 a[188:189], v42 offset:10240
    ds_read_b64_tr_b16 a[190:191], v42 offset:10496
    global_load_lds_dwordx4 v10, s[20:21] offset:0
    v_mfma_f32_32x32x16_bf16 v[160:175], a[160:163], a[140:143], v[160:175]
    ds_read_b64_tr_b16 a[192:193], v43 offset:8192
    ds_read_b64_tr_b16 a[194:195], v43 offset:8448
    v_mfma_f32_32x32x16_bf16 v[176:191], a[164:167], a[140:143], v[176:191]
    s_waitcnt lgkmcnt(6)
    ds_read_b64_tr_b16 a[196:197], v43 offset:10240
    ds_read_b64_tr_b16 a[198:199], v43 offset:10496
    v_smfmac_f32_16x16x64_bf16 a[212:215], a[242:245], a[168:175], v17
    v_mfma_f32_32x32x16_bf16 v[160:175], a[168:171], a[144:147], v[160:175]
    ds_read_b64_tr_b16 a[160:161], v12 offset:16384
    ds_read_b64_tr_b16 a[162:163], v12 offset:16896
    global_load_lds_dwordx4 v11, s[20:21] offset:1024
    v_mfma_f32_32x32x16_bf16 v[176:191], a[172:175], a[144:147], v[176:191]
    ds_read_b64_tr_b16 a[164:165], v12 offset:18432
    ds_read_b64_tr_b16 a[166:167], v12 offset:18944
    v_accvgpr_read_b32 v92, a212
    v_accvgpr_read_b32 v93, a213
    v_add_f32 v92, v92, v93
    v_cvt_pk_bf16_f32 v93, v92, v92
    v_mfma_f32_32x32x16_bf16 v[160:175], a[176:179], a[148:151], v[160:175]
    s_add_u32 s7, s57, 196608
    ds_read_b64_tr_b16 a[168:169], v13 offset:16384
    ds_read_b64_tr_b16 a[170:171], v13 offset:16896
    v_and_b32 v93, 0xffff0000, v93
    v_sub_f32 v92, v92, v93
    v_cvt_pk_bf16_f32 v92, v93, v92
    v_mfma_f32_32x32x16_bf16 v[176:191], a[180:183], a[148:151], v[176:191]
    s_waitcnt lgkmcnt(6)
    ds_read_b64_tr_b16 a[172:173], v13 offset:18432
    ds_read_b64_tr_b16 a[174:175], v13 offset:18944
    global_load_lds_dwordx4 v10, s[22:23] offset:2048
    v_mfma_f32_32x32x16_bf16 v[160:175], a[184:187], a[152:155], v[160:175]
    ds_read_b64_tr_b16 a[176:177], v14 offset:16384
    ds_read_b64_tr_b16 a[178:179], v14 offset:16896
    ds_write_b32 v0, v92 offset:3072
    v_mfma_f32_32x32x16_bf16 v[176:191], a[188:191], a[152:155], v[176:191]
    ds_read_b64_tr_b16 a[180:181], v14 offset:18432
    ds_read_b64_tr_b16 a[182:183], v14 offset:18944
    buffer_store_dwordx4 v[152:155], v16, s[24:27], s7 offen sc1
    v_mfma_f32_32x32x16_bf16 v[160:175], a[192:195], a[156:159], v[160:175]
    s_waitcnt lgkmcnt(2)
    s_barrier
    ds_read_b64_tr_b16 a[184:185], v15 offset:16384
    ds_read_b64_tr_b16 a[186:187], v15 offset:16896
    v_mfma_f32_32x32x16_bf16 v[176:191], a[196:199], a[156:159], v[176:191]
    s_waitcnt lgkmcnt(7)
    ds_read_b64_tr_b16 a[188:189], v15 offset:18432
    ds_read_b64_tr_b16 a[190:191], v15 offset:18944
    global_load_lds_dwordx4 v11, s[22:23] offset:3072
    ds_read_b128 a[224:227], v39 offset:3072
    ds_read_b128 a[228:231], v39 offset:3584
    v_add_u32 v10, 196608, v10
    v_add_u32 v11, 196608, v11
    v_mfma_f32_32x32x16_bf16 v[192:207], a[160:163], a[0:3], 0
    s_mov_b32 m0, s54
    ds_read_b64_tr_b16 a[192:193], v6 offset:16384
    ds_read_b64_tr_b16 a[194:195], v6 offset:16896
    buffer_load_dwordx4 v19, s[36:39], s91 offen lds
    v_mfma_f32_32x32x16_bf16 v[224:239], a[164:167], a[0:3], 0
    s_bitset1_b32 m0, 10
    ds_read_b64_tr_b16 a[196:197], v6 offset:18432
    ds_read_b64_tr_b16 a[198:199], v6 offset:18944
    buffer_load_dwordx4 v20, s[36:39], s92 offen lds
    v_smfmac_f32_16x16x64_bf16 v[100:103], a[242:245], a[160:167], v17
    s_waitcnt lgkmcnt(5)
    v_mfma_f32_32x32x16_bf16 v[160:175], a[224:227], a[246:249], v[160:175]
    v_mfma_f32_32x32x16_bf16 v[208:223], a[168:171], a[0:3], 0
    s_bitset1_b32 m0, 11
    ds_read_b64_tr_b16 a[160:161], v7 offset:16384
    ds_read_b64_tr_b16 a[162:163], v7 offset:16896
    buffer_load_dwordx4 v22, s[36:39], s94 offen lds
    s_waitcnt lgkmcnt(6)
    v_mfma_f32_32x32x16_bf16 v[176:191], a[228:231], a[246:249], v[176:191]
    v_mfma_f32_32x32x16_bf16 v[240:255], a[172:175], a[0:3], 0
    s_waitcnt lgkmcnt(8)
    s_bitset0_b32 m0, 10
    ds_read_b64_tr_b16 a[164:165], v7 offset:18432
    ds_read_b64_tr_b16 a[166:167], v7 offset:18944
    buffer_load_dwordx4 v21, s[36:39], s93 offen lds
    v_smfmac_f32_16x16x64_bf16 v[108:111], a[242:245], a[168:175], v17
    v_mfma_f32_32x32x16_bf16 v[192:207], a[176:179], a[4:7], v[192:207]
    ds_read_b64_tr_b16 a[168:169], v2 offset:16384
    ds_read_b64_tr_b16 a[170:171], v2 offset:16896
    v_mul_f32 v80, v29, v160
    v_mul_f32 v81, v29, v161
    v_mul_f32 v82, v29, v162
    v_mul_f32 v83, v29, v163
    v_mfma_f32_32x32x16_bf16 v[224:239], a[180:183], a[4:7], v[224:239]
    ds_read_b64_tr_b16 a[172:173], v2 offset:18432
    ds_read_b64_tr_b16 a[174:175], v2 offset:18944
    v_exp_f32 v80, v80
    v_exp_f32 v81, v81
    v_mfma_f32_32x32x16_bf16 v[208:223], a[184:187], a[4:7], v[208:223]
    ds_read_b64_tr_b16 a[176:177], v3 offset:16384
    ds_read_b64_tr_b16 a[178:179], v3 offset:16896
    v_exp_f32 v82, v82
    v_exp_f32 v83, v83
    v_mfma_f32_32x32x16_bf16 v[240:255], a[188:191], a[4:7], v[240:255]
    s_waitcnt lgkmcnt(6)
    ds_read_b64_tr_b16 a[180:181], v3 offset:18432
    ds_read_b64_tr_b16 a[182:183], v3 offset:18944
    v_fma_f32 v80, v80, v28, v28
    v_fma_f32 v81, v81, v28, v28
    v_fma_f32 v82, v82, v28, v28
    v_fma_f32 v83, v83, v28, v28
    v_mfma_f32_32x32x16_bf16 v[192:207], a[192:195], a[8:11], v[192:207]
    s_waitcnt vmcnt(15)
    s_barrier
    ds_read_b64_tr_b16 a[184:185], v12 offset:32768
    ds_read_b64_tr_b16 a[186:187], v12 offset:33280
    v_mfma_f32_32x32x16_bf16 v[224:239], a[196:199], a[8:11], v[224:239]
    s_mov_b32 m0, s62
    ds_read_b64_tr_b16 a[188:189], v12 offset:34816
    ds_read_b64_tr_b16 a[190:191], v12 offset:35328
    global_load_lds_dwordx4 v10, s[20:21] offset:0
    v_rcp_f32 v80, v80
    v_mfma_f32_32x32x16_bf16 v[208:223], a[160:163], a[8:11], v[208:223]
    ds_read_b64_tr_b16 a[192:193], v13 offset:32768
    ds_read_b64_tr_b16 a[194:195], v13 offset:33280
    v_rcp_f32 v81, v81
    v_rcp_f32 v82, v82
    v_mfma_f32_32x32x16_bf16 v[240:255], a[164:167], a[8:11], v[240:255]
    s_waitcnt lgkmcnt(6)
    ds_read_b64_tr_b16 a[196:197], v13 offset:34816
    ds_read_b64_tr_b16 a[198:199], v13 offset:35328
    v_rcp_f32 v83, v83
    v_mul_f32 v84, v80, v176
    v_mul_f32 v85, v81, v177
    v_mfma_f32_32x32x16_bf16 v[192:207], a[168:171], a[12:15], v[192:207]
    ds_read_b64_tr_b16 a[160:161], v14 offset:32768
    ds_read_b64_tr_b16 a[162:163], v14 offset:33280
    global_load_lds_dwordx4 v11, s[20:21] offset:1024
    v_mul_f32 v86, v82, v178
    v_mul_f32 v87, v83, v179
    v_cvt_pk_bf16_f32 v160, v84, v85
    v_mfma_f32_32x32x16_bf16 v[224:239], a[172:175], a[12:15], v[224:239]
    ds_read_b64_tr_b16 a[164:165], v14 offset:34816
    ds_read_b64_tr_b16 a[166:167], v14 offset:35328
    v_cvt_pk_bf16_f32 v161, v86, v87
    v_mul_f32 v64, v29, v164
    v_mul_f32 v65, v29, v165
    v_mul_f32 v66, v29, v166
    v_mfma_f32_32x32x16_bf16 v[208:223], a[176:179], a[12:15], v[208:223]
    ds_read_b64_tr_b16 a[168:169], v15 offset:32768
    ds_read_b64_tr_b16 a[170:171], v15 offset:33280
    v_mul_f32 v67, v29, v167
    v_exp_f32 v64, v64
    v_mfma_f32_32x32x16_bf16 v[240:255], a[180:183], a[12:15], v[240:255]
    s_waitcnt lgkmcnt(6)
    ds_read_b64_tr_b16 a[172:173], v15 offset:34816
    ds_read_b64_tr_b16 a[174:175], v15 offset:35328
    global_load_lds_dwordx4 v10, s[22:23] offset:2048
    v_exp_f32 v65, v65
    v_mfma_f32_32x32x16_bf16 v[192:207], a[184:187], a[16:19], v[192:207]
    s_waitcnt vmcnt(8)
    s_barrier
    ds_read_b64_tr_b16 a[176:177], v6 offset:32768
    ds_read_b64_tr_b16 a[178:179], v6 offset:33280
    s_mov_b32 s44, 0x1000000
L_spNQ:
    v_cmp_eq_u32 vcc, 0, v33
    s_nop 0
    s_cbranch_vccz L_okNQ
    s_sub_u32 s44, s44, 1
    s_cbranch_scc1 L_okNQ
    s_sleep 1
    buffer_load_dword v33, v37, s[32:35], 0 offen sc1
    s_waitcnt vmcnt(0)
    s_branch L_spNQ
L_okNQ:
    v_readfirstlane_b32 s84, v33
    s_cmp_lg_u32 s3, 0
    s_cbranch_scc1 L_flQQ
    s_mov_b64 exec, 1
    v_mov_b32 v42, s84
    v_mov_b32 v43, 0
    buffer_store_dword v42, v43, s[24:27], s95 offen sc1
    s_mov_b64 exec, -1
L_flQQ:
    v_mfma_f32_32x32x16_bf16 v[224:239], a[188:191], a[16:19], v[224:239]
    ds_read_b64_tr_b16 a[180:181], v6 offset:34816
    ds_read_b64_tr_b16 a[182:183], v6 offset:35328
    v_exp_f32 v66, v66
    v_exp_f32 v67, v67
    v_smfmac_f32_16x16x64_bf16 v[100:103], a[242:245], a[184:191], v17
    v_fma_f32 v64, v64, v28, v28
    v_fma_f32 v65, v65, v28, v28
    v_mfma_f32_32x32x16_bf16 v[208:223], a[192:195], a[16:19], v[208:223]
    ds_read_b64_tr_b16 a[184:185], v7 offset:32768
    ds_read_b64_tr_b16 a[186:187], v7 offset:33280
    global_load_lds_dwordx4 v11, s[22:23] offset:3072
    v_add_u32 v10, 196608, v10
    v_add_u32 v11, 196608, v11
    v_fma_f32 v66, v66, v28, v28
    v_mfma_f32_32x32x16_bf16 v[240:255], a[196:199], a[16:19], v[240:255]
    s_waitcnt lgkmcnt(6)
    s_mov_b32 m0, s47
    ds_read_b64_tr_b16 a[188:189], v7 offset:34816
    ds_read_b64_tr_b16 a[190:191], v7 offset:35328
    v_fma_f32 v67, v67, v28, v28
    v_rcp_f32 v64, v64
    v_smfmac_f32_16x16x64_bf16 v[108:111], a[242:245], a[192:199], v17
    v_rcp_f32 v65, v65
    v_mfma_f32_32x32x16_bf16 v[192:207], a[160:163], a[20:23], v[192:207]
    ds_read_b64_tr_b16 a[192:193], v2 offset:32768
    ds_read_b64_tr_b16 a[194:195], v2 offset:33280
    v_rcp_f32 v66, v66
    v_rcp_f32 v67, v67
    v_mfma_f32_32x32x16_bf16 v[224:239], a[164:167], a[20:23], v[224:239]
    ds_read_b64_tr_b16 a[196:197], v2 offset:34816
    ds_read_b64_tr_b16 a[198:199], v2 offset:35328
    global_load_lds_dwordx4 v10, s[20:21] offset:0
    v_mul_f32 v68, v64, v180
    v_mul_f32 v69, v65, v181
    v_mul_f32 v70, v66, v182
    v_mfma_f32_32x32x16_bf16 v[208:223], a[168:171], a[20:23], v[208:223]
    ds_read_b64_tr_b16 a[160:161], v3 offset:32768
    ds_read_b64_tr_b16 a[162:163], v3 offset:33280
    v_mul_f32 v71, v67, v183
    v_cvt_pk_bf16_f32 v162, v68, v69
    v_cvt_pk_bf16_f32 v163, v70, v71
    v_mul_f32 v72, v29, v168
    v_mfma_f32_32x32x16_bf16 v[240:255], a[172:175], a[20:23], v[240:255]
    s_waitcnt lgkmcnt(6)
    ds_read_b64_tr_b16 a[164:165], v3 offset:34816
    ds_read_b64_tr_b16 a[166:167], v3 offset:35328
    v_mul_f32 v73, v29, v169
    v_mul_f32 v74, v29, v170
    v_mul_f32 v75, v29, v171
    v_mfma_f32_32x32x16_bf16 v[192:207], a[176:179], a[24:27], v[192:207]
    ds_read_b64_tr_b16 a[168:169], v12 offset:49152
    ds_read_b64_tr_b16 a[170:171], v12 offset:49664
    global_load_lds_dwordx4 v11, s[20:21] offset:1024
    v_exp_f32 v72, v72
    v_mfma_f32_32x32x16_bf16 v[224:239], a[180:183], a[24:27], v[224:239]
    ds_read_b64_tr_b16 a[172:173], v12 offset:51200
    ds_read_b64_tr_b16 a[174:175], v12 offset:51712
    v_xor_b32 v12, 0x10000, v12
    v_exp_f32 v73, v73
    v_mfma_f32_32x32x16_bf16 v[208:223], a[184:187], a[24:27], v[208:223]
    ds_read_b64_tr_b16 a[176:177], v13 offset:49152
    ds_read_b64_tr_b16 a[178:179], v13 offset:49664
    v_exp_f32 v74, v74
    v_exp_f32 v75, v75
    v_mfma_f32_32x32x16_bf16 v[240:255], a[188:191], a[24:27], v[240:255]
    s_waitcnt lgkmcnt(6)
    ds_read_b64_tr_b16 a[180:181], v13 offset:51200
    ds_read_b64_tr_b16 a[182:183], v13 offset:51712
    global_load_lds_dwordx4 v10, s[22:23] offset:2048
    v_xor_b32 v13, 0x10000, v13
    v_fma_f32 v72, v72, v28, v28
    v_fma_f32 v73, v73, v28, v28
    v_mfma_f32_32x32x16_bf16 v[192:207], a[192:195], a[28:31], v[192:207]
    ds_read_b64_tr_b16 a[184:185], v14 offset:49152
    ds_read_b64_tr_b16 a[186:187], v14 offset:49664
    v_fma_f32 v74, v74, v28, v28
    v_fma_f32 v75, v75, v28, v28
    v_rcp_f32 v72, v72
    v_mfma_f32_32x32x16_bf16 v[224:239], a[196:199], a[28:31], v[224:239]
    ds_read_b64_tr_b16 a[188:189], v14 offset:51200
    ds_read_b64_tr_b16 a[190:191], v14 offset:51712
    v_xor_b32 v14, 0x10000, v14
    v_rcp_f32 v73, v73
    v_mfma_f32_32x32x16_bf16 v[208:223], a[160:163], a[28:31], v[208:223]
    ds_read_b64_tr_b16 a[192:193], v15 offset:49152
    ds_read_b64_tr_b16 a[194:195], v15 offset:49664
    global_load_lds_dwordx4 v11, s[22:23] offset:3072
    v_add_u32 v10, 196608, v10
    v_add_u32 v11, 196608, v11
    v_mfma_f32_32x32x16_bf16 v[240:255], a[164:167], a[28:31], v[240:255]
    s_waitcnt lgkmcnt(6)
    ds_read_b64_tr_b16 a[196:197], v15 offset:51200
    ds_read_b64_tr_b16 a[198:199], v15 offset:51712
    v_xor_b32 v15, 0x10000, v15
    v_rcp_f32 v74, v74
    v_mfma_f32_32x32x16_bf16 v[192:207], a[168:171], a[32:35], v[192:207]
    ds_read_b64_tr_b16 a[160:161], v6 offset:49152
    ds_read_b64_tr_b16 a[162:163], v6 offset:49664
    v_rcp_f32 v75, v75
    v_mul_f32 v76, v72, v184
    v_mul_f32 v77, v73, v185
    v_mfma_f32_32x32x16_bf16 v[224:239], a[172:175], a[32:35], v[224:239]
    ds_read_b64_tr_b16 a[164:165], v6 offset:51200
    ds_read_b64_tr_b16 a[166:167], v6 offset:51712
    v_xor_b32 v6, 0x10000, v6
    v_mul_f32 v78, v74, v186
    v_mul_f32 v79, v75, v187
    v_smfmac_f32_16x16x64_bf16 v[100:103], a[242:245], a[168:175], v17
    v_cvt_pk_bf16_f32 v168, v76, v77
    v_cvt_pk_bf16_f32 v169, v78, v79
    v_mul_f32 v80, v29, v172
    v_mfma_f32_32x32x16_bf16 v[208:223], a[176:179], a[32:35], v[208:223]
    ds_read_b64_tr_b16 a[168:169], v7 offset:49152
    ds_read_b64_tr_b16 a[170:171], v7 offset:49664
    v_mul_f32 v81, v29, v173
    v_mul_f32 v82, v29, v174
    v_mul_f32 v83, v29, v175
    v_mfma_f32_32x32x16_bf16 v[240:255], a[180:183], a[32:35], v[240:255]
    s_waitcnt lgkmcnt(6)
    ds_read_b64_tr_b16 a[172:173], v7 offset:51200
    ds_read_b64_tr_b16 a[174:175], v7 offset:51712
    v_xor_b32 v7, 0x10000, v7
    v_exp_f32 v80, v80
    v_smfmac_f32_16x16x64_bf16 v[108:111], a[242:245], a[176:183], v17
    v_exp_f32 v81, v81
    v_mfma_f32_32x32x16_bf16 v[192:207], a[184:187], a[36:39], v[192:207]
    ds_read_b64_tr_b16 a[176:177], v2 offset:49152
    ds_read_b64_tr_b16 a[178:179], v2 offset:49664
    v_exp_f32 v82, v82
    v_exp_f32 v83, v83
    v_mfma_f32_32x32x16_bf16 v[224:239], a[188:191], a[36:39], v[224:239]
    ds_read_b64_tr_b16 a[180:181], v2 offset:51200
    ds_read_b64_tr_b16 a[182:183], v2 offset:51712
    v_xor_b32 v2, 0x10000, v2
    v_fma_f32 v80, v80, v28, v28
    v_fma_f32 v81, v81, v28, v28
    v_fma_f32 v82, v82, v28, v28
    v_mfma_f32_32x32x16_bf16 v[208:223], a[192:195], a[36:39], v[208:223]
    ds_read_b64_tr_b16 a[184:185], v3 offset:49152
    ds_read_b64_tr_b16 a[186:187], v3 offset:49664
    v_fma_f32 v83, v83, v28, v28
    v_rcp_f32 v80, v80
    v_mfma_f32_32x32x16_bf16 v[240:255], a[196:199], a[36:39], v[240:255]
    s_waitcnt lgkmcnt(6)
    ds_read_b64_tr_b16 a[188:189], v3 offset:51200
    ds_read_b64_tr_b16 a[190:191], v3 offset:51712
    v_xor_b32 v3, 0x10000, v3
    v_rcp_f32 v81, v81
    v_mfma_f32_32x32x16_bf16 v[192:207], a[160:163], a[40:43], v[192:207]
    s_waitcnt vmcnt(12)
    s_barrier
    ds_read_b64_tr_b16 a[192:193], v12 offset:0
    ds_read_b64_tr_b16 a[194:195], v12 offset:512
    v_mfma_f32_32x32x16_bf16 v[224:239], a[164:167], a[40:43], v[224:239]
    s_mov_b32 m0, s48
    ds_read_b64_tr_b16 a[196:197], v12 offset:2048
    ds_read_b64_tr_b16 a[198:199], v12 offset:2560
    global_load_lds_dwordx4 v10, s[20:21] offset:0
    v_rcp_f32 v82, v82
    v_mfma_f32_32x32x16_bf16 v[208:223], a[168:171], a[40:43], v[208:223]
    ds_read_b64_tr_b16 a[160:161], v13 offset:0
    ds_read_b64_tr_b16 a[162:163], v13 offset:512
    v_rcp_f32 v83, v83
    v_mul_f32 v84, v80, v188
    v_mul_f32 v85, v81, v189
    v_mfma_f32_32x32x16_bf16 v[240:255], a[172:175], a[40:43], v[240:255]
    s_waitcnt lgkmcnt(6)
    ds_read_b64_tr_b16 a[164:165], v13 offset:2048
    ds_read_b64_tr_b16 a[166:167], v13 offset:2560
    v_mul_f32 v86, v82, v190
    v_mul_f32 v87, v83, v191
    v_cvt_pk_bf16_f32 v170, v84, v85
    v_cvt_pk_bf16_f32 v171, v86, v87
    v_mfma_f32_32x32x16_bf16 v[192:207], a[176:179], a[44:47], v[192:207]
    ds_read_b64_tr_b16 a[168:169], v14 offset:0
    ds_read_b64_tr_b16 a[170:171], v14 offset:512
    global_load_lds_dwordx4 v11, s[20:21] offset:1024
    v_mfma_f32_32x32x16_bf16 v[224:239], a[180:183], a[44:47], v[224:239]
    ds_read_b64_tr_b16 a[172:173], v14 offset:2048
    ds_read_b64_tr_b16 a[174:175], v14 offset:2560
    v_mfma_f32_32x32x16_bf16 v[208:223], a[184:187], a[44:47], v[208:223]
    ds_read_b64_tr_b16 a[176:177], v15 offset:0
    ds_read_b64_tr_b16 a[178:179], v15 offset:512
    v_mfma_f32_32x32x16_bf16 v[240:255], a[188:191], a[44:47], v[240:255]
    s_waitcnt lgkmcnt(6)
    ds_read_b64_tr_b16 a[180:181], v15 offset:2048
    ds_read_b64_tr_b16 a[182:183], v15 offset:2560
    global_load_lds_dwordx4 v10, s[22:23] offset:2048
    v_mfma_f32_32x32x16_bf16 v[192:207], a[192:195], a[48:51], v[192:207]
    ds_read_b64_tr_b16 a[184:185], v6 offset:0
    ds_read_b64_tr_b16 a[186:187], v6 offset:512
    v_mfma_f32_32x32x16_bf16 v[224:239], a[196:199], a[48:51], v[224:239]
    ds_read_b64_tr_b16 a[188:189], v6 offset:2048
    ds_read_b64_tr_b16 a[190:191], v6 offset:2560
    v_smfmac_f32_16x16x64_bf16 v[100:103], a[242:245], a[192:199], v17
    v_mfma_f32_32x32x16_bf16 v[208:223], a[160:163], a[48:51], v[208:223]
    ds_read_b64_tr_b16 a[192:193], v7 offset:0
    ds_read_b64_tr_b16 a[194:195], v7 offset:512
    global_load_lds_dwordx4 v11, s[22:23] offset:3072
    v_add_u32 v10, 196608, v10
    v_add_u32 v11, 196608, v11
    v_mfma_f32_32x32x16_bf16 v[240:255], a[164:167], a[48:51], v[240:255]
    s_waitcnt lgkmcnt(6)
    s_mov_b32 m0, s49
    ds_read_b64_tr_b16 a[196:197], v7 offset:2048
    ds_read_b64_tr_b16 a[198:199], v7 offset:2560
    v_smfmac_f32_16x16x64_bf16 v[108:111], a[242:245], a[160:167], v17
    v_mfma_f32_32x32x16_bf16 v[192:207], a[168:171], a[52:55], v[192:207]
    ds_read_b64_tr_b16 a[160:161], v2 offset:0
    ds_read_b64_tr_b16 a[162:163], v2 offset:512
    v_mfma_f32_32x32x16_bf16 v[224:239], a[172:175], a[52:55], v[224:239]
    ds_read_b64_tr_b16 a[164:165], v2 offset:2048
    ds_read_b64_tr_b16 a[166:167], v2 offset:2560
    global_load_lds_dwordx4 v10, s[20:21] offset:0
    v_mfma_f32_32x32x16_bf16 v[208:223], a[176:179], a[52:55], v[208:223]
    ds_read_b64_tr_b16 a[168:169], v3 offset:0
    ds_read_b64_tr_b16 a[170:171], v3 offset:512
    global_load_lds_dwordx4 v11, s[20:21] offset:1024
    global_load_lds_dwordx4 v10, s[22:23] offset:2048
    global_load_lds_dwordx4 v11, s[22:23] offset:3072
    v_add_u32 v10, 196608, v10
    v_add_u32 v11, 196608, v11
    v_mfma_f32_32x32x16_bf16 v[240:255], a[180:183], a[52:55], v[240:255]
    s_waitcnt lgkmcnt(6)
    ds_read_b64_tr_b16 a[172:173], v3 offset:2048
    ds_read_b64_tr_b16 a[174:175], v3 offset:2560
    s_branch L_p1c
L_clsV:
    v_mfma_f32_32x32x16_bf16 v[96:111], a[0:3], a[160:163], 0
    s_mov_b32 m0, s53
    s_cmp_eq_u32 s3, 1
    s_cselect_b64 s[100:101], s[74:75], s[72:73]
    s_cmp_eq_u32 s3, 2
    ds_read_b64_tr_b16 a[192:193], v6 offset:0
    ds_read_b64_tr_b16 a[194:195], v6 offset:512
    global_load_lds_dwordx4 v84, s[44:45] offset:0
    v_mfma_f32_32x32x16_bf16 v[112:127], a[0:3], a[164:167], 0
    s_cselect_b64 s[100:101], s[66:67], s[100:101]
    s_cmp_eq_u32 s3, 3
    s_cselect_b64 s[100:101], s[64:65], s[100:101]
    s_lshr_b32 s99, s3, 1
    s_lshl_b32 s99, s99, 21
    s_load_dword s58, s[100:101], s99
    s_mul_i32 s86, s85, 6554
    ds_read_b64_tr_b16 a[196:197], v7 offset:0
    ds_read_b64_tr_b16 a[198:199], v7 offset:512
    v_smfmac_f32_16x16x64_bf16 a[216:219], a[242:245], a[160:167], v17
    v_mfma_f32_32x32x16_bf16 v[128:143], a[0:3], a[168:171], 0
    s_waitcnt vmcnt(15)
    s_lshr_b32 s86, s86, 16
    ds_read_b64_tr_b16 a[160:161], v6 offset:2048
    ds_read_b64_tr_b16 a[162:163], v6 offset:2560
    ds_read_b128 v[160:163], v92 offset:16384
    ds_read_b128 v[164:167], v93 offset:16384
    global_load_lds_dwordx4 v85, s[44:45] offset:1024
    v_mfma_f32_32x32x16_bf16 v[144:159], a[0:3], a[172:175], 0
    s_waitcnt lgkmcnt(8)
    s_mul_i32 s6, s86, 10
    s_sub_u32 s87, s85, s6
    s_cmp_lt_u32 s86, 48
    s_cselect_b32 s36, s76, s68
    ds_read_b64_tr_b16 a[164:165], v7 offset:2048
    ds_read_b64_tr_b16 a[166:167], v7 offset:2560
    ds_read_b128 v[168:171], v94 offset:16384
    ds_read_b128 v[172:175], v95 offset:16384
    v_smfmac_f32_16x16x64_bf16 a[220:223], a[242:245], a[168:175], v17
    v_mfma_f32_32x32x16_bf16 v[96:111], a[4:7], a[176:179], v[96:111]
    s_cselect_b32 s37, s77, s69
    s_mov_b32 s38, 819200
    s_cselect_b32 s38, 1966080, s38
    ds_read_b64_tr_b16 a[168:169], v2 offset:0
    ds_read_b64_tr_b16 a[170:171], v2 offset:512
    ds_read_b128 a[16:19], v92 offset:16384
    global_load_lds_dwordx4 v86, s[44:45] offset:2048
    v_mfma_f32_32x32x16_bf16 v[112:127], a[4:7], a[180:183], v[112:127]
    s_mov_b32 s39, 0x00020000
    ds_read_b64_tr_b16 a[172:173], v3 offset:0
    ds_read_b64_tr_b16 a[174:175], v3 offset:512
    v_lshrrev_b32 v74, 2, v64
    v_and_b32 v75, 3, v64
    v_lshl_add_u32 v75, v74, 3, v75
    v_mul_u32_u24 v75, 1280, v75
    v_mfma_f32_32x32x16_bf16 v[128:143], a[4:7], a[184:187], v[128:143]
    ds_read_b64_tr_b16 a[176:177], v2 offset:2048
    ds_read_b64_tr_b16 a[178:179], v2 offset:2560
    ds_read_b128 a[20:23], v93 offset:16384
    global_load_lds_dwordx4 v87, s[44:45] offset:3072
    v_add_u32 v84, 128, v84
    v_add_u32 v85, 128, v85
    v_mfma_f32_32x32x16_bf16 v[144:159], a[4:7], a[188:191], v[144:159]
    s_waitcnt lgkmcnt(10)
    ds_read_b64_tr_b16 a[180:181], v3 offset:2048
    ds_read_b64_tr_b16 a[182:183], v3 offset:2560
    v_add_u32 v86, 128, v86
    v_add_u32 v87, 128, v87
    v_add_u32 v75, v75, v66
    v_mul_u32_u24 v74, 15360, v74
    s_waitcnt lgkmcnt(10)
    v_smfmac_f32_16x16x64_bf16 a[250:253], a[242:245], v[160:167], v17
    v_smfmac_f32_16x16x64_bf16 a[250:253], a[242:245], v[168:175], v17
    v_dot2_f32_bf16 v34, v160, v160, v34
    v_dot2_f32_bf16 v35, v161, v161, v35
    v_dot2_f32_bf16 v36, v162, v162, v36
    v_dot2_f32_bf16 v37, v163, v163, v37
    v_dot2_f32_bf16 v34, v164, v164, v34
    v_dot2_f32_bf16 v35, v165, v165, v35
    v_dot2_f32_bf16 v36, v166, v166, v36
    v_dot2_f32_bf16 v37, v167, v167, v37
    v_dot2_f32_bf16 v34, v168, v168, v34
    v_dot2_f32_bf16 v35, v169, v169, v35
    v_dot2_f32_bf16 v36, v170, v170, v36
    v_dot2_f32_bf16 v37, v171, v171, v37
    v_dot2_f32_bf16 v34, v172, v172, v34
    v_dot2_f32_bf16 v35, v173, v173, v35
    v_dot2_f32_bf16 v36, v174, v174, v36
    v_dot2_f32_bf16 v37, v175, v175, v37
    v_mfma_f32_32x32x16_bf16 v[96:111], a[8:11], a[192:195], v[96:111]
    s_waitcnt vmcnt(14)
    s_barrier
    ds_read_b64_tr_b16 a[184:185], v12 offset:16384
    ds_read_b64_tr_b16 a[186:187], v12 offset:16896
    ds_read_b128 a[24:27], v94 offset:16384
    v_mfma_f32_32x32x16_bf16 v[112:127], a[8:11], a[196:199], v[112:127]
    s_mov_b32 m0, s50
    ds_read_b64_tr_b16 a[188:189], v13 offset:16384
    ds_read_b64_tr_b16 a[190:191], v13 offset:16896
    global_load_lds_dwordx4 v8, s[12:13] offset:0
    v_add_u32 v76, v75, v74
    v_mfma_f32_32x32x16_bf16 v[128:143], a[8:11], a[160:163], v[128:143]
    s_cmp_lt_u32 s85, 680
    s_cselect_b32 s6, 0, 1073741824
    ds_read_b64_tr_b16 a[192:193], v12 offset:18432
    ds_read_b64_tr_b16 a[194:195], v12 offset:18944
    ds_read_b128 a[28:31], v95 offset:16384
    v_lshlrev_b32 v23, 4, v1
    v_or_b32 v23, s6, v23
    v_mfma_f32_32x32x16_bf16 v[144:159], a[8:11], a[164:167], v[144:159]
    s_waitcnt lgkmcnt(8)
    ds_read_b64_tr_b16 a[196:197], v13 offset:18432
    ds_read_b64_tr_b16 a[198:199], v13 offset:18944
    global_load_lds_dwordx4 v9, s[12:13] offset:1024
    v_or_b32 v75, s6, v75
    v_or_b32 v76, s6, v76
    v_mfma_f32_32x32x16_bf16 v[96:111], a[12:15], a[168:171], v[96:111]
    s_cmp_eq_u32 s3, 1
    s_cselect_b64 s[100:101], s[68:69], s[76:77]
    s_cmp_eq_u32 s3, 2
    s_cselect_b64 s[100:101], s[80:81], s[100:101]
    s_cmp_eq_u32 s3, 3
    ds_read_b64_tr_b16 a[160:161], v14 offset:16384
    ds_read_b64_tr_b16 a[162:163], v14 offset:16896
    v_mfma_f32_32x32x16_bf16 v[112:127], a[12:15], a[172:175], v[112:127]
    s_cselect_b64 s[100:101], s[78:79], s[100:101]
    s_load_dword s58, s[100:101], 0
    s_lshl_b32 s6, s86, 2
    s_sub_u32 s6, s6, 192
    ds_read_b64_tr_b16 a[164:165], v15 offset:16384
    ds_read_b64_tr_b16 a[166:167], v15 offset:16896
    global_load_lds_dwordx4 v8, s[14:15] offset:2048
    v_mfma_f32_32x32x16_bf16 v[128:143], a[12:15], a[176:179], v[128:143]
    s_mul_i32 s7, s6, 205
    s_lshr_b32 s7, s7, 10
    s_mul_i32 s98, s7, 5
    s_sub_u32 s98, s6, s98
    s_mul_i32 s7, s7, 40
    ds_read_b64_tr_b16 a[168:169], v14 offset:18432
    ds_read_b64_tr_b16 a[170:171], v14 offset:18944
    v_mfma_f32_32x32x16_bf16 v[144:159], a[12:15], a[180:183], v[144:159]
    s_waitcnt lgkmcnt(6)
    s_lshl2_add_u32 s7, s98, s7
    ds_read_b64_tr_b16 a[172:173], v15 offset:18432
    ds_read_b64_tr_b16 a[174:175], v15 offset:18944
    global_load_lds_dwordx4 v9, s[14:15] offset:3072
    v_add_u32 v8, 245760, v8
    v_add_u32 v9, 245760, v9
    v_mfma_f32_32x32x16_bf16 v[96:111], a[16:19], a[184:187], v[96:111]
    s_mov_b32 m0, s63
    s_cmp_ge_u32 s98, 2
    s_cselect_b32 s99, 8, 0
    s_add_u32 s7, s7, s99
    s_cmp_eq_u32 s98, 2
    ds_read_b64_tr_b16 a[176:177], v6 offset:16384
    ds_read_b64_tr_b16 a[178:179], v6 offset:16896
    v_mfma_f32_32x32x16_bf16 v[112:127], a[16:19], a[188:191], v[112:127]
    ds_read_b64_tr_b16 a[180:181], v7 offset:16384
    ds_read_b64_tr_b16 a[182:183], v7 offset:16896
    global_load_lds_dwordx4 v84, s[44:45] offset:0
    s_mov_b64 exec, 255
    global_load_dword a210, v44, s[64:65] offset:768
    s_mov_b64 exec, 65535
    global_load_dword a211, v45, s[66:67]
    s_mov_b64 exec, -1
    v_smfmac_f32_16x16x64_bf16 a[216:219], a[242:245], a[184:191], v17
    v_mfma_f32_32x32x16_bf16 v[128:143], a[16:19], a[192:195], v[128:143]
    s_waitcnt vmcnt(15)
    s_cselect_b64 s[100:101], -1, 0
    s_lshl_b32 s6, s86, 5
    ds_read_b64_tr_b16 a[184:185], v6 offset:18432
    ds_read_b64_tr_b16 a[186:187], v6 offset:18944
    ds_read_b128 v[160:163], v92 offset:0
    ds_read_b128 v[164:167], v93 offset:0
    v_mfma_f32_32x32x16_bf16 v[144:159], a[16:19], a[196:199], v[144:159]
    s_waitcnt lgkmcnt(8)
    s_add_u32 s6, s6, 0
    s_cmp_lt_u32 s86, 48
    s_cselect_b32 s6, s6, s7
    ds_read_b64_tr_b16 a[188:189], v7 offset:18432
    ds_read_b64_tr_b16 a[190:191], v7 offset:18944
    ds_read_b128 v[168:171], v94 offset:0
    ds_read_b128 v[172:175], v95 offset:0
    global_load_lds_dwordx4 v85, s[44:45] offset:1024
    v_smfmac_f32_16x16x64_bf16 a[220:223], a[242:245], a[192:199], v17
    v_mfma_f32_32x32x16_bf16 v[96:111], a[20:23], a[160:163], v[96:111]
    s_cselect_b64 s[100:101], 0, s[100:101]
    s_mul_i32 s6, s6, 1280
    s_lshl_b32 s7, s87, 7
    s_add_u32 s91, s6, s7
    ds_read_b64_tr_b16 a[192:193], v2 offset:16384
    ds_read_b64_tr_b16 a[194:195], v2 offset:16896
    ds_read_b128 a[32:35], v92 offset:0
    v_mfma_f32_32x32x16_bf16 v[112:127], a[20:23], a[164:167], v[112:127]
    s_add_u32 s99, s3, 0
    s_min_u32 s99, s99, 10
    s_lshl_b32 s99, s99, 21
    s_load_dword s58, s[82:83], s99
    ds_read_b64_tr_b16 a[196:197], v3 offset:16384
    ds_read_b64_tr_b16 a[198:199], v3 offset:16896
    global_load_lds_dwordx4 v86, s[44:45] offset:2048
    v_mfma_f32_32x32x16_bf16 v[128:143], a[20:23], a[168:171], v[128:143]
    ds_read_b64_tr_b16 a[160:161], v2 offset:18432
    ds_read_b64_tr_b16 a[162:163], v2 offset:18944
    ds_read_b128 a[36:39], v93 offset:0
    v_cndmask_b32 v19, v75, v76, s[100:101]
    v_mfma_f32_32x32x16_bf16 v[144:159], a[20:23], a[172:175], v[144:159]
    s_waitcnt lgkmcnt(10)
    ds_read_b64_tr_b16 a[164:165], v3 offset:18432
    ds_read_b64_tr_b16 a[166:167], v3 offset:18944
    global_load_lds_dwordx4 v87, s[44:45] offset:3072
    v_add_u32 v84, 128, v84
    v_add_u32 v85, 128, v85
    v_add_u32 v86, 128, v86
    s_waitcnt lgkmcnt(10)
    v_smfmac_f32_16x16x64_bf16 a[250:253], a[242:245], v[160:167], v17
    v_smfmac_f32_16x16x64_bf16 a[250:253], a[242:245], v[168:175], v17
    v_dot2_f32_bf16 v34, v160, v160, v34
    v_dot2_f32_bf16 v35, v161, v161, v35
    v_dot2_f32_bf16 v36, v162, v162, v36
    v_dot2_f32_bf16 v37, v163, v163, v37
    v_dot2_f32_bf16 v34, v164, v164, v34
    v_dot2_f32_bf16 v35, v165, v165, v35
    v_dot2_f32_bf16 v36, v166, v166, v36
    v_dot2_f32_bf16 v37, v167, v167, v37
    v_dot2_f32_bf16 v34, v168, v168, v34
    v_dot2_f32_bf16 v35, v169, v169, v35
    v_dot2_f32_bf16 v36, v170, v170, v36
    v_dot2_f32_bf16 v37, v171, v171, v37
    v_dot2_f32_bf16 v34, v172, v172, v34
    v_dot2_f32_bf16 v35, v173, v173, v35
    v_dot2_f32_bf16 v36, v174, v174, v36
    v_dot2_f32_bf16 v37, v175, v175, v37
    v_mfma_f32_32x32x16_bf16 v[96:111], a[24:27], a[176:179], v[96:111]
    s_waitcnt vmcnt(14)
    s_barrier
    ds_read_b64_tr_b16 a[168:169], v12 offset:32768
    ds_read_b64_tr_b16 a[170:171], v12 offset:33280
    ds_read_b128 a[40:43], v94 offset:0
    v_mfma_f32_32x32x16_bf16 v[112:127], a[24:27], a[180:183], v[112:127]
    s_lshl_b32 s6, s86, 2
    s_sub_u32 s6, s6, 191
    s_mul_i32 s7, s6, 205
    s_lshr_b32 s7, s7, 10
    ds_read_b64_tr_b16 a[172:173], v13 offset:32768
    ds_read_b64_tr_b16 a[174:175], v13 offset:33280
    v_add_u32 v87, 128, v87
    v_mfma_f32_32x32x16_bf16 v[128:143], a[24:27], a[184:187], v[128:143]
    s_mov_b32 m0, s51
    s_mul_i32 s98, s7, 5
    s_sub_u32 s98, s6, s98
    ds_read_b64_tr_b16 a[176:177], v12 offset:34816
    ds_read_b64_tr_b16 a[178:179], v12 offset:35328
    ds_read_b128 a[44:47], v95 offset:0
    global_load_lds_dwordx4 v8, s[12:13] offset:0
    v_mfma_f32_32x32x16_bf16 v[144:159], a[24:27], a[188:191], v[144:159]
    s_waitcnt lgkmcnt(8)
    s_mul_i32 s7, s7, 40
    s_lshl2_add_u32 s7, s98, s7
    s_cmp_ge_u32 s98, 2
    s_cselect_b32 s99, 8, 0
    ds_read_b64_tr_b16 a[180:181], v13 offset:34816
    ds_read_b64_tr_b16 a[182:183], v13 offset:35328
    v_mfma_f32_32x32x16_bf16 v[96:111], a[28:31], a[192:195], v[96:111]
    s_add_u32 s7, s7, s99
    s_cmp_eq_u32 s98, 2
    s_cselect_b64 s[100:101], -1, 0
    s_lshl_b32 s6, s86, 5
    ds_read_b64_tr_b16 a[184:185], v14 offset:32768
    ds_read_b64_tr_b16 a[186:187], v14 offset:33280
    global_load_lds_dwordx4 v9, s[12:13] offset:1024
    v_mfma_f32_32x32x16_bf16 v[112:127], a[28:31], a[196:199], v[112:127]
    s_add_u32 s6, s6, 4
    s_cmp_lt_u32 s86, 48
    s_cselect_b32 s6, s6, s7
    s_cselect_b64 s[100:101], 0, s[100:101]
    s_mul_i32 s6, s6, 1280
    ds_read_b64_tr_b16 a[188:189], v15 offset:32768
    ds_read_b64_tr_b16 a[190:191], v15 offset:33280
    v_mfma_f32_32x32x16_bf16 v[128:143], a[28:31], a[160:163], v[128:143]
    s_lshl_b32 s7, s87, 7
    s_add_u32 s99, s3, 4
    s_min_u32 s99, s99, 10
    s_lshl_b32 s99, s99, 21
    ds_read_b64_tr_b16 a[192:193], v14 offset:34816
    ds_read_b64_tr_b16 a[194:195], v14 offset:35328
    global_load_lds_dwordx4 v8, s[14:15] offset:2048
    v_mfma_f32_32x32x16_bf16 v[144:159], a[28:31], a[164:167], v[144:159]
    s_waitcnt lgkmcnt(6)
    s_load_dword s58, s[82:83], s99
    s_add_u32 s92, s6, s7
    ds_read_b64_tr_b16 a[196:197], v15 offset:34816
    ds_read_b64_tr_b16 a[198:199], v15 offset:35328
    v_cndmask_b32 v20, v75, v76, s[100:101]
    v_mfma_f32_32x32x16_bf16 v[96:111], a[32:35], a[168:171], v[96:111]
    s_lshl_b32 s6, s86, 2
    s_sub_u32 s6, s6, 190
    ds_read_b64_tr_b16 a[160:161], v6 offset:32768
    ds_read_b64_tr_b16 a[162:163], v6 offset:33280
    global_load_lds_dwordx4 v9, s[14:15] offset:3072
    v_add_u32 v8, 245760, v8
    v_add_u32 v9, 245760, v9
    v_mfma_f32_32x32x16_bf16 v[112:127], a[32:35], a[172:175], v[112:127]
    s_mov_b32 m0, s62
    ds_read_b64_tr_b16 a[164:165], v7 offset:32768
    ds_read_b64_tr_b16 a[166:167], v7 offset:33280
    s_mov_b64 exec, 7
    global_load_dword a210, v46, s[72:73]
    global_load_dword a210, v46, s[74:75]
    s_mov_b64 exec, -1
    v_add_u32 v46, 393216, v46
    v_smfmac_f32_16x16x64_bf16 a[216:219], a[242:245], a[168:175], v17
    v_mfma_f32_32x32x16_bf16 v[128:143], a[32:35], a[176:179], v[128:143]
    s_waitcnt vmcnt(16)
    s_mul_i32 s7, s6, 205
    ds_read_b64_tr_b16 a[168:169], v6 offset:34816
    ds_read_b64_tr_b16 a[170:171], v6 offset:35328
    ds_read_b128 v[160:163], v92 offset:32768
    ds_read_b128 v[164:167], v93 offset:32768
    global_load_lds_dwordx4 v84, s[44:45] offset:0
    v_mfma_f32_32x32x16_bf16 v[144:159], a[32:35], a[180:183], v[144:159]
    s_waitcnt lgkmcnt(8)
    s_lshr_b32 s7, s7, 10
    s_mul_i32 s98, s7, 5
    s_sub_u32 s98, s6, s98
    s_mul_i32 s7, s7, 40
    ds_read_b64_tr_b16 a[172:173], v7 offset:34816
    ds_read_b64_tr_b16 a[174:175], v7 offset:35328
    ds_read_b128 v[168:171], v94 offset:32768
    ds_read_b128 v[172:175], v95 offset:32768
    v_smfmac_f32_16x16x64_bf16 a[220:223], a[242:245], a[176:183], v17
    v_mfma_f32_32x32x16_bf16 v[96:111], a[36:39], a[184:187], v[96:111]
    s_lshl2_add_u32 s7, s98, s7
    s_cmp_ge_u32 s98, 2
    s_cselect_b32 s99, 8, 0
    ds_read_b64_tr_b16 a[176:177], v2 offset:32768
    ds_read_b64_tr_b16 a[178:179], v2 offset:33280
    ds_read_b128 a[48:51], v92 offset:32768
    global_load_lds_dwordx4 v85, s[44:45] offset:1024
    v_mfma_f32_32x32x16_bf16 v[112:127], a[36:39], a[188:191], v[112:127]
    s_add_u32 s7, s7, s99
    s_cmp_eq_u32 s98, 2
    s_cselect_b64 s[100:101], -1, 0
    s_lshl_b32 s6, s86, 5
    s_add_u32 s6, s6, 16
    ds_read_b64_tr_b16 a[180:181], v3 offset:32768
    ds_read_b64_tr_b16 a[182:183], v3 offset:33280
    v_mfma_f32_32x32x16_bf16 v[128:143], a[36:39], a[192:195], v[128:143]
    s_cmp_lt_u32 s86, 48
    s_cselect_b32 s6, s6, s7
    s_cselect_b64 s[100:101], 0, s[100:101]
    ds_read_b64_tr_b16 a[184:185], v2 offset:34816
    ds_read_b64_tr_b16 a[186:187], v2 offset:35328
    ds_read_b128 a[52:55], v93 offset:32768
    global_load_lds_dwordx4 v86, s[44:45] offset:2048
    v_mfma_f32_32x32x16_bf16 v[144:159], a[36:39], a[196:199], v[144:159]
    s_waitcnt lgkmcnt(10)
    s_mul_i32 s6, s6, 1280
    s_add_u32 s99, s3, 8
    s_min_u32 s99, s99, 10
    s_lshl_b32 s99, s99, 21
    ds_read_b64_tr_b16 a[188:189], v3 offset:34816
    ds_read_b64_tr_b16 a[190:191], v3 offset:35328
    s_waitcnt lgkmcnt(10)
    v_smfmac_f32_16x16x64_bf16 a[250:253], a[242:245], v[160:167], v17
    v_smfmac_f32_16x16x64_bf16 a[250:253], a[242:245], v[168:175], v17
    v_dot2_f32_bf16 v34, v160, v160, v34
    v_dot2_f32_bf16 v35, v161, v161, v35
    v_dot2_f32_bf16 v36, v162, v162, v36
    v_dot2_f32_bf16 v37, v163, v163, v37
    v_dot2_f32_bf16 v34, v164, v164, v34
    v_dot2_f32_bf16 v35, v165, v165, v35
    v_dot2_f32_bf16 v36, v166, v166, v36
    v_dot2_f32_bf16 v37, v167, v167, v37
    v_dot2_f32_bf16 v34, v168, v168, v34
    v_dot2_f32_bf16 v35, v169, v169, v35
    v_dot2_f32_bf16 v36, v170, v170, v36
    v_dot2_f32_bf16 v37, v171, v171, v37
    v_dot2_f32_bf16 v34, v172, v172, v34
    v_dot2_f32_bf16 v35, v173, v173, v35
    v_dot2_f32_bf16 v36, v174, v174, v36
    v_dot2_f32_bf16 v37, v175, v175, v37
    v_mfma_f32_32x32x16_bf16 v[96:111], a[40:43], a[160:163], v[96:111]
    s_waitcnt vmcnt(15)
    s_barrier
    ds_read_b64_tr_b16 a[192:193], v12 offset:49152
    ds_read_b64_tr_b16 a[194:195], v12 offset:49664
    ds_read_b128 a[56:59], v94 offset:32768
    v_mfma_f32_32x32x16_bf16 v[112:127], a[40:43], a[164:167], v[112:127]
    s_load_dword s58, s[82:83], s99
    ds_read_b64_tr_b16 a[196:197], v13 offset:49152
    ds_read_b64_tr_b16 a[198:199], v13 offset:49664
    global_load_lds_dwordx4 v87, s[44:45] offset:3072
    v_add_u32 v84, 128, v84
    v_add_u32 v85, 128, v85
    v_add_u32 v86, 128, v86
    v_mfma_f32_32x32x16_bf16 v[128:143], a[40:43], a[168:171], v[128:143]
    s_lshl_b32 s7, s87, 7
    s_add_u32 s93, s6, s7
    ds_read_b64_tr_b16 a[160:161], v12 offset:51200
    ds_read_b64_tr_b16 a[162:163], v12 offset:51712
    ds_read_b128 a[60:63], v95 offset:32768
    v_xor_b32 v12, 0x10000, v12
    v_add_u32 v87, 128, v87
    v_mfma_f32_32x32x16_bf16 v[144:159], a[40:43], a[172:175], v[144:159]
    s_waitcnt lgkmcnt(8)
    s_mov_b32 m0, s52
    ds_read_b64_tr_b16 a[164:165], v13 offset:51200
    ds_read_b64_tr_b16 a[166:167], v13 offset:51712
    global_load_lds_dwordx4 v8, s[12:13] offset:0
    v_xor_b32 v13, 0x10000, v13
    v_cndmask_b32 v21, v75, v76, s[100:101]
    v_mfma_f32_32x32x16_bf16 v[96:111], a[44:47], a[176:179], v[96:111]
    s_lshl_b32 s6, s86, 2
    s_sub_u32 s6, s6, 189
    s_mul_i32 s7, s6, 205
    s_lshr_b32 s7, s7, 10
    s_mul_i32 s98, s7, 5
    ds_read_b64_tr_b16 a[168:169], v14 offset:49152
    ds_read_b64_tr_b16 a[170:171], v14 offset:49664
    v_mfma_f32_32x32x16_bf16 v[112:127], a[44:47], a[180:183], v[112:127]
    s_sub_u32 s98, s6, s98
    s_mul_i32 s7, s7, 40
    s_lshl2_add_u32 s7, s98, s7
    s_cmp_ge_u32 s98, 2
    ds_read_b64_tr_b16 a[172:173], v15 offset:49152
    ds_read_b64_tr_b16 a[174:175], v15 offset:49664
    global_load_lds_dwordx4 v9, s[12:13] offset:1024
    v_mfma_f32_32x32x16_bf16 v[128:143], a[44:47], a[184:187], v[128:143]
    s_cselect_b32 s99, 8, 0
    s_add_u32 s7, s7, s99
    s_cmp_eq_u32 s98, 2
    s_cselect_b64 s[100:101], -1, 0
    ds_read_b64_tr_b16 a[176:177], v14 offset:51200
    ds_read_b64_tr_b16 a[178:179], v14 offset:51712
    v_xor_b32 v14, 0x10000, v14
    v_mfma_f32_32x32x16_bf16 v[144:159], a[44:47], a[188:191], v[144:159]
    s_waitcnt lgkmcnt(6)
    s_lshl_b32 s6, s86, 5
    s_add_u32 s6, s6, 20
    ds_read_b64_tr_b16 a[180:181], v15 offset:51200
    ds_read_b64_tr_b16 a[182:183], v15 offset:51712
    global_load_lds_dwordx4 v8, s[14:15] offset:2048
    v_xor_b32 v15, 0x10000, v15
    v_mfma_f32_32x32x16_bf16 v[96:111], a[48:51], a[192:195], v[96:111]
    s_cmp_lt_u32 s86, 48
    s_cselect_b32 s6, s6, s7
    s_cselect_b64 s[100:101], 0, s[100:101]
    s_mov_b32 s99, 0x200000
    ds_read_b64_tr_b16 a[184:185], v6 offset:49152
    ds_read_b64_tr_b16 a[186:187], v6 offset:49664
    v_mfma_f32_32x32x16_bf16 v[112:127], a[48:51], a[196:199], v[112:127]
    ds_read_b64_tr_b16 a[188:189], v7 offset:49152
    ds_read_b64_tr_b16 a[190:191], v7 offset:49664
    global_load_lds_dwordx4 v9, s[14:15] offset:3072
    v_add_u32 v8, 245760, v8
    v_add_u32 v9, 245760, v9
    s_mov_b64 exec, 7
    global_load_dword a210, v46, s[72:73]
    global_load_dword a210, v46, s[74:75]
    s_mov_b64 exec, -1
    v_add_u32 v46, 393216, v46
    v_smfmac_f32_16x16x64_bf16 a[216:219], a[242:245], a[192:199], v17
    v_mfma_f32_32x32x16_bf16 v[128:143], a[48:51], a[160:163], v[128:143]
    s_waitcnt vmcnt(16)
    s_mov_b32 m0, s53
    ds_read_b64_tr_b16 a[192:193], v6 offset:51200
    ds_read_b64_tr_b16 a[194:195], v6 offset:51712
    ds_read_b128 v[160:163], v92 offset:16384
    ds_read_b128 v[164:167], v93 offset:16384
    v_xor_b32 v6, 0x10000, v6
    v_mfma_f32_32x32x16_bf16 v[144:159], a[48:51], a[164:167], v[144:159]
    s_waitcnt lgkmcnt(8)
    s_load_dword s58, s[78:79], s99
    s_mul_i32 s6, s6, 1280
    ds_read_b64_tr_b16 a[196:197], v7 offset:51200
    ds_read_b64_tr_b16 a[198:199], v7 offset:51712
    ds_read_b128 v[168:171], v94 offset:16384
    ds_read_b128 v[172:175], v95 offset:16384
    global_load_lds_dwordx4 v84, s[44:45] offset:0
    v_smfmac_f32_16x16x64_bf16 a[220:223], a[242:245], a[160:167], v17
    v_xor_b32 v7, 0x10000, v7
    v_mfma_f32_32x32x16_bf16 v[96:111], a[52:55], a[168:171], v[96:111]
    s_lshl_b32 s7, s87, 7
    s_add_u32 s94, s6, s7
    ds_read_b64_tr_b16 a[160:161], v2 offset:49152
    ds_read_b64_tr_b16 a[162:163], v2 offset:49664
    ds_read_b128 a[64:67], v92 offset:16384
    v_cndmask_b32 v22, v75, v76, s[100:101]
    v_mfma_f32_32x32x16_bf16 v[112:127], a[52:55], a[172:175], v[112:127]
    s_add_u32 s54, s42, 147456
    ds_read_b64_tr_b16 a[164:165], v3 offset:49152
    ds_read_b64_tr_b16 a[166:167], v3 offset:49664
    global_load_lds_dwordx4 v85, s[44:45] offset:1024
    v_lshrrev_b32 v74, 4, v1
    v_lshlrev_b32 v74, 10, v74
    v_and_b32 v75, 15, v1
    v_mfma_f32_32x32x16_bf16 v[128:143], a[52:55], a[176:179], v[128:143]
    ds_read_b64_tr_b16 a[168:169], v2 offset:51200
    ds_read_b64_tr_b16 a[170:171], v2 offset:51712
    ds_read_b128 a[68:71], v93 offset:16384
    v_xor_b32 v2, 0x10000, v2
    v_lshrrev_b32 v76, 2, v75
    v_lshl_add_u32 v74, v76, 7, v74
    v_mfma_f32_32x32x16_bf16 v[144:159], a[52:55], a[180:183], v[144:159]
    s_waitcnt lgkmcnt(10)
    ds_read_b64_tr_b16 a[172:173], v3 offset:51200
    ds_read_b64_tr_b16 a[174:175], v3 offset:51712
    global_load_lds_dwordx4 v86, s[44:45] offset:2048
    v_xor_b32 v3, 0x10000, v3
    v_and_b32 v75, 3, v75
    v_lshl_add_u32 v74, v75, 3, v74
    s_waitcnt lgkmcnt(10)
    v_smfmac_f32_16x16x64_bf16 a[250:253], a[242:245], v[160:167], v17
    v_smfmac_f32_16x16x64_bf16 a[250:253], a[242:245], v[168:175], v17
    v_dot2_f32_bf16 v34, v160, v160, v34
    v_dot2_f32_bf16 v35, v161, v161, v35
    v_dot2_f32_bf16 v36, v162, v162, v36
    v_dot2_f32_bf16 v37, v163, v163, v37
    v_dot2_f32_bf16 v34, v164, v164, v34
    v_dot2_f32_bf16 v35, v165, v165, v35
    v_dot2_f32_bf16 v36, v166, v166, v36
    v_dot2_f32_bf16 v37, v167, v167, v37
    v_dot2_f32_bf16 v34, v168, v168, v34
    v_dot2_f32_bf16 v35, v169, v169, v35
    v_dot2_f32_bf16 v36, v170, v170, v36
    v_dot2_f32_bf16 v37, v171, v171, v37
    v_dot2_f32_bf16 v34, v172, v172, v34
    v_dot2_f32_bf16 v35, v173, v173, v35
    v_dot2_f32_bf16 v36, v174, v174, v36
    v_dot2_f32_bf16 v37, v175, v175, v37
    v_mfma_f32_32x32x16_bf16 v[96:111], a[56:59], a[184:187], v[96:111]
    s_waitcnt vmcnt(15)
    s_barrier
    ds_read_b64_tr_b16 a[176:177], v12 offset:0
    ds_read_b64_tr_b16 a[178:179], v12 offset:512
    ds_read_b128 a[72:75], v94 offset:16384
    v_mfma_f32_32x32x16_bf16 v[112:127], a[56:59], a[188:191], v[112:127]
    ds_read_b64_tr_b16 a[180:181], v13 offset:0
    ds_read_b64_tr_b16 a[182:183], v13 offset:512
    global_load_lds_dwordx4 v87, s[44:45] offset:3072
    v_add_u32 v84, 128, v84
    v_add_u32 v85, 128, v85
    v_add_u32 v86, 128, v86
    v_mfma_f32_32x32x16_bf16 v[128:143], a[56:59], a[192:195], v[128:143]
    ds_read_b64_tr_b16 a[184:185], v12 offset:2048
    ds_read_b64_tr_b16 a[186:187], v12 offset:2560
    ds_read_b128 a[76:79], v95 offset:16384
    v_add_u32 v87, 128, v87
    v_add_u32 v24, s54, v74
    v_mfma_f32_32x32x16_bf16 v[144:159], a[56:59], a[196:199], v[144:159]
    s_waitcnt lgkmcnt(8)
    s_mov_b32 m0, s47
    s_lshl_b32 s88, s4, 2
    s_lshr_b32 s98, s5, 3
    ds_read_b64_tr_b16 a[188:189], v13 offset:2048
    ds_read_b64_tr_b16 a[190:191], v13 offset:2560
    global_load_lds_dwordx4 v8, s[12:13] offset:0
    v_mfma_f32_32x32x16_bf16 v[96:111], a[60:63], a[160:163], v[96:111]
    s_add_u32 s88, s88, s98
    s_and_b32 s89, s5, 7
    s_and_b32 s90, s3, 1
    s_lshr_b32 s98, s88, 1
    s_mul_i32 s98, s98, 5
    ds_read_b64_tr_b16 a[192:193], v14 offset:0
    ds_read_b64_tr_b16 a[194:195], v14 offset:512
    v_mfma_f32_32x32x16_bf16 v[112:127], a[60:63], a[164:167], v[112:127]
    s_and_b32 s99, s88, 1
    s_mul_i32 s100, s99, 3
    s_add_u32 s100, s100, s98
    s_lshl_b32 s100, s100, 15
    ds_read_b64_tr_b16 a[196:197], v15 offset:0
    ds_read_b64_tr_b16 a[198:199], v15 offset:512
    global_load_lds_dwordx4 v9, s[12:13] offset:1024
    v_mfma_f32_32x32x16_bf16 v[128:143], a[60:63], a[168:171], v[128:143]
    s_add_u32 s98, s98, 2
    s_lshl_b32 s98, s98, 15
    s_lshl_b32 s99, s99, 3
    s_add_u32 s99, s99, s98
    s_mul_i32 s98, s88, 81920
    ds_read_b64_tr_b16 a[160:161], v14 offset:2048
    ds_read_b64_tr_b16 a[162:163], v14 offset:2560
    v_mfma_f32_32x32x16_bf16 v[144:159], a[60:63], a[172:175], v[144:159]
    s_waitcnt lgkmcnt(6)
    ds_read_b64_tr_b16 a[164:165], v15 offset:2048
    ds_read_b64_tr_b16 a[166:167], v15 offset:2560
    global_load_lds_dwordx4 v8, s[14:15] offset:2048
    v_lshrrev_b32 v44, 5, v1
    v_and_b32 v45, 31, v1
    v_lshlrev_b32 v47, 4, v45
    v_mfma_f32_32x32x16_bf16 v[96:111], a[64:67], a[176:179], v[96:111]
    ds_read_b64_tr_b16 a[168:169], v6 offset:0
    ds_read_b64_tr_b16 a[170:171], v6 offset:512
    v_lshrrev_b32 v30, 1, v45
    v_lshl_add_u32 v59, v44, 15, v47
    v_xor_b32 v30, v30, v45
    v_add_u32 v59, s100, v59
    v_mfma_f32_32x32x16_bf16 v[112:127], a[64:67], a[180:183], v[112:127]
    ds_read_b64_tr_b16 a[172:173], v7 offset:0
    ds_read_b64_tr_b16 a[174:175], v7 offset:512
    global_load_lds_dwordx4 v9, s[14:15] offset:3072
    v_add_u32 v8, 245760, v8
    v_add_u32 v9, 245760, v9
    s_mov_b64 exec, 7
    global_load_dword a210, v46, s[72:73]
    global_load_dword a210, v46, s[74:75]
    s_mov_b64 exec, -1
    v_add_u32 v46, 393216, v46
    v_smfmac_f32_16x16x64_bf16 a[216:219], a[242:245], a[176:183], v17
    v_mfma_f32_32x32x16_bf16 v[128:143], a[64:67], a[184:187], v[128:143]
    s_waitcnt vmcnt(16)
    s_mov_b32 m0, s63
    ds_read_b64_tr_b16 a[176:177], v6 offset:2048
    ds_read_b64_tr_b16 a[178:179], v6 offset:2560
    ds_read_b128 v[160:163], v92 offset:0
    ds_read_b128 v[164:167], v93 offset:0
    v_and_b32 v30, 4, v30
    v_mfma_f32_32x32x16_bf16 v[144:159], a[64:67], a[188:191], v[144:159]
    s_waitcnt lgkmcnt(8)
    ds_read_b64_tr_b16 a[180:181], v7 offset:2048
    ds_read_b64_tr_b16 a[182:183], v7 offset:2560
    ds_read_b128 v[168:171], v94 offset:0
    ds_read_b128 v[172:175], v95 offset:0
    global_load_lds_dwordx4 v84, s[44:45] offset:0
    v_smfmac_f32_16x16x64_bf16 a[220:223], a[242:245], a[184:191], v17
    v_add_u32 v47, s99, v47
    v_mul_u32_u24 v30, 48, v30
    v_cmp_eq_u32 vcc, 0, v44
    v_mfma_f32_32x32x16_bf16 v[96:111], a[68:71], a[192:195], v[96:111]
    ds_read_b64_tr_b16 a[184:185], v2 offset:0
    ds_read_b64_tr_b16 a[186:187], v2 offset:512
    ds_read_b128 a[80:83], v92 offset:0
    v_xor_b32 v48, v59, v30
    v_xor_b32 v50, v47, v30
    v_mov_b32 v30, 5242880
    v_mfma_f32_32x32x16_bf16 v[112:127], a[68:71], a[196:199], v[112:127]
    ds_read_b64_tr_b16 a[188:189], v3 offset:0
    ds_read_b64_tr_b16 a[190:191], v3 offset:512
    global_load_lds_dwordx4 v85, s[44:45] offset:1024
    v_mov_b32 v51, 7864336
    v_mov_b32 v63, 0xdddd
    v_cndmask_b32 v50, v30, v50, vcc
    v_mfma_f32_32x32x16_bf16 v[128:143], a[68:71], a[160:163], v[128:143]
    ds_read_b64_tr_b16 a[192:193], v2 offset:2048
    ds_read_b64_tr_b16 a[194:195], v2 offset:2560
    ds_read_b128 a[84:87], v93 offset:0
    v_cndmask_b32 v51, v51, v47, vcc
    v_lshrrev_b32 v47, 2, v45
    v_lshlrev_b32 v47, 14, v47
    v_mfma_f32_32x32x16_bf16 v[144:159], a[68:71], a[164:167], v[144:159]
    s_waitcnt lgkmcnt(10)
    ds_read_b64_tr_b16 a[196:197], v3 offset:2048
    ds_read_b64_tr_b16 a[198:199], v3 offset:2560
    global_load_lds_dwordx4 v86, s[44:45] offset:2048
    v_add_u32 v47, s98, v47
    v_and_b32 v30, 3, v45
    v_lshlrev_b32 v30, 4, v30
    s_waitcnt lgkmcnt(10)
    v_smfmac_f32_16x16x64_bf16 a[250:253], a[242:245], v[160:167], v17
    v_smfmac_f32_16x16x64_bf16 a[250:253], a[242:245], v[168:175], v17
    v_dot2_f32_bf16 v34, v160, v160, v34
    v_dot2_f32_bf16 v35, v161, v161, v35
    v_dot2_f32_bf16 v36, v162, v162, v36
    v_dot2_f32_bf16 v37, v163, v163, v37
    v_dot2_f32_bf16 v34, v164, v164, v34
    v_dot2_f32_bf16 v35, v165, v165, v35
    v_dot2_f32_bf16 v36, v166, v166, v36
    v_dot2_f32_bf16 v37, v167, v167, v37
    v_dot2_f32_bf16 v34, v168, v168, v34
    v_dot2_f32_bf16 v35, v169, v169, v35
    v_dot2_f32_bf16 v36, v170, v170, v36
    v_dot2_f32_bf16 v37, v171, v171, v37
    v_dot2_f32_bf16 v34, v172, v172, v34
    v_dot2_f32_bf16 v35, v173, v173, v35
    v_dot2_f32_bf16 v36, v174, v174, v36
    v_dot2_f32_bf16 v37, v175, v175, v37
    v_mfma_f32_32x32x16_bf16 v[96:111], a[72:75], a[168:171], v[96:111]
    s_waitcnt vmcnt(15)
    s_barrier
    ds_read_b64_tr_b16 a[160:161], v12 offset:16384
    ds_read_b64_tr_b16 a[162:163], v12 offset:16896
    ds_read_b128 a[88:91], v94 offset:0
    v_mfma_f32_32x32x16_bf16 v[112:127], a[72:75], a[172:175], v[112:127]
    ds_read_b64_tr_b16 a[164:165], v13 offset:16384
    ds_read_b64_tr_b16 a[166:167], v13 offset:16896
    global_load_lds_dwordx4 v87, s[44:45] offset:3072
    v_add_u32 v84, 128, v84
    v_add_u32 v85, 128, v85
    v_add_u32 v86, 128, v86
    v_mfma_f32_32x32x16_bf16 v[128:143], a[72:75], a[176:179], v[128:143]
    ds_read_b64_tr_b16 a[168:169], v12 offset:18432
    ds_read_b64_tr_b16 a[170:171], v12 offset:18944
    ds_read_b128 a[92:95], v95 offset:0
    v_xor_b32 v12, 0x10000, v12
    v_add_u32 v87, 128, v87
    v_lshl_add_u32 v30, v44, 6, v30
    v_mfma_f32_32x32x16_bf16 v[144:159], a[72:75], a[180:183], v[144:159]
    s_waitcnt lgkmcnt(8)
    s_mov_b32 m0, s48
    ds_read_b64_tr_b16 a[172:173], v13 offset:18432
    ds_read_b64_tr_b16 a[174:175], v13 offset:18944
    global_load_lds_dwordx4 v8, s[12:13] offset:0
    v_xor_b32 v13, 0x10000, v13
    v_add_u32 v47, v47, v30
    v_mfma_f32_32x32x16_bf16 v[96:111], a[76:79], a[184:187], v[96:111]
    ds_read_b64_tr_b16 a[176:177], v14 offset:16384
    ds_read_b64_tr_b16 a[178:179], v14 offset:16896
    v_mov_b32 v30, 2621456
    v_cmp_gt_u32 vcc, 20, v45
    v_mfma_f32_32x32x16_bf16 v[112:127], a[76:79], a[188:191], v[112:127]
    s_lshl_b32 s98, s90, 14
    s_add_u32 s99, s98, 2625536
    s_lshr_b32 s98, s98, 1
    ds_read_b64_tr_b16 a[180:181], v15 offset:16384
    ds_read_b64_tr_b16 a[182:183], v15 offset:16896
    global_load_lds_dwordx4 v9, s[12:13] offset:1024
    v_cndmask_b32 v47, v30, v47, vcc
    v_mfma_f32_32x32x16_bf16 v[128:143], a[76:79], a[192:195], v[128:143]
    ds_read_b64_tr_b16 a[184:185], v14 offset:18432
    ds_read_b64_tr_b16 a[186:187], v14 offset:18944
    v_xor_b32 v14, 0x10000, v14
    v_mov_b32 v30, 2621440
    v_cmp_eq_u32 vcc, 20, v45
    v_mfma_f32_32x32x16_bf16 v[144:159], a[76:79], a[196:199], v[144:159]
    s_waitcnt lgkmcnt(6)
    s_add_u32 s64, s24, s99
    s_addc_u32 s65, s25, 0
    ds_read_b64_tr_b16 a[188:189], v15 offset:18432
    ds_read_b64_tr_b16 a[190:191], v15 offset:18944
    global_load_lds_dwordx4 v8, s[14:15] offset:2048
    v_xor_b32 v15, 0x10000, v15
    v_mfma_f32_32x32x16_bf16 v[96:111], a[80:83], a[160:163], v[96:111]
    ds_read_b64_tr_b16 a[192:193], v6 offset:16384
    ds_read_b64_tr_b16 a[194:195], v6 offset:16896
    v_cndmask_b32 v52, v47, v30, vcc
    v_mfma_f32_32x32x16_bf16 v[112:127], a[80:83], a[164:167], v[112:127]
    ds_read_b64_tr_b16 a[196:197], v7 offset:16384
    ds_read_b64_tr_b16 a[198:199], v7 offset:16896
    global_load_lds_dwordx4 v9, s[14:15] offset:3072
    v_add_u32 v8, 245760, v8
    v_add_u32 v9, 245760, v9
    s_mov_b64 exec, 7
    global_load_dword a210, v46, s[72:73]
    global_load_dword a210, v46, s[74:75]
    s_mov_b64 exec, -1
    v_add_u32 v46, 393216, v46
    v_smfmac_f32_16x16x64_bf16 a[216:219], a[242:245], a[160:167], v17
    v_mfma_f32_32x32x16_bf16 v[128:143], a[80:83], a[168:171], v[128:143]
    s_waitcnt vmcnt(16)
    s_mov_b32 m0, s62
    ds_read_b64_tr_b16 a[160:161], v6 offset:18432
    ds_read_b64_tr_b16 a[162:163], v6 offset:18944
    ds_read_b128 v[160:163], v92 offset:32768
    ds_read_b128 v[164:167], v93 offset:32768
    v_xor_b32 v6, 0x10000, v6
    v_mfma_f32_32x32x16_bf16 v[144:159], a[80:83], a[172:175], v[144:159]
    s_waitcnt lgkmcnt(8)
    s_add_u32 s99, s98, 5246976
    s_add_u32 s66, s24, s99
    ds_read_b64_tr_b16 a[164:165], v7 offset:18432
    ds_read_b64_tr_b16 a[166:167], v7 offset:18944
    ds_read_b128 v[168:171], v94 offset:32768
    ds_read_b128 v[172:175], v95 offset:32768
    global_load_lds_dwordx4 v84, s[44:45] offset:0
    v_smfmac_f32_16x16x64_bf16 a[220:223], a[242:245], a[168:175], v17
    v_xor_b32 v7, 0x10000, v7
    v_mfma_f32_32x32x16_bf16 v[96:111], a[84:87], a[176:179], v[96:111]
    s_addc_u32 s67, s25, 0
    s_lshl_b32 s98, s89, 1
    s_lshr_b32 s99, s3, 1
    s_add_u32 s98, s98, s99
    ds_read_b64_tr_b16 a[168:169], v2 offset:16384
    ds_read_b64_tr_b16 a[170:171], v2 offset:16896
    ds_read_b128 a[96:99], v92 offset:32768
    v_mfma_f32_32x32x16_bf16 v[112:127], a[84:87], a[180:183], v[112:127]
    s_lshl_b32 s98, s98, 11
    s_lshl_b32 s99, s90, 10
    s_add_u32 s100, s98, s99
    s_add_u32 s68, s24, s100
    ds_read_b64_tr_b16 a[172:173], v3 offset:16384
    ds_read_b64_tr_b16 a[174:175], v3 offset:16896
    global_load_lds_dwordx4 v85, s[44:45] offset:1024
    v_mfma_f32_32x32x16_bf16 v[128:143], a[84:87], a[184:187], v[128:143]
    s_addc_u32 s69, s25, 0
    s_xor_b32 s46, s100, 1024
    s_lshr_b32 s99, s88, 1
    ds_read_b64_tr_b16 a[176:177], v2 offset:18432
    ds_read_b64_tr_b16 a[178:179], v2 offset:18944
    ds_read_b128 a[100:103], v93 offset:32768
    v_xor_b32 v2, 0x10000, v2
    v_mfma_f32_32x32x16_bf16 v[144:159], a[84:87], a[188:191], v[144:159]
    s_waitcnt lgkmcnt(10)
    s_mul_i32 s99, s99, 163840
    s_add_u32 s77, s100, s99
    ds_read_b64_tr_b16 a[180:181], v3 offset:18432
    ds_read_b64_tr_b16 a[182:183], v3 offset:18944
    global_load_lds_dwordx4 v86, s[44:45] offset:2048
    v_xor_b32 v3, 0x10000, v3
    s_waitcnt lgkmcnt(10)
    v_smfmac_f32_16x16x64_bf16 a[250:253], a[242:245], v[160:167], v17
    v_smfmac_f32_16x16x64_bf16 a[250:253], a[242:245], v[168:175], v17
    v_dot2_f32_bf16 v34, v160, v160, v34
    v_dot2_f32_bf16 v35, v161, v161, v35
    v_dot2_f32_bf16 v36, v162, v162, v36
    v_dot2_f32_bf16 v37, v163, v163, v37
    v_dot2_f32_bf16 v34, v164, v164, v34
    v_dot2_f32_bf16 v35, v165, v165, v35
    v_dot2_f32_bf16 v36, v166, v166, v36
    v_dot2_f32_bf16 v37, v167, v167, v37
    v_dot2_f32_bf16 v34, v168, v168, v34
    v_dot2_f32_bf16 v35, v169, v169, v35
    v_dot2_f32_bf16 v36, v170, v170, v36
    v_dot2_f32_bf16 v37, v171, v171, v37
    v_dot2_f32_bf16 v34, v172, v172, v34
    v_dot2_f32_bf16 v35, v173, v173, v35
    v_dot2_f32_bf16 v36, v174, v174, v36
    v_dot2_f32_bf16 v37, v175, v175, v37
    v_mfma_f32_32x32x16_bf16 v[96:111], a[88:91], a[192:195], v[96:111]
    s_waitcnt vmcnt(15)
    s_barrier
    ds_read_b64_tr_b16 a[184:185], v12 offset:0
    ds_read_b64_tr_b16 a[186:187], v12 offset:512
    ds_read_b128 a[104:107], v94 offset:32768
    v_mfma_f32_32x32x16_bf16 v[112:127], a[88:91], a[196:199], v[112:127]
    s_add_u32 s77, s77, 8388608
    ds_read_b64_tr_b16 a[188:189], v13 offset:0
    ds_read_b64_tr_b16 a[190:191], v13 offset:512
    global_load_lds_dwordx4 v87, s[44:45] offset:3072
    v_add_u32 v84, 128, v84
    v_add_u32 v85, 128, v85
    v_add_u32 v86, 128, v86
    v_mfma_f32_32x32x16_bf16 v[128:143], a[88:91], a[160:163], v[128:143]
    s_and_b32 s99, s88, 1
    s_lshl3_add_u32 s83, s99, s77
    s_mul_i32 s99, s99, 98304
    ds_read_b64_tr_b16 a[192:193], v12 offset:2048
    ds_read_b64_tr_b16 a[194:195], v12 offset:2560
    ds_read_b128 a[108:111], v95 offset:32768
    v_add_u32 v87, 128, v87
    v_mfma_f32_32x32x16_bf16 v[144:159], a[88:91], a[164:167], v[144:159]
    s_waitcnt lgkmcnt(8)
    s_mov_b32 m0, s49
    s_add_u32 s77, s77, s99
    s_add_u32 s70, s24, s46
    ds_read_b64_tr_b16 a[196:197], v13 offset:2048
    ds_read_b64_tr_b16 a[198:199], v13 offset:2560
    global_load_lds_dwordx4 v8, s[12:13] offset:0
    v_mfma_f32_32x32x16_bf16 v[96:111], a[92:95], a[168:171], v[96:111]
    s_addc_u32 s71, s25, 0
    s_lshr_b32 s98, s4, 1
    s_lshl_b32 s98, s98, 3
    s_add_u32 s81, s98, s89
    s_and_b32 s98, s4, 1
    ds_read_b64_tr_b16 a[160:161], v14 offset:0
    ds_read_b64_tr_b16 a[162:163], v14 offset:512
    v_mfma_f32_32x32x16_bf16 v[112:127], a[92:95], a[172:175], v[112:127]
    s_lshl_b32 s98, s98, 2
    s_lshr_b32 s99, s5, 3
    s_add_u32 s82, s98, s99
    ds_read_b64_tr_b16 a[164:165], v15 offset:0
    ds_read_b64_tr_b16 a[166:167], v15 offset:512
    global_load_lds_dwordx4 v9, s[12:13] offset:1024
    v_lshlrev_b32 v47, 4, v45
    v_mfma_f32_32x32x16_bf16 v[128:143], a[92:95], a[176:179], v[128:143]
    ds_read_b64_tr_b16 a[168:169], v14 offset:2048
    ds_read_b64_tr_b16 a[170:171], v14 offset:2560
    v_lshl_add_u32 v58, v44, 15, v47
    v_lshlrev_b32 v53, 4, v1
    v_lshrrev_b32 v47, 4, v1
    v_and_b32 v30, 15, v1
    v_mfma_f32_32x32x16_bf16 v[144:159], a[92:95], a[180:183], v[144:159]
    s_waitcnt lgkmcnt(6)
    ds_read_b64_tr_b16 a[172:173], v15 offset:2048
    ds_read_b64_tr_b16 a[174:175], v15 offset:2560
    global_load_lds_dwordx4 v8, s[14:15] offset:2048
    v_lshlrev_b32 v30, 4, v30
    v_lshl_add_u32 v49, v47, 15, v30
    v_mfma_f32_32x32x16_bf16 v[96:111], a[96:99], a[184:187], v[96:111]
    s_mul_i32 s98, s3, 40960
    ds_read_b64_tr_b16 a[176:177], v6 offset:0
    ds_read_b64_tr_b16 a[178:179], v6 offset:512
    v_add_u32 v60, s98, v53
    v_mfma_f32_32x32x16_bf16 v[112:127], a[96:99], a[188:191], v[112:127]
    ds_read_b64_tr_b16 a[180:181], v7 offset:0
    ds_read_b64_tr_b16 a[182:183], v7 offset:512
    global_load_lds_dwordx4 v9, s[14:15] offset:3072
    v_add_u32 v8, 245760, v8
    v_add_u32 v9, 245760, v9
    s_mov_b64 exec, 7
    global_load_dword a210, v46, s[72:73]
    global_load_dword a210, v46, s[74:75]
    s_mov_b64 exec, -1
    v_smfmac_f32_16x16x64_bf16 a[216:219], a[242:245], a[184:191], v17
    v_mfma_f32_32x32x16_bf16 v[128:143], a[96:99], a[192:195], v[128:143]
    s_waitcnt vmcnt(16)
    s_mov_b32 m0, s53
    s_xor_b32 s99, s3, 1
    ds_read_b64_tr_b16 a[184:185], v6 offset:2048
    ds_read_b64_tr_b16 a[186:187], v6 offset:2560
    ds_read_b128 v[160:163], v92 offset:16384
    ds_read_b128 v[164:167], v93 offset:16384
    v_mfma_f32_32x32x16_bf16 v[144:159], a[96:99], a[196:199], v[144:159]
    s_waitcnt lgkmcnt(8)
    s_mul_i32 s98, s99, 40960
    ds_read_b64_tr_b16 a[188:189], v7 offset:2048
    ds_read_b64_tr_b16 a[190:191], v7 offset:2560
    ds_read_b128 v[168:171], v94 offset:16384
    ds_read_b128 v[172:175], v95 offset:16384
    global_load_lds_dwordx4 v84, s[44:45] offset:0
    v_smfmac_f32_16x16x64_bf16 a[220:223], a[242:245], a[192:199], v17
    v_add_u32 v61, s98, v53
    v_add_u32 v62, 8192, v38
    v_mfma_f32_32x32x16_bf16 v[96:111], a[100:103], a[160:163], v[96:111]
    s_lshl_b32 s98, s81, 10
    s_mul_i32 s99, s3, 655360
    s_add_u32 s76, s98, s99
    s_add_u32 s76, s76, 8388608
    ds_read_b64_tr_b16 a[192:193], v2 offset:0
    ds_read_b64_tr_b16 a[194:195], v2 offset:512
    ds_read_b128 a[112:115], v92 offset:16384
    v_mfma_f32_32x32x16_bf16 v[112:127], a[100:103], a[164:167], v[112:127]
    s_add_u32 s83, s83, 65536
    s_mov_b32 s43, 0
    s_add_u32 s98, s3, 1
    s_and_b32 s98, s98, 3
    ds_read_b64_tr_b16 a[196:197], v3 offset:0
    ds_read_b64_tr_b16 a[198:199], v3 offset:512
    global_load_lds_dwordx4 v85, s[44:45] offset:1024
    v_mfma_f32_32x32x16_bf16 v[128:143], a[100:103], a[168:171], v[128:143]
    s_mul_i32 s99, s98, 49152
    ds_read_b64_tr_b16 a[160:161], v2 offset:2048
    ds_read_b64_tr_b16 a[162:163], v2 offset:2560
    ds_read_b128 a[116:119], v93 offset:16384
    v_add_u32 v54, s99, v53
    v_mfma_f32_32x32x16_bf16 v[144:159], a[100:103], a[172:175], v[144:159]
    s_waitcnt lgkmcnt(10)
    s_add_u32 s98, s3, 2
    s_and_b32 s98, s98, 3
    s_mul_i32 s99, s98, 49152
    ds_read_b64_tr_b16 a[164:165], v3 offset:2048
    ds_read_b64_tr_b16 a[166:167], v3 offset:2560
    global_load_lds_dwordx4 v86, s[44:45] offset:2048
    s_waitcnt lgkmcnt(10)
    v_smfmac_f32_16x16x64_bf16 a[250:253], a[242:245], v[160:167], v17
    v_smfmac_f32_16x16x64_bf16 a[250:253], a[242:245], v[168:175], v17
    v_dot2_f32_bf16 v34, v160, v160, v34
    v_dot2_f32_bf16 v35, v161, v161, v35
    v_dot2_f32_bf16 v36, v162, v162, v36
    v_dot2_f32_bf16 v37, v163, v163, v37
    v_dot2_f32_bf16 v34, v164, v164, v34
    v_dot2_f32_bf16 v35, v165, v165, v35
    v_dot2_f32_bf16 v36, v166, v166, v36
    v_dot2_f32_bf16 v37, v167, v167, v37
    v_dot2_f32_bf16 v34, v168, v168, v34
    v_dot2_f32_bf16 v35, v169, v169, v35
    v_dot2_f32_bf16 v36, v170, v170, v36
    v_dot2_f32_bf16 v37, v171, v171, v37
    v_dot2_f32_bf16 v34, v172, v172, v34
    v_dot2_f32_bf16 v35, v173, v173, v35
    v_dot2_f32_bf16 v36, v174, v174, v36
    v_dot2_f32_bf16 v37, v175, v175, v37
    v_mfma_f32_32x32x16_bf16 v[96:111], a[104:107], a[176:179], v[96:111]
    s_waitcnt vmcnt(15)
    s_barrier
    ds_read_b64_tr_b16 a[168:169], v12 offset:16384
    ds_read_b64_tr_b16 a[170:171], v12 offset:16896
    ds_read_b128 a[120:123], v94 offset:16384
    v_mfma_f32_32x32x16_bf16 v[112:127], a[104:107], a[180:183], v[112:127]
    ds_read_b64_tr_b16 a[172:173], v13 offset:16384
    ds_read_b64_tr_b16 a[174:175], v13 offset:16896
    global_load_lds_dwordx4 v87, s[44:45] offset:3072
    v_add_u32 v55, s99, v53
    v_mfma_f32_32x32x16_bf16 v[128:143], a[104:107], a[184:187], v[128:143]
    s_mov_b32 m0, s50
    s_add_u32 s98, s3, 3
    s_and_b32 s98, s98, 3
    s_mul_i32 s99, s98, 49152
    ds_read_b64_tr_b16 a[176:177], v12 offset:18432
    ds_read_b64_tr_b16 a[178:179], v12 offset:18944
    ds_read_b128 a[124:127], v95 offset:16384
    v_mfma_f32_32x32x16_bf16 v[144:159], a[104:107], a[188:191], v[144:159]
    s_waitcnt lgkmcnt(8)
    ds_read_b64_tr_b16 a[180:181], v13 offset:18432
    ds_read_b64_tr_b16 a[182:183], v13 offset:18944
    global_load_lds_dwordx4 v8, s[12:13] offset:0
    v_add_u32 v56, s99, v53
    v_mfma_f32_32x32x16_bf16 v[96:111], a[108:111], a[192:195], v[96:111]
    s_add_u32 s98, s3, 4
    s_and_b32 s98, s98, 3
    s_mul_i32 s99, s98, 49152
    ds_read_b64_tr_b16 a[184:185], v14 offset:16384
    ds_read_b64_tr_b16 a[186:187], v14 offset:16896
    v_add_u32 v57, s99, v53
    v_mfma_f32_32x32x16_bf16 v[112:127], a[108:111], a[196:199], v[112:127]
    s_lshl_b32 s98, s87, 2
    s_add_u32 s98, s98, 0
    s_mul_i32 s99, s98, 52
    s_lshr_b32 s99, s99, 8
    ds_read_b64_tr_b16 a[188:189], v15 offset:16384
    ds_read_b64_tr_b16 a[190:191], v15 offset:16896
    global_load_lds_dwordx4 v9, s[12:13] offset:1024
    v_mfma_f32_32x32x16_bf16 v[128:143], a[108:111], a[160:163], v[128:143]
    s_mul_i32 s99, s99, 355
    s_add_u32 s98, s98, s99
    s_mul_i32 s99, s86, 5
    s_add_u32 s98, s98, s99
    s_lshl_b32 s98, s98, 10
    ds_read_b64_tr_b16 a[192:193], v14 offset:18432
    ds_read_b64_tr_b16 a[194:195], v14 offset:18944
    v_mfma_f32_32x32x16_bf16 v[144:159], a[108:111], a[164:167], v[144:159]
    s_waitcnt lgkmcnt(6)
    s_add_u32 s72, s98, 17825792
    s_lshl_b32 s98, s87, 2
    s_add_u32 s98, s98, 1
    ds_read_b64_tr_b16 a[196:197], v15 offset:18432
    ds_read_b64_tr_b16 a[198:199], v15 offset:18944
    global_load_lds_dwordx4 v8, s[14:15] offset:2048
    v_mfma_f32_32x32x16_bf16 v[96:111], a[112:115], a[168:171], v[96:111]
    s_mul_i32 s99, s98, 52
    s_lshr_b32 s99, s99, 8
    s_mul_i32 s99, s99, 355
    s_add_u32 s98, s98, s99
    s_mul_i32 s99, s86, 5
    ds_read_b64_tr_b16 a[160:161], v6 offset:16384
    ds_read_b64_tr_b16 a[162:163], v6 offset:16896
    v_mfma_f32_32x32x16_bf16 v[112:127], a[112:115], a[172:175], v[112:127]
    s_add_u32 s98, s98, s99
    s_lshl_b32 s98, s98, 10
    s_add_u32 s73, s98, 17825792
    s_lshl_b32 s98, s87, 2
    s_add_u32 s98, s98, 2
    s_mul_i32 s99, s98, 52
    ds_read_b64_tr_b16 a[164:165], v7 offset:16384
    ds_read_b64_tr_b16 a[166:167], v7 offset:16896
    global_load_lds_dwordx4 v9, s[14:15] offset:3072
    v_smfmac_f32_16x16x64_bf16 a[216:219], a[242:245], a[168:175], v17
    v_mfma_f32_32x32x16_bf16 v[128:143], a[112:115], a[176:179], v[128:143]
    s_waitcnt vmcnt(14)
    s_mov_b32 m0, s51
    s_lshr_b32 s99, s99, 8
    ds_read_b64_tr_b16 a[168:169], v6 offset:18432
    ds_read_b64_tr_b16 a[170:171], v6 offset:18944
    ds_read_b128 v[160:163], v92 offset:0
    ds_read_b128 v[164:167], v93 offset:0
    v_mfma_f32_32x32x16_bf16 v[144:159], a[112:115], a[180:183], v[144:159]
    s_waitcnt lgkmcnt(8)
    s_mul_i32 s99, s99, 355
    s_add_u32 s98, s98, s99
    s_mul_i32 s99, s86, 5
    s_add_u32 s98, s98, s99
    ds_read_b64_tr_b16 a[172:173], v7 offset:18432
    ds_read_b64_tr_b16 a[174:175], v7 offset:18944
    ds_read_b128 v[168:171], v94 offset:0
    ds_read_b128 v[172:175], v95 offset:0
    v_smfmac_f32_16x16x64_bf16 a[220:223], a[242:245], a[176:183], v17
    v_mfma_f32_32x32x16_bf16 v[96:111], a[116:119], a[184:187], v[96:111]
    s_lshl_b32 s98, s98, 10
    s_add_u32 s79, s98, 17825792
    s_lshl_b32 s98, s87, 2
    ds_read_b64_tr_b16 a[176:177], v2 offset:16384
    ds_read_b64_tr_b16 a[178:179], v2 offset:16896
    ds_read_b128 a[128:131], v92 offset:0
    global_load_lds_dwordx4 v4, s[16:17] offset:0
    v_mfma_f32_32x32x16_bf16 v[112:127], a[116:119], a[188:191], v[112:127]
    s_add_u32 s98, s98, 3
    s_mul_i32 s99, s98, 52
    s_lshr_b32 s99, s99, 8
    s_mul_i32 s99, s99, 355
    s_add_u32 s98, s98, s99
    ds_read_b64_tr_b16 a[180:181], v3 offset:16384
    ds_read_b64_tr_b16 a[182:183], v3 offset:16896
    v_mfma_f32_32x32x16_bf16 v[128:143], a[116:119], a[192:195], v[128:143]
    s_mul_i32 s99, s86, 5
    s_add_u32 s98, s98, s99
    s_lshl_b32 s98, s98, 10
    s_add_u32 s55, s98, 17825792
    ds_read_b64_tr_b16 a[184:185], v2 offset:18432
    ds_read_b64_tr_b16 a[186:187], v2 offset:18944
    ds_read_b128 a[132:135], v93 offset:0
    v_mfma_f32_32x32x16_bf16 v[144:159], a[116:119], a[196:199], v[144:159]
    s_waitcnt lgkmcnt(10)
    ds_read_b64_tr_b16 a[188:189], v3 offset:18432
    ds_read_b64_tr_b16 a[190:191], v3 offset:18944
    global_load_lds_dwordx4 v5, s[16:17] offset:1024
    s_waitcnt lgkmcnt(10)
    v_smfmac_f32_16x16x64_bf16 a[250:253], a[242:245], v[160:167], v17
    v_smfmac_f32_16x16x64_bf16 a[250:253], a[242:245], v[168:175], v17
    v_dot2_f32_bf16 v34, v160, v160, v34
    v_dot2_f32_bf16 v35, v161, v161, v35
    v_dot2_f32_bf16 v36, v162, v162, v36
    v_dot2_f32_bf16 v37, v163, v163, v37
    v_dot2_f32_bf16 v34, v164, v164, v34
    v_dot2_f32_bf16 v35, v165, v165, v35
    v_dot2_f32_bf16 v36, v166, v166, v36
    v_dot2_f32_bf16 v37, v167, v167, v37
    v_dot2_f32_bf16 v34, v168, v168, v34
    v_dot2_f32_bf16 v35, v169, v169, v35
    v_dot2_f32_bf16 v36, v170, v170, v36
    v_dot2_f32_bf16 v37, v171, v171, v37
    v_dot2_f32_bf16 v34, v172, v172, v34
    v_dot2_f32_bf16 v35, v173, v173, v35
    v_dot2_f32_bf16 v36, v174, v174, v36
    v_dot2_f32_bf16 v37, v175, v175, v37
    v_mfma_f32_32x32x16_bf16 v[96:111], a[120:123], a[160:163], v[96:111]
    s_waitcnt vmcnt(12)
    s_barrier
    ds_read_b64_tr_b16 a[192:193], v12 offset:32768
    ds_read_b64_tr_b16 a[194:195], v12 offset:33280
    ds_read_b128 a[136:139], v94 offset:0
    v_mfma_f32_32x32x16_bf16 v[112:127], a[120:123], a[164:167], v[112:127]
    s_mul_i32 s45, s3, 40960
    ds_read_b64_tr_b16 a[196:197], v13 offset:32768
    ds_read_b64_tr_b16 a[198:199], v13 offset:33280
    buffer_store_dwordx4 v[80:83], v25, s[24:27], 0 offen sc1
    v_mfma_f32_32x32x16_bf16 v[128:143], a[120:123], a[168:171], v[128:143]
    s_mul_i32 s98, s82, 368640
    ds_read_b64_tr_b16 a[160:161], v12 offset:34816
    ds_read_b64_tr_b16 a[162:163], v12 offset:35328
    ds_read_b128 a[140:143], v95 offset:0
    global_load_lds_dwordx4 v4, s[18:19] offset:2048
    v_accvgpr_write_b32 a212, 0
    v_accvgpr_write_b32 a213, 0
    v_mfma_f32_32x32x16_bf16 v[144:159], a[120:123], a[172:175], v[144:159]
    s_waitcnt lgkmcnt(8)
    ds_read_b64_tr_b16 a[164:165], v13 offset:34816
    ds_read_b64_tr_b16 a[166:167], v13 offset:35328
    v_accvgpr_write_b32 a214, 0
    v_accvgpr_write_b32 a215, 0
    v_mfma_f32_32x32x16_bf16 v[96:111], a[124:127], a[176:179], v[96:111]
    s_mul_i32 s99, s3, 61440
    ds_read_b64_tr_b16 a[168:169], v14 offset:32768
    ds_read_b64_tr_b16 a[170:171], v14 offset:33280
    v_mfma_f32_32x32x16_bf16 v[112:127], a[124:127], a[180:183], v[112:127]
    s_add_u32 s74, s98, s99
    ds_read_b64_tr_b16 a[172:173], v15 offset:32768
    ds_read_b64_tr_b16 a[174:175], v15 offset:33280
    global_load_lds_dwordx4 v5, s[18:19] offset:3072
    v_add_u32 v4, 393216, v4
    v_add_u32 v5, 393216, v5
    v_mfma_f32_32x32x16_bf16 v[128:143], a[124:127], a[184:187], v[128:143]
    s_mov_b32 m0, s52
    ds_read_b64_tr_b16 a[176:177], v14 offset:34816
    ds_read_b64_tr_b16 a[178:179], v14 offset:35328
    v_mfma_f32_32x32x16_bf16 v[144:159], a[124:127], a[188:191], v[144:159]
    s_waitcnt lgkmcnt(6)
    ds_read_b64_tr_b16 a[180:181], v15 offset:34816
    ds_read_b64_tr_b16 a[182:183], v15 offset:35328
    v_mfma_f32_32x32x16_bf16 v[96:111], a[128:131], a[192:195], v[96:111]
    s_add_u32 s74, s74, 17825792
    ds_read_b64_tr_b16 a[184:185], v6 offset:32768
    ds_read_b64_tr_b16 a[186:187], v6 offset:33280
    global_load_lds_dwordx4 v4, s[16:17] offset:0
    v_mfma_f32_32x32x16_bf16 v[112:127], a[128:131], a[196:199], v[112:127]
    s_mul_i32 s99, s3, 25600
    ds_read_b64_tr_b16 a[188:189], v7 offset:32768
    ds_read_b64_tr_b16 a[190:191], v7 offset:33280
    v_smfmac_f32_16x16x64_bf16 a[216:219], a[242:245], a[192:199], v17
    v_mfma_f32_32x32x16_bf16 v[128:143], a[128:131], a[160:163], v[128:143]
    s_waitcnt vmcnt(10)
    ds_read_b64_tr_b16 a[192:193], v6 offset:34816
    ds_read_b64_tr_b16 a[194:195], v6 offset:35328
    ds_read_b128 v[160:163], v92 offset:32768
    ds_read_b128 v[164:167], v93 offset:32768
    v_mfma_f32_32x32x16_bf16 v[144:159], a[128:131], a[164:167], v[144:159]
    s_waitcnt lgkmcnt(8)
    ds_read_b64_tr_b16 a[196:197], v7 offset:34816
    ds_read_b64_tr_b16 a[198:199], v7 offset:35328
    ds_read_b128 v[168:171], v94 offset:32768
    ds_read_b128 v[172:175], v95 offset:32768
    global_load_lds_dwordx4 v5, s[16:17] offset:1024
    v_smfmac_f32_16x16x64_bf16 a[220:223], a[242:245], a[160:167], v17
    v_mfma_f32_32x32x16_bf16 v[96:111], a[132:135], a[168:171], v[96:111]
    s_add_u32 s80, s98, s99
    ds_read_b64_tr_b16 a[160:161], v2 offset:32768
    ds_read_b64_tr_b16 a[162:163], v2 offset:33280
    ds_read_b128 a[144:147], v92 offset:32768
    v_mfma_f32_32x32x16_bf16 v[112:127], a[132:135], a[172:175], v[112:127]
    s_add_u32 s80, s80, 18071552
    ds_read_b64_tr_b16 a[164:165], v3 offset:32768
    ds_read_b64_tr_b16 a[166:167], v3 offset:33280
    v_mfma_f32_32x32x16_bf16 v[128:143], a[132:135], a[176:179], v[128:143]
    s_mul_i32 s98, s81, 196608
    ds_read_b64_tr_b16 a[168:169], v2 offset:34816
    ds_read_b64_tr_b16 a[170:171], v2 offset:35328
    ds_read_b128 a[148:151], v93 offset:32768
    global_load_lds_dwordx4 v4, s[18:19] offset:2048
    v_mfma_f32_32x32x16_bf16 v[144:159], a[132:135], a[180:183], v[144:159]
    s_waitcnt lgkmcnt(10)
    ds_read_b64_tr_b16 a[172:173], v3 offset:34816
    ds_read_b64_tr_b16 a[174:175], v3 offset:35328
    s_waitcnt lgkmcnt(10)
    v_smfmac_f32_16x16x64_bf16 a[250:253], a[242:245], v[160:167], v17
    v_smfmac_f32_16x16x64_bf16 a[250:253], a[242:245], v[168:175], v17
    v_dot2_f32_bf16 v34, v160, v160, v34
    v_dot2_f32_bf16 v35, v161, v161, v35
    v_dot2_f32_bf16 v36, v162, v162, v36
    v_dot2_f32_bf16 v37, v163, v163, v37
    v_dot2_f32_bf16 v34, v164, v164, v34
    v_dot2_f32_bf16 v35, v165, v165, v35
    v_dot2_f32_bf16 v36, v166, v166, v36
    v_dot2_f32_bf16 v37, v167, v167, v37
    v_dot2_f32_bf16 v34, v168, v168, v34
    v_dot2_f32_bf16 v35, v169, v169, v35
    v_dot2_f32_bf16 v36, v170, v170, v36
    v_dot2_f32_bf16 v37, v171, v171, v37
    v_dot2_f32_bf16 v34, v172, v172, v34
    v_dot2_f32_bf16 v35, v173, v173, v35
    v_dot2_f32_bf16 v36, v174, v174, v36
    v_dot2_f32_bf16 v37, v175, v175, v37
    v_mfma_f32_32x32x16_bf16 v[96:111], a[136:139], a[184:187], v[96:111]
    s_waitcnt vmcnt(8)
    s_barrier
    ds_read_b64_tr_b16 a[176:177], v12 offset:49152
    ds_read_b64_tr_b16 a[178:179], v12 offset:49664
    ds_read_b128 a[152:155], v94 offset:32768
    v_mfma_f32_32x32x16_bf16 v[112:127], a[136:139], a[188:191], v[112:127]
    s_mul_i32 s99, s3, 12288
    ds_read_b64_tr_b16 a[180:181], v13 offset:49152
    ds_read_b64_tr_b16 a[182:183], v13 offset:49664
    global_load_lds_dwordx4 v5, s[18:19] offset:3072
    v_add_u32 v4, 393216, v4
    v_add_u32 v5, 393216, v5
    v_accvgpr_read_b32 v26, a250
    v_mfma_f32_32x32x16_bf16 v[128:143], a[136:139], a[192:195], v[128:143]
    s_mov_b32 m0, s62
    ds_read_b64_tr_b16 a[184:185], v12 offset:51200
    ds_read_b64_tr_b16 a[186:187], v12 offset:51712
    ds_read_b128 a[156:159], v95 offset:32768
    v_accvgpr_read_b32 v27, a251
    v_add_f32 v34, v34, v35
    v_add_f32 v36, v36, v37
    v_mfma_f32_32x32x16_bf16 v[144:159], a[136:139], a[196:199], v[144:159]
    s_waitcnt lgkmcnt(8)
    ds_read_b64_tr_b16 a[188:189], v13 offset:51200
    ds_read_b64_tr_b16 a[190:191], v13 offset:51712
    v_add_f32 v26, v26, v27
    v_add_f32 v36, v36, v34
    v_mov_b32 v27, v26
    v_mov_b32 v37, v36
    v_mfma_f32_32x32x16_bf16 v[96:111], a[140:143], a[160:163], v[96:111]
    s_add_u32 s75, s98, s99
    ds_read_b64_tr_b16 a[192:193], v14 offset:49152
    ds_read_b64_tr_b16 a[194:195], v14 offset:49664
    global_load_lds_dwordx4 v4, s[16:17] offset:0
    v_cmp_gt_u32 vcc, 32, v1
    v_permlane32_swap_b32 v26, v27
    v_mfma_f32_32x32x16_bf16 v[112:127], a[140:143], a[164:167], v[112:127]
    s_add_u32 s75, s75, 11534336
    ds_read_b64_tr_b16 a[196:197], v15 offset:49152
    ds_read_b64_tr_b16 a[198:199], v15 offset:49664
    v_permlane32_swap_b32 v36, v37
    v_add_f32 v26, v26, v27
    v_add_f32 v36, v36, v37
    v_mfma_f32_32x32x16_bf16 v[128:143], a[140:143], a[168:171], v[128:143]
    s_add_u32 s78, s95, 8192
    ds_read_b64_tr_b16 a[160:161], v14 offset:51200
    ds_read_b64_tr_b16 a[162:163], v14 offset:51712
    v_mul_f32 v26, 3133983949, v26
    v_mul_f32 v36, 986500301, v36
    v_fma_f32 v36, -v26, v26, v36
    v_cvt_pk_bf16_f32 v26, v26, v26
    v_mfma_f32_32x32x16_bf16 v[144:159], a[140:143], a[172:175], v[144:159]
    s_waitcnt lgkmcnt(6)
    ds_read_b64_tr_b16 a[164:165], v15 offset:51200
    ds_read_b64_tr_b16 a[166:167], v15 offset:51712
    global_load_lds_dwordx4 v5, s[16:17] offset:1024
    v_max_f32 v36, 0, v36
    v_cndmask_b32 v26, 0, v26, vcc
    v_smfmac_f32_16x16x64_bf16 a[216:219], a[242:245], a[176:183], v17
    v_cvt_pk_bf16_f32 v36, v36, v36
    v_accvgpr_write_b32 a246, v26
    v_accvgpr_write_b32 a247, v26
    v_mfma_f32_32x32x16_bf16 v[96:111], a[144:147], a[176:179], v[96:111]
    s_add_u32 s98, s3, 1
    ds_read_b64_tr_b16 a[168:169], v6 offset:49152
    ds_read_b64_tr_b16 a[170:171], v6 offset:49664
    v_accvgpr_write_b32 a248, v26
    v_accvgpr_write_b32 a249, v26
    v_and_b32 v36, 0xffff0000, v36
    v_smfmac_f32_16x16x64_bf16 a[220:223], a[242:245], a[184:191], v17
    v_add_f32 v36, 925353388, v36
    v_cvt_pk_bf16_f32 v36, v36, v36
    v_lshlrev_b32 v36, 16, v36
    v_mfma_f32_32x32x16_bf16 v[112:127], a[144:147], a[180:183], v[112:127]
    s_and_b32 s98, s98, 3
    ds_read_b64_tr_b16 a[172:173], v7 offset:49152
    ds_read_b64_tr_b16 a[174:175], v7 offset:49664
    v_sqrt_f32 v36, v36
    v_mov_b32 v37, 0
    v_cvt_pk_bf16_f32 v36, v36, v36
    v_mfma_f32_32x32x16_bf16 v[128:143], a[144:147], a[184:187], v[128:143]
    s_lshl_b32 s98, s98, 8
    ds_read_b64_tr_b16 a[176:177], v6 offset:51200
    ds_read_b64_tr_b16 a[178:179], v6 offset:51712
    global_load_lds_dwordx4 v4, s[18:19] offset:2048
    v_accvgpr_read_b32 v68, a216
    v_accvgpr_read_b32 v69, a217
    v_add_f32 v68, v68, v69
    v_mfma_f32_32x32x16_bf16 v[144:159], a[144:147], a[188:191], v[144:159]
    s_waitcnt lgkmcnt(6)
    ds_read_b64_tr_b16 a[180:181], v7 offset:51200
    ds_read_b64_tr_b16 a[182:183], v7 offset:51712
    v_cvt_pk_bf16_f32 v69, v68, v68
    v_and_b32 v69, 0xffff0000, v69
    v_sub_f32 v68, v68, v69
    v_cvt_pk_bf16_f32 v68, v69, v68
    v_mfma_f32_32x32x16_bf16 v[96:111], a[148:151], a[192:195], v[96:111]
    s_add_u32 s12, s76, s98
    ds_read_b64_tr_b16 a[184:185], v2 offset:49152
    ds_read_b64_tr_b16 a[186:187], v2 offset:49664
    v_accvgpr_read_b32 v70, a220
    v_accvgpr_read_b32 v71, a221
    v_add_f32 v70, v70, v71
    v_cvt_pk_bf16_f32 v71, v70, v70
    v_mfma_f32_32x32x16_bf16 v[112:127], a[148:151], a[196:199], v[112:127]
    s_add_u32 s98, s3, 2
    ds_read_b64_tr_b16 a[188:189], v3 offset:49152
    ds_read_b64_tr_b16 a[190:191], v3 offset:49664
    global_load_lds_dwordx4 v5, s[18:19] offset:3072
    v_add_u32 v4, 393216, v4
    v_add_u32 v5, 393216, v5
    v_and_b32 v71, 0xffff0000, v71
    v_mfma_f32_32x32x16_bf16 v[128:143], a[148:151], a[160:163], v[128:143]
    s_mov_b32 m0, s63
    ds_read_b64_tr_b16 a[192:193], v2 offset:51200
    ds_read_b64_tr_b16 a[194:195], v2 offset:51712
    v_sub_f32 v70, v70, v71
    v_cvt_pk_bf16_f32 v70, v71, v70
    ds_write_b32 v0, v68 offset:1024
    ds_write_b32 v0, v70 offset:2048
    v_mfma_f32_32x32x16_bf16 v[144:159], a[148:151], a[164:167], v[144:159]
    s_waitcnt lgkmcnt(8)
    ds_read_b64_tr_b16 a[196:197], v3 offset:51200
    ds_read_b64_tr_b16 a[198:199], v3 offset:51712
    v_lshlrev_b32 v28, 16, v36
    v_rcp_f32 v27, v28
    s_nop 0
    v_mul_f32 v29, 3216550459, v27
    v_mfma_f32_32x32x16_bf16 v[96:111], a[152:155], a[168:171], v[96:111]
    s_waitcnt lgkmcnt(2)
    s_waitcnt vmcnt(8)
    s_barrier
    ds_read_b64_tr_b16 a[160:161], v40 offset:0
    ds_read_b64_tr_b16 a[162:163], v40 offset:256
    v_mfma_f32_32x32x16_bf16 v[112:127], a[152:155], a[172:175], v[112:127]
    ds_read_b64_tr_b16 a[164:165], v40 offset:2048
    ds_read_b64_tr_b16 a[166:167], v40 offset:2304
    global_load_lds_dwordx4 v4, s[16:17] offset:0
    ds_read_b128 a[224:227], v39 offset:1024
    ds_read_b128 a[228:231], v39 offset:1536
    ds_read_b128 a[232:235], v39 offset:2048
    ds_read_b128 a[236:239], v39 offset:2560
    v_mfma_f32_32x32x16_bf16 v[128:143], a[152:155], a[176:179], v[128:143]
    s_and_b32 s98, s98, 3
    ds_read_b64_tr_b16 a[168:169], v41 offset:0
    ds_read_b64_tr_b16 a[170:171], v41 offset:256
    v_mov_b32 v32, 131072
    v_add_u32 v32, s42, v32
    v_and_b32 v30, 31, v1
    v_lshl_add_u32 v30, v30, 2, v32
    v_mfma_f32_32x32x16_bf16 v[144:159], a[152:155], a[180:183], v[144:159]
    s_waitcnt lgkmcnt(10)
    ds_read_b64_tr_b16 a[172:173], v41 offset:2048
    ds_read_b64_tr_b16 a[174:175], v41 offset:2304
    v_lshrrev_b32 v31, 5, v1
    v_lshl_add_u32 v31, v31, 4, v32
    v_mfma_f32_32x32x16_bf16 v[96:111], a[156:159], a[184:187], v[96:111]
    s_lshl_b32 s98, s98, 8
    ds_read_b64_tr_b16 a[176:177], v42 offset:0
    ds_read_b64_tr_b16 a[178:179], v42 offset:256
    global_load_lds_dwordx4 v5, s[16:17] offset:1024
    v_mfma_f32_32x32x16_bf16 v[112:127], a[156:159], a[188:191], v[112:127]
    s_add_u32 s13, s76, s98
    ds_read_b64_tr_b16 a[180:181], v42 offset:2048
    ds_read_b64_tr_b16 a[182:183], v42 offset:2304
    ds_write_b32 v30, v27
    ds_read_b128 v[80:83], v31 offset:0
    ds_read_b128 v[84:87], v31 offset:32
    ds_read_b128 v[88:91], v31 offset:64
    ds_read_b128 v[92:95], v31 offset:96
    buffer_load_dword v33, v37, s[32:35], 0 offen sc1
    s_waitcnt lgkmcnt(15)
    v_mfma_f32_32x32x16_bf16 v[96:111], a[246:249], a[224:227], v[96:111]
    v_mfma_f32_32x32x16_bf16 v[128:143], a[156:159], a[192:195], v[128:143]
    s_add_u32 s98, s3, 3
    ds_read_b64_tr_b16 a[184:185], v43 offset:0
    ds_read_b64_tr_b16 a[186:187], v43 offset:256
    s_waitcnt lgkmcnt(15)
    v_mfma_f32_32x32x16_bf16 v[112:127], a[246:249], a[228:231], v[112:127]
    v_mfma_f32_32x32x16_bf16 v[144:159], a[156:159], a[196:199], v[144:159]
    s_waitcnt lgkmcnt(11)
    s_and_b32 s98, s98, 3
    s_lshl_b32 s98, s98, 8
    s_add_u32 s14, s76, s98
    s_add_u32 s98, s3, 4
    s_and_b32 s98, s98, 3
    s_lshl_b32 s98, s98, 8
    s_add_u32 s15, s76, s98
    ds_read_b64_tr_b16 a[188:189], v43 offset:2048
    ds_read_b64_tr_b16 a[190:191], v43 offset:2304
    global_load_lds_dwordx4 v4, s[18:19] offset:2048
    s_waitcnt lgkmcnt(15)
    v_mfma_f32_32x32x16_bf16 v[128:143], a[246:249], a[232:235], v[128:143]
    v_mfma_f32_32x32x16_bf16 v[160:175], a[160:163], a[0:3], 0
    ds_read_b64_tr_b16 a[192:193], v40 offset:8192
    ds_read_b64_tr_b16 a[194:195], v40 offset:8448
    s_waitcnt lgkmcnt(15)
    v_mfma_f32_32x32x16_bf16 v[144:159], a[246:249], a[236:239], v[144:159]
    v_mfma_f32_32x32x16_bf16 v[176:191], a[164:167], a[0:3], 0
    s_waitcnt lgkmcnt(6)
    ds_read_b64_tr_b16 a[196:197], v40 offset:10240
    ds_read_b64_tr_b16 a[198:199], v40 offset:10496
    v_mul_f32 v64, v80, v96
    v_mul_f32 v65, v81, v97
    v_mul_f32 v66, v82, v98
    v_smfmac_f32_16x16x64_bf16 a[212:215], a[242:245], a[160:167], v17
    v_mul_f32 v67, v83, v99
    v_mul_f32 v68, v84, v100
    v_mul_f32 v69, v85, v101
    v_mfma_f32_32x32x16_bf16 v[160:175], a[168:171], a[4:7], v[160:175]
    ds_read_b64_tr_b16 a[160:161], v41 offset:8192
    ds_read_b64_tr_b16 a[162:163], v41 offset:8448
    global_load_lds_dwordx4 v5, s[18:19] offset:3072
    v_add_u32 v4, 393216, v4
    v_add_u32 v5, 393216, v5
    v_mul_f32 v70, v86, v102
    v_mfma_f32_32x32x16_bf16 v[176:191], a[172:175], a[4:7], v[176:191]
    s_waitcnt lgkmcnt(6)
    s_mov_b32 m0, s47
    ds_read_b64_tr_b16 a[164:165], v41 offset:10240
    ds_read_b64_tr_b16 a[166:167], v41 offset:10496
    v_mul_f32 v71, v87, v103
    v_cvt_pk_bf16_f32 v96, v64, v65
    v_cvt_pk_bf16_f32 v97, v66, v67
    v_mfma_f32_32x32x16_bf16 v[160:175], a[176:179], a[8:11], v[160:175]
    ds_read_b64_tr_b16 a[168:169], v42 offset:8192
    ds_read_b64_tr_b16 a[170:171], v42 offset:8448
    v_cvt_pk_bf16_f32 v98, v68, v69
    v_cvt_pk_bf16_f32 v99, v70, v71
    v_mul_f32 v72, v88, v104
    v_mul_f32 v73, v89, v105
    v_mfma_f32_32x32x16_bf16 v[176:191], a[180:183], a[8:11], v[176:191]
    s_add_u32 s6, s56, 0
    ds_read_b64_tr_b16 a[172:173], v42 offset:10240
    ds_read_b64_tr_b16 a[174:175], v42 offset:10496
    global_load_lds_dwordx4 v4, s[16:17] offset:0
    v_mul_f32 v74, v90, v106
    v_mul_f32 v75, v91, v107
    v_mul_f32 v76, v92, v108
    v_mfma_f32_32x32x16_bf16 v[160:175], a[184:187], a[12:15], v[160:175]
    ds_read_b64_tr_b16 a[176:177], v43 offset:8192
    ds_read_b64_tr_b16 a[178:179], v43 offset:8448
    buffer_store_dwordx4 v[96:99], v16, s[24:27], s6 offen offset:0 sc1
    v_mfma_f32_32x32x16_bf16 v[176:191], a[188:191], a[12:15], v[176:191]
    s_waitcnt lgkmcnt(6)
    ds_read_b64_tr_b16 a[180:181], v43 offset:10240
    ds_read_b64_tr_b16 a[182:183], v43 offset:10496
    v_mul_f32 v77, v93, v109
    v_mul_f32 v78, v94, v110
    v_mul_f32 v79, v95, v111
    v_cvt_pk_bf16_f32 v104, v72, v73
    v_mfma_f32_32x32x16_bf16 v[160:175], a[192:195], a[16:19], v[160:175]
    s_waitcnt vmcnt(11)
    s_barrier
    ds_read_b64_tr_b16 a[184:185], v40 offset:16384
    ds_read_b64_tr_b16 a[186:187], v40 offset:16640
    v_mfma_f32_32x32x16_bf16 v[176:191], a[196:199], a[16:19], v[176:191]
    ds_read_b64_tr_b16 a[188:189], v40 offset:18432
    ds_read_b64_tr_b16 a[190:191], v40 offset:18688
    global_load_lds_dwordx4 v5, s[16:17] offset:1024
    v_cvt_pk_bf16_f32 v105, v74, v75
    v_cvt_pk_bf16_f32 v106, v76, v77
    v_smfmac_f32_16x16x64_bf16 a[212:215], a[242:245], a[192:199], v17
    v_cvt_pk_bf16_f32 v107, v78, v79
    v_mul_f32 v64, v80, v112
    v_mul_f32 v65, v81, v113
    v_mfma_f32_32x32x16_bf16 v[160:175], a[160:163], a[20:23], v[160:175]
    ds_read_b64_tr_b16 a[192:193], v41 offset:16384
    ds_read_b64_tr_b16 a[194:195], v41 offset:16640
    v_mul_f32 v66, v82, v114
    v_mul_f32 v67, v83, v115
    v_mul_f32 v68, v84, v116
    v_mul_f32 v69, v85, v117
    v_mfma_f32_32x32x16_bf16 v[176:191], a[164:167], a[20:23], v[176:191]
    s_waitcnt lgkmcnt(6)
    ds_read_b64_tr_b16 a[196:197], v41 offset:18432
    ds_read_b64_tr_b16 a[198:199], v41 offset:18688
    v_mul_f32 v70, v86, v118
    v_mul_f32 v71, v87, v119
    v_cvt_pk_bf16_f32 v112, v64, v65
    v_cvt_pk_bf16_f32 v113, v66, v67
    v_mfma_f32_32x32x16_bf16 v[160:175], a[168:171], a[24:27], v[160:175]
    ds_read_b64_tr_b16 a[160:161], v42 offset:16384
    ds_read_b64_tr_b16 a[162:163], v42 offset:16640
    global_load_lds_dwordx4 v4, s[18:19] offset:2048
    v_cvt_pk_bf16_f32 v114, v68, v69
    v_cvt_pk_bf16_f32 v115, v70, v71
    v_mul_f32 v72, v88, v120
    v_mfma_f32_32x32x16_bf16 v[176:191], a[172:175], a[24:27], v[176:191]
    ds_read_b64_tr_b16 a[164:165], v42 offset:18432
    ds_read_b64_tr_b16 a[166:167], v42 offset:18688
    v_mul_f32 v73, v89, v121
    v_mul_f32 v74, v90, v122
    v_mul_f32 v75, v91, v123
    v_mul_f32 v76, v92, v124
    v_mfma_f32_32x32x16_bf16 v[160:175], a[176:179], a[28:31], v[160:175]
    s_add_u32 s7, s56, 0
    ds_read_b64_tr_b16 a[168:169], v43 offset:16384
    ds_read_b64_tr_b16 a[170:171], v43 offset:16640
    buffer_store_dwordx4 v[104:107], v16, s[24:27], s7 offen offset:128 sc1
    v_mfma_f32_32x32x16_bf16 v[176:191], a[180:183], a[28:31], v[176:191]
    s_waitcnt lgkmcnt(6)
    ds_read_b64_tr_b16 a[172:173], v43 offset:18432
    ds_read_b64_tr_b16 a[174:175], v43 offset:18688
    global_load_lds_dwordx4 v5, s[18:19] offset:3072
    v_mul_f32 v77, v93, v125
    v_mul_f32 v78, v94, v126
    v_mul_f32 v79, v95, v127
    v_mfma_f32_32x32x16_bf16 v[160:175], a[184:187], a[32:35], v[160:175]
    s_mov_b32 m0, s48
    ds_read_b64_tr_b16 a[176:177], v40 offset:24576
    ds_read_b64_tr_b16 a[178:179], v40 offset:24832
    v_cvt_pk_bf16_f32 v120, v72, v73
    v_cvt_pk_bf16_f32 v121, v74, v75
    v_cvt_pk_bf16_f32 v122, v76, v77
    v_cvt_pk_bf16_f32 v123, v78, v79
    v_mfma_f32_32x32x16_bf16 v[176:191], a[188:191], a[32:35], v[176:191]
    ds_read_b64_tr_b16 a[180:181], v40 offset:26624
    ds_read_b64_tr_b16 a[182:183], v40 offset:26880
    v_mul_f32 v64, v80, v128
    v_mul_f32 v65, v81, v129
    v_mul_f32 v66, v82, v130
    v_smfmac_f32_16x16x64_bf16 a[212:215], a[242:245], a[184:191], v17
    v_mul_f32 v67, v83, v131
    v_mul_f32 v68, v84, v132
    v_mul_f32 v69, v85, v133
    v_mfma_f32_32x32x16_bf16 v[160:175], a[192:195], a[36:39], v[160:175]
    ds_read_b64_tr_b16 a[184:185], v41 offset:24576
    ds_read_b64_tr_b16 a[186:187], v41 offset:24832
    global_load_lds_dwordx4 v10, s[20:21] offset:0
    v_mul_f32 v70, v86, v134
    v_mul_f32 v71, v87, v135
    v_cvt_pk_bf16_f32 v128, v64, v65
    v_mfma_f32_32x32x16_bf16 v[176:191], a[196:199], a[36:39], v[176:191]
    s_waitcnt lgkmcnt(6)
    ds_read_b64_tr_b16 a[188:189], v41 offset:26624
    ds_read_b64_tr_b16 a[190:191], v41 offset:26880
    v_cvt_pk_bf16_f32 v129, v66, v67
    v_cvt_pk_bf16_f32 v130, v68, v69
    v_cvt_pk_bf16_f32 v131, v70, v71
    v_mul_f32 v72, v88, v136
    v_mfma_f32_32x32x16_bf16 v[160:175], a[160:163], a[40:43], v[160:175]
    ds_read_b64_tr_b16 a[192:193], v42 offset:24576
    ds_read_b64_tr_b16 a[194:195], v42 offset:24832
    v_mul_f32 v73, v89, v137
    v_mul_f32 v74, v90, v138
    v_mul_f32 v75, v91, v139
    v_mul_f32 v76, v92, v140
    v_mfma_f32_32x32x16_bf16 v[176:191], a[164:167], a[40:43], v[176:191]
    ds_read_b64_tr_b16 a[196:197], v42 offset:26624
    ds_read_b64_tr_b16 a[198:199], v42 offset:26880
    global_load_lds_dwordx4 v11, s[20:21] offset:1024
    v_mul_f32 v77, v93, v141
    v_mul_f32 v78, v94, v142
    v_mul_f32 v79, v95, v143
    v_mfma_f32_32x32x16_bf16 v[160:175], a[168:171], a[44:47], v[160:175]
    ds_read_b64_tr_b16 a[160:161], v43 offset:24576
    ds_read_b64_tr_b16 a[162:163], v43 offset:24832
    v_cvt_pk_bf16_f32 v136, v72, v73
    v_cvt_pk_bf16_f32 v137, v74, v75
    v_cvt_pk_bf16_f32 v138, v76, v77
    v_cvt_pk_bf16_f32 v139, v78, v79
    v_mfma_f32_32x32x16_bf16 v[176:191], a[172:175], a[44:47], v[176:191]
    s_waitcnt lgkmcnt(6)
    ds_read_b64_tr_b16 a[164:165], v43 offset:26624
    ds_read_b64_tr_b16 a[166:167], v43 offset:26880
    v_mul_f32 v64, v80, v144
    v_mul_f32 v65, v81, v145
    v_mul_f32 v66, v82, v146
    v_mul_f32 v67, v83, v147
    v_mfma_f32_32x32x16_bf16 v[160:175], a[176:179], a[48:51], v[160:175]
    s_waitcnt vmcnt(8)
    s_barrier
    ds_read_b64_tr_b16 a[168:169], v40 offset:32768
    ds_read_b64_tr_b16 a[170:171], v40 offset:33024
    v_mfma_f32_32x32x16_bf16 v[176:191], a[180:183], a[48:51], v[176:191]
    s_add_u32 s6, s56, 131072
    ds_read_b64_tr_b16 a[172:173], v40 offset:34816
    ds_read_b64_tr_b16 a[174:175], v40 offset:35072
    global_load_lds_dwordx4 v10, s[22:23] offset:2048
    buffer_store_dwordx4 v[112:115], v16, s[24:27], s6 offen offset:0 sc1
    v_smfmac_f32_16x16x64_bf16 a[212:215], a[242:245], a[176:183], v17
    v_mul_f32 v68, v84, v148
    v_mfma_f32_32x32x16_bf16 v[160:175], a[184:187], a[52:55], v[160:175]
    ds_read_b64_tr_b16 a[176:177], v41 offset:32768
    ds_read_b64_tr_b16 a[178:179], v41 offset:33024
    v_mul_f32 v69, v85, v149
    v_mul_f32 v70, v86, v150
    v_mul_f32 v71, v87, v151
    v_cvt_pk_bf16_f32 v144, v64, v65
    v_mfma_f32_32x32x16_bf16 v[176:191], a[188:191], a[52:55], v[176:191]
    s_waitcnt lgkmcnt(6)
    ds_read_b64_tr_b16 a[180:181], v41 offset:34816
    ds_read_b64_tr_b16 a[182:183], v41 offset:35072
    v_cvt_pk_bf16_f32 v145, v66, v67
    v_cvt_pk_bf16_f32 v146, v68, v69
    v_cvt_pk_bf16_f32 v147, v70, v71
    v_mul_f32 v72, v88, v152
    v_mfma_f32_32x32x16_bf16 v[160:175], a[192:195], a[56:59], v[160:175]
    ds_read_b64_tr_b16 a[184:185], v42 offset:32768
    ds_read_b64_tr_b16 a[186:187], v42 offset:33024
    global_load_lds_dwordx4 v11, s[22:23] offset:3072
    v_add_u32 v10, 196608, v10
    v_add_u32 v11, 196608, v11
    v_mul_f32 v73, v89, v153
    v_mfma_f32_32x32x16_bf16 v[176:191], a[196:199], a[56:59], v[176:191]
    s_mov_b32 m0, s49
    ds_read_b64_tr_b16 a[188:189], v42 offset:34816
    ds_read_b64_tr_b16 a[190:191], v42 offset:35072
    v_mul_f32 v74, v90, v154
    v_mul_f32 v75, v91, v155
    v_mul_f32 v76, v92, v156
    v_mul_f32 v77, v93, v157
    v_mfma_f32_32x32x16_bf16 v[160:175], a[160:163], a[60:63], v[160:175]
    ds_read_b64_tr_b16 a[192:193], v43 offset:32768
    ds_read_b64_tr_b16 a[194:195], v43 offset:33024
    v_mul_f32 v78, v94, v158
    v_mul_f32 v79, v95, v159
    v_cvt_pk_bf16_f32 v152, v72, v73
    v_cvt_pk_bf16_f32 v153, v74, v75
    v_mfma_f32_32x32x16_bf16 v[176:191], a[164:167], a[60:63], v[176:191]
    s_waitcnt lgkmcnt(6)
    ds_read_b64_tr_b16 a[196:197], v43 offset:34816
    ds_read_b64_tr_b16 a[198:199], v43 offset:35072
    global_load_lds_dwordx4 v10, s[20:21] offset:0
    v_cvt_pk_bf16_f32 v154, v76, v77
    v_cvt_pk_bf16_f32 v155, v78, v79
    v_mov_b32 v100, 0
    v_mfma_f32_32x32x16_bf16 v[160:175], a[168:171], a[64:67], v[160:175]
    ds_read_b64_tr_b16 a[160:161], v40 offset:40960
    ds_read_b64_tr_b16 a[162:163], v40 offset:41216
    v_mov_b32 v101, 0
    v_mov_b32 v102, 0
    v_mov_b32 v103, 0
    v_mov_b32 v108, 0
    v_mfma_f32_32x32x16_bf16 v[176:191], a[172:175], a[64:67], v[176:191]
    ds_read_b64_tr_b16 a[164:165], v40 offset:43008
    ds_read_b64_tr_b16 a[166:167], v40 offset:43264
    v_mov_b32 v109, 0
    v_mov_b32 v110, 0
    v_mov_b32 v111, 0
    v_smfmac_f32_16x16x64_bf16 a[212:215], a[242:245], a[168:175], v17
    v_mfma_f32_32x32x16_bf16 v[160:175], a[176:179], a[68:71], v[160:175]
    s_add_u32 s7, s56, 131072
    ds_read_b64_tr_b16 a[168:169], v41 offset:40960
    ds_read_b64_tr_b16 a[170:171], v41 offset:41216
    global_load_lds_dwordx4 v11, s[20:21] offset:1024
    v_mfma_f32_32x32x16_bf16 v[176:191], a[180:183], a[68:71], v[176:191]
    s_waitcnt lgkmcnt(6)
    ds_read_b64_tr_b16 a[172:173], v41 offset:43008
    ds_read_b64_tr_b16 a[174:175], v41 offset:43264
    buffer_store_dwordx4 v[120:123], v16, s[24:27], s7 offen offset:128 sc1
    v_mfma_f32_32x32x16_bf16 v[160:175], a[184:187], a[72:75], v[160:175]
    ds_read_b64_tr_b16 a[176:177], v42 offset:40960
    ds_read_b64_tr_b16 a[178:179], v42 offset:41216
    v_mfma_f32_32x32x16_bf16 v[176:191], a[188:191], a[72:75], v[176:191]
    ds_read_b64_tr_b16 a[180:181], v42 offset:43008
    ds_read_b64_tr_b16 a[182:183], v42 offset:43264
    global_load_lds_dwordx4 v10, s[22:23] offset:2048
    v_mfma_f32_32x32x16_bf16 v[160:175], a[192:195], a[76:79], v[160:175]
    ds_read_b64_tr_b16 a[184:185], v43 offset:40960
    ds_read_b64_tr_b16 a[186:187], v43 offset:41216
    v_mfma_f32_32x32x16_bf16 v[176:191], a[196:199], a[76:79], v[176:191]
    s_waitcnt lgkmcnt(6)
    ds_read_b64_tr_b16 a[188:189], v43 offset:43008
    ds_read_b64_tr_b16 a[190:191], v43 offset:43264
    v_mfma_f32_32x32x16_bf16 v[160:175], a[160:163], a[80:83], v[160:175]
    ds_read_b64_tr_b16 a[192:193], v40 offset:49152
    ds_read_b64_tr_b16 a[194:195], v40 offset:49408
    global_load_lds_dwordx4 v11, s[22:23] offset:3072
    v_add_u32 v10, 196608, v10
    v_add_u32 v11, 196608, v11
    v_mfma_f32_32x32x16_bf16 v[176:191], a[164:167], a[80:83], v[176:191]
    s_mov_b32 m0, s50
    ds_read_b64_tr_b16 a[196:197], v40 offset:51200
    ds_read_b64_tr_b16 a[198:199], v40 offset:51456
    v_smfmac_f32_16x16x64_bf16 a[212:215], a[242:245], a[160:167], v17
    v_mfma_f32_32x32x16_bf16 v[160:175], a[168:171], a[84:87], v[160:175]
    ds_read_b64_tr_b16 a[160:161], v41 offset:49152
    ds_read_b64_tr_b16 a[162:163], v41 offset:49408
    v_mfma_f32_32x32x16_bf16 v[176:191], a[172:175], a[84:87], v[176:191]
    s_waitcnt lgkmcnt(6)
    ds_read_b64_tr_b16 a[164:165], v41 offset:51200
    ds_read_b64_tr_b16 a[166:167], v41 offset:51456
    global_load_lds_dwordx4 v10, s[20:21] offset:0
    v_mfma_f32_32x32x16_bf16 v[160:175], a[176:179], a[88:91], v[160:175]
    s_add_u32 s6, s57, 0
    ds_read_b64_tr_b16 a[168:169], v42 offset:49152
    ds_read_b64_tr_b16 a[170:171], v42 offset:49408
    buffer_store_dwordx4 v[128:131], v16, s[24:27], s6 offen offset:0 sc1
    v_mfma_f32_32x32x16_bf16 v[176:191], a[180:183], a[88:91], v[176:191]
    ds_read_b64_tr_b16 a[172:173], v42 offset:51200
    ds_read_b64_tr_b16 a[174:175], v42 offset:51456
    v_mfma_f32_32x32x16_bf16 v[160:175], a[184:187], a[92:95], v[160:175]
    ds_read_b64_tr_b16 a[176:177], v43 offset:49152
    ds_read_b64_tr_b16 a[178:179], v43 offset:49408
    global_load_lds_dwordx4 v11, s[20:21] offset:1024
    v_mfma_f32_32x32x16_bf16 v[176:191], a[188:191], a[92:95], v[176:191]
    s_waitcnt lgkmcnt(6)
    ds_read_b64_tr_b16 a[180:181], v43 offset:51200
    ds_read_b64_tr_b16 a[182:183], v43 offset:51456
    v_mfma_f32_32x32x16_bf16 v[160:175], a[192:195], a[96:99], v[160:175]
    ds_read_b64_tr_b16 a[184:185], v40 offset:57344
    ds_read_b64_tr_b16 a[186:187], v40 offset:57600
    v_mfma_f32_32x32x16_bf16 v[176:191], a[196:199], a[96:99], v[176:191]
    ds_read_b64_tr_b16 a[188:189], v40 offset:59392
    ds_read_b64_tr_b16 a[190:191], v40 offset:59648
    global_load_lds_dwordx4 v10, s[22:23] offset:2048
    v_xor_b32 v40, 0x10000, v40
    v_smfmac_f32_16x16x64_bf16 a[212:215], a[242:245], a[192:199], v17
    v_mfma_f32_32x32x16_bf16 v[160:175], a[160:163], a[100:103], v[160:175]
    ds_read_b64_tr_b16 a[192:193], v41 offset:57344
    ds_read_b64_tr_b16 a[194:195], v41 offset:57600
    v_mfma_f32_32x32x16_bf16 v[176:191], a[164:167], a[100:103], v[176:191]
    s_waitcnt lgkmcnt(6)
    ds_read_b64_tr_b16 a[196:197], v41 offset:59392
    ds_read_b64_tr_b16 a[198:199], v41 offset:59648
    v_xor_b32 v41, 0x10000, v41
    v_mfma_f32_32x32x16_bf16 v[160:175], a[168:171], a[104:107], v[160:175]
    ds_read_b64_tr_b16 a[160:161], v42 offset:57344
    ds_read_b64_tr_b16 a[162:163], v42 offset:57600
    global_load_lds_dwordx4 v11, s[22:23] offset:3072
    v_add_u32 v10, 196608, v10
    v_add_u32 v11, 196608, v11
    v_mfma_f32_32x32x16_bf16 v[176:191], a[172:175], a[104:107], v[176:191]
    ds_read_b64_tr_b16 a[164:165], v42 offset:59392
    ds_read_b64_tr_b16 a[166:167], v42 offset:59648
    v_xor_b32 v42, 0x10000, v42
    v_mfma_f32_32x32x16_bf16 v[160:175], a[176:179], a[108:111], v[160:175]
    s_add_u32 s7, s57, 0
    ds_read_b64_tr_b16 a[168:169], v43 offset:57344
    ds_read_b64_tr_b16 a[170:171], v43 offset:57600
    buffer_store_dwordx4 v[136:139], v16, s[24:27], s7 offen offset:128 sc1
    v_mfma_f32_32x32x16_bf16 v[176:191], a[180:183], a[108:111], v[176:191]
    s_waitcnt lgkmcnt(6)
    ds_read_b64_tr_b16 a[172:173], v43 offset:59392
    ds_read_b64_tr_b16 a[174:175], v43 offset:59648
    v_xor_b32 v43, 0x10000, v43
    v_mfma_f32_32x32x16_bf16 v[160:175], a[184:187], a[112:115], v[160:175]
    s_waitcnt vmcnt(11)
    s_barrier
    ds_read_b64_tr_b16 a[176:177], v40 offset:0
    ds_read_b64_tr_b16 a[178:179], v40 offset:256
    v_mfma_f32_32x32x16_bf16 v[176:191], a[188:191], a[112:115], v[176:191]
    s_mov_b32 m0, s51
    ds_read_b64_tr_b16 a[180:181], v40 offset:2048
    ds_read_b64_tr_b16 a[182:183], v40 offset:2304
    global_load_lds_dwordx4 v10, s[20:21] offset:0
    v_smfmac_f32_16x16x64_bf16 a[212:215], a[242:245], a[184:191], v17
    v_mfma_f32_32x32x16_bf16 v[160:175], a[192:195], a[116:119], v[160:175]
    ds_read_b64_tr_b16 a[184:185], v41 offset:0
    ds_read_b64_tr_b16 a[186:187], v41 offset:256
    v_mfma_f32_32x32x16_bf16 v[176:191], a[196:199], a[116:119], v[176:191]
    s_waitcnt lgkmcnt(6)
    ds_read_b64_tr_b16 a[188:189], v41 offset:2048
    ds_read_b64_tr_b16 a[190:191], v41 offset:2304
    v_mfma_f32_32x32x16_bf16 v[160:175], a[160:163], a[120:123], v[160:175]
    ds_read_b64_tr_b16 a[192:193], v42 offset:0
    ds_read_b64_tr_b16 a[194:195], v42 offset:256
    global_load_lds_dwordx4 v11, s[20:21] offset:1024
    v_mfma_f32_32x32x16_bf16 v[176:191], a[164:167], a[120:123], v[176:191]
    ds_read_b64_tr_b16 a[196:197], v42 offset:2048
    ds_read_b64_tr_b16 a[198:199], v42 offset:2304
    v_mfma_f32_32x32x16_bf16 v[160:175], a[168:171], a[124:127], v[160:175]
    ds_read_b64_tr_b16 a[160:161], v43 offset:0
    ds_read_b64_tr_b16 a[162:163], v43 offset:256
    v_mfma_f32_32x32x16_bf16 v[176:191], a[172:175], a[124:127], v[176:191]
    s_waitcnt lgkmcnt(6)
    ds_read_b64_tr_b16 a[164:165], v43 offset:2048
    ds_read_b64_tr_b16 a[166:167], v43 offset:2304
    global_load_lds_dwordx4 v10, s[22:23] offset:2048
    v_mfma_f32_32x32x16_bf16 v[160:175], a[176:179], a[128:131], v[160:175]
    s_add_u32 s6, s57, 131072
    ds_read_b64_tr_b16 a[168:169], v40 offset:8192
    ds_read_b64_tr_b16 a[170:171], v40 offset:8448
    buffer_store_dwordx4 v[144:147], v16, s[24:27], s6 offen offset:0 sc1
    v_mfma_f32_32x32x16_bf16 v[176:191], a[180:183], a[128:131], v[176:191]
    ds_read_b64_tr_b16 a[172:173], v40 offset:10240
    ds_read_b64_tr_b16 a[174:175], v40 offset:10496
    v_smfmac_f32_16x16x64_bf16 a[212:215], a[242:245], a[176:183], v17
    v_mfma_f32_32x32x16_bf16 v[160:175], a[184:187], a[132:135], v[160:175]
    ds_read_b64_tr_b16 a[176:177], v41 offset:8192
    ds_read_b64_tr_b16 a[178:179], v41 offset:8448
    global_load_lds_dwordx4 v11, s[22:23] offset:3072
    v_add_u32 v10, 196608, v10
    v_add_u32 v11, 196608, v11
    v_mfma_f32_32x32x16_bf16 v[176:191], a[188:191], a[132:135], v[176:191]
    s_waitcnt lgkmcnt(6)
    s_mov_b32 m0, s52
    ds_read_b64_tr_b16 a[180:181], v41 offset:10240
    ds_read_b64_tr_b16 a[182:183], v41 offset:10496
    v_mfma_f32_32x32x16_bf16 v[160:175], a[192:195], a[136:139], v[160:175]
    ds_read_b64_tr_b16 a[184:185], v42 offset:8192
    ds_read_b64_tr_b16 a[186:187], v42 offset:8448
    v_mfma_f32_32x32x16_bf16 v[176:191], a[196:199], a[136:139], v[176:191]
    ds_read_b64_tr_b16 a[188:189], v42 offset:10240
    ds_read_b64_tr_b16 a[190:191], v42 offset:10496
    global_load_lds_dwordx4 v10, s[20:21] offset:0
    v_mfma_f32_32x32x16_bf16 v[160:175], a[160:163], a[140:143], v[160:175]
    ds_read_b64_tr_b16 a[192:193], v43 offset:8192
    ds_read_b64_tr_b16 a[194:195], v43 offset:8448
    v_mfma_f32_32x32x16_bf16 v[176:191], a[164:167], a[140:143], v[176:191]
    s_waitcnt lgkmcnt(6)
    ds_read_b64_tr_b16 a[196:197], v43 offset:10240
    ds_read_b64_tr_b16 a[198:199], v43 offset:10496
    v_smfmac_f32_16x16x64_bf16 a[212:215], a[242:245], a[168:175], v17
    v_mfma_f32_32x32x16_bf16 v[160:175], a[168:171], a[144:147], v[160:175]
    ds_read_b64_tr_b16 a[160:161], v12 offset:16384
    ds_read_b64_tr_b16 a[162:163], v12 offset:16896
    global_load_lds_dwordx4 v11, s[20:21] offset:1024
    v_mfma_f32_32x32x16_bf16 v[176:191], a[172:175], a[144:147], v[176:191]
    ds_read_b64_tr_b16 a[164:165], v12 offset:18432
    ds_read_b64_tr_b16 a[166:167], v12 offset:18944
    v_accvgpr_read_b32 v92, a212
    v_accvgpr_read_b32 v93, a213
    v_add_f32 v92, v92, v93
    v_cvt_pk_bf16_f32 v93, v92, v92
    v_mfma_f32_32x32x16_bf16 v[160:175], a[176:179], a[148:151], v[160:175]
    s_add_u32 s7, s57, 131072
    ds_read_b64_tr_b16 a[168:169], v13 offset:16384
    ds_read_b64_tr_b16 a[170:171], v13 offset:16896
    v_and_b32 v93, 0xffff0000, v93
    v_sub_f32 v92, v92, v93
    v_cvt_pk_bf16_f32 v92, v93, v92
    v_mfma_f32_32x32x16_bf16 v[176:191], a[180:183], a[148:151], v[176:191]
    s_waitcnt lgkmcnt(6)
    ds_read_b64_tr_b16 a[172:173], v13 offset:18432
    ds_read_b64_tr_b16 a[174:175], v13 offset:18944
    global_load_lds_dwordx4 v10, s[22:23] offset:2048
    v_mfma_f32_32x32x16_bf16 v[160:175], a[184:187], a[152:155], v[160:175]
    ds_read_b64_tr_b16 a[176:177], v14 offset:16384
    ds_read_b64_tr_b16 a[178:179], v14 offset:16896
    ds_write_b32 v0, v92 offset:3072
    v_mfma_f32_32x32x16_bf16 v[176:191], a[188:191], a[152:155], v[176:191]
    ds_read_b64_tr_b16 a[180:181], v14 offset:18432
    ds_read_b64_tr_b16 a[182:183], v14 offset:18944
    buffer_store_dwordx4 v[152:155], v16, s[24:27], s7 offen offset:128 sc1
    v_mfma_f32_32x32x16_bf16 v[160:175], a[192:195], a[156:159], v[160:175]
    s_waitcnt lgkmcnt(2)
    s_barrier
    ds_read_b64_tr_b16 a[184:185], v15 offset:16384
    ds_read_b64_tr_b16 a[186:187], v15 offset:16896
    v_mfma_f32_32x32x16_bf16 v[176:191], a[196:199], a[156:159], v[176:191]
    s_waitcnt lgkmcnt(7)
    ds_read_b64_tr_b16 a[188:189], v15 offset:18432
    ds_read_b64_tr_b16 a[190:191], v15 offset:18944
    global_load_lds_dwordx4 v11, s[22:23] offset:3072
    ds_read_b128 a[224:227], v39 offset:3072
    ds_read_b128 a[228:231], v39 offset:3584
    v_add_u32 v10, 196608, v10
    v_add_u32 v11, 196608, v11
    v_mfma_f32_32x32x16_bf16 v[192:207], a[160:163], a[0:3], 0
    s_mov_b32 m0, s54
    ds_read_b64_tr_b16 a[192:193], v6 offset:16384
    ds_read_b64_tr_b16 a[194:195], v6 offset:16896
    buffer_load_dwordx4 v19, s[36:39], s91 offen lds
    v_mfma_f32_32x32x16_bf16 v[224:239], a[164:167], a[0:3], 0
    s_bitset1_b32 m0, 10
    ds_read_b64_tr_b16 a[196:197], v6 offset:18432
    ds_read_b64_tr_b16 a[198:199], v6 offset:18944
    buffer_load_dwordx4 v20, s[36:39], s92 offen lds
    v_smfmac_f32_16x16x64_bf16 v[100:103], a[242:245], a[160:167], v17
    s_waitcnt lgkmcnt(5)
    v_mfma_f32_32x32x16_bf16 v[160:175], a[224:227], a[246:249], v[160:175]
    v_mfma_f32_32x32x16_bf16 v[208:223], a[168:171], a[0:3], 0
    s_bitset1_b32 m0, 11
    ds_read_b64_tr_b16 a[160:161], v7 offset:16384
    ds_read_b64_tr_b16 a[162:163], v7 offset:16896
    buffer_load_dwordx4 v22, s[36:39], s94 offen lds
    s_waitcnt lgkmcnt(6)
    v_mfma_f32_32x32x16_bf16 v[176:191], a[228:231], a[246:249], v[176:191]
    v_mfma_f32_32x32x16_bf16 v[240:255], a[172:175], a[0:3], 0
    s_waitcnt lgkmcnt(8)
    s_bitset0_b32 m0, 10
    ds_read_b64_tr_b16 a[164:165], v7 offset:18432
    ds_read_b64_tr_b16 a[166:167], v7 offset:18944
    buffer_load_dwordx4 v21, s[36:39], s93 offen lds
    v_smfmac_f32_16x16x64_bf16 v[108:111], a[242:245], a[168:175], v17
    v_mfma_f32_32x32x16_bf16 v[192:207], a[176:179], a[4:7], v[192:207]
    ds_read_b64_tr_b16 a[168:169], v2 offset:16384
    ds_read_b64_tr_b16 a[170:171], v2 offset:16896
    v_mul_f32 v80, v29, v160
    v_mul_f32 v81, v29, v161
    v_mul_f32 v82, v29, v162
    v_mul_f32 v83, v29, v163
    v_mfma_f32_32x32x16_bf16 v[224:239], a[180:183], a[4:7], v[224:239]
    ds_read_b64_tr_b16 a[172:173], v2 offset:18432
    ds_read_b64_tr_b16 a[174:175], v2 offset:18944
    v_exp_f32 v80, v80
    v_exp_f32 v81, v81
    v_mfma_f32_32x32x16_bf16 v[208:223], a[184:187], a[4:7], v[208:223]
    ds_read_b64_tr_b16 a[176:177], v3 offset:16384
    ds_read_b64_tr_b16 a[178:179], v3 offset:16896
    v_exp_f32 v82, v82
    v_exp_f32 v83, v83
    v_mfma_f32_32x32x16_bf16 v[240:255], a[188:191], a[4:7], v[240:255]
    s_waitcnt lgkmcnt(6)
    ds_read_b64_tr_b16 a[180:181], v3 offset:18432
    ds_read_b64_tr_b16 a[182:183], v3 offset:18944
    v_fma_f32 v80, v80, v28, v28
    v_fma_f32 v81, v81, v28, v28
    v_fma_f32 v82, v82, v28, v28
    v_fma_f32 v83, v83, v28, v28
    v_mfma_f32_32x32x16_bf16 v[192:207], a[192:195], a[8:11], v[192:207]
    s_waitcnt vmcnt(15)
    s_barrier
    ds_read_b64_tr_b16 a[184:185], v12 offset:32768
    ds_read_b64_tr_b16 a[186:187], v12 offset:33280
    v_mfma_f32_32x32x16_bf16 v[224:239], a[196:199], a[8:11], v[224:239]
    s_mov_b32 m0, s62
    ds_read_b64_tr_b16 a[188:189], v12 offset:34816
    ds_read_b64_tr_b16 a[190:191], v12 offset:35328
    global_load_lds_dwordx4 v10, s[20:21] offset:0
    v_rcp_f32 v80, v80
    v_mfma_f32_32x32x16_bf16 v[208:223], a[160:163], a[8:11], v[208:223]
    ds_read_b64_tr_b16 a[192:193], v13 offset:32768
    ds_read_b64_tr_b16 a[194:195], v13 offset:33280
    v_rcp_f32 v81, v81
    v_rcp_f32 v82, v82
    v_mfma_f32_32x32x16_bf16 v[240:255], a[164:167], a[8:11], v[240:255]
    s_waitcnt lgkmcnt(6)
    ds_read_b64_tr_b16 a[196:197], v13 offset:34816
    ds_read_b64_tr_b16 a[198:199], v13 offset:35328
    v_rcp_f32 v83, v83
    v_mul_f32 v84, v80, v176
    v_mul_f32 v85, v81, v177
    v_mfma_f32_32x32x16_bf16 v[192:207], a[168:171], a[12:15], v[192:207]
    ds_read_b64_tr_b16 a[160:161], v14 offset:32768
    ds_read_b64_tr_b16 a[162:163], v14 offset:33280
    global_load_lds_dwordx4 v11, s[20:21] offset:1024
    v_mul_f32 v86, v82, v178
    v_mul_f32 v87, v83, v179
    v_cvt_pk_bf16_f32 v160, v84, v85
    v_mfma_f32_32x32x16_bf16 v[224:239], a[172:175], a[12:15], v[224:239]
    ds_read_b64_tr_b16 a[164:165], v14 offset:34816
    ds_read_b64_tr_b16 a[166:167], v14 offset:35328
    v_cvt_pk_bf16_f32 v161, v86, v87
    v_mul_f32 v64, v29, v164
    v_mul_f32 v65, v29, v165
    v_mul_f32 v66, v29, v166
    v_mfma_f32_32x32x16_bf16 v[208:223], a[176:179], a[12:15], v[208:223]
    ds_read_b64_tr_b16 a[168:169], v15 offset:32768
    ds_read_b64_tr_b16 a[170:171], v15 offset:33280
    v_mul_f32 v67, v29, v167
    v_exp_f32 v64, v64
    v_mfma_f32_32x32x16_bf16 v[240:255], a[180:183], a[12:15], v[240:255]
    s_waitcnt lgkmcnt(6)
    ds_read_b64_tr_b16 a[172:173], v15 offset:34816
    ds_read_b64_tr_b16 a[174:175], v15 offset:35328
    global_load_lds_dwordx4 v10, s[22:23] offset:2048
    v_exp_f32 v65, v65
    v_mfma_f32_32x32x16_bf16 v[192:207], a[184:187], a[16:19], v[192:207]
    s_waitcnt vmcnt(8)
    s_barrier
    ds_read_b64_tr_b16 a[176:177], v6 offset:32768
    ds_read_b64_tr_b16 a[178:179], v6 offset:33280
    s_mov_b32 s44, 0x1000000
L_spNV:
    v_cmp_eq_u32 vcc, 0, v33
    s_nop 0
    s_cbranch_vccz L_okNV
    s_sub_u32 s44, s44, 1
    s_cbranch_scc1 L_okNV
    s_sleep 1
    buffer_load_dword v33, v37, s[32:35], 0 offen sc1
    s_waitcnt vmcnt(0)
    s_branch L_spNV
L_okNV:
    v_readfirstlane_b32 s84, v33
    s_cmp_lg_u32 s3, 0
    s_cbranch_scc1 L_flQV
    s_mov_b64 exec, 1
    v_mov_b32 v42, s84
    v_mov_b32 v43, 0
    buffer_store_dword v42, v43, s[24:27], s95 offen sc1
    s_mov_b64 exec, -1
L_flQV:
    v_mfma_f32_32x32x16_bf16 v[224:239], a[188:191], a[16:19], v[224:239]
    ds_read_b64_tr_b16 a[180:181], v6 offset:34816
    ds_read_b64_tr_b16 a[182:183], v6 offset:35328
    v_exp_f32 v66, v66
    v_exp_f32 v67, v67
    v_smfmac_f32_16x16x64_bf16 v[100:103], a[242:245], a[184:191], v17
    v_fma_f32 v64, v64, v28, v28
    v_fma_f32 v65, v65, v28, v28
    v_mfma_f32_32x32x16_bf16 v[208:223], a[192:195], a[16:19], v[208:223]
    ds_read_b64_tr_b16 a[184:185], v7 offset:32768
    ds_read_b64_tr_b16 a[186:187], v7 offset:33280
    global_load_lds_dwordx4 v11, s[22:23] offset:3072
    v_add_u32 v10, 196608, v10
    v_add_u32 v11, 196608, v11
    v_fma_f32 v66, v66, v28, v28
    v_mfma_f32_32x32x16_bf16 v[240:255], a[196:199], a[16:19], v[240:255]
    s_waitcnt lgkmcnt(6)
    s_mov_b32 m0, s47
    ds_read_b64_tr_b16 a[188:189], v7 offset:34816
    ds_read_b64_tr_b16 a[190:191], v7 offset:35328
    v_fma_f32 v67, v67, v28, v28
    v_rcp_f32 v64, v64
    v_smfmac_f32_16x16x64_bf16 v[108:111], a[242:245], a[192:199], v17
    v_rcp_f32 v65, v65
    v_mfma_f32_32x32x16_bf16 v[192:207], a[160:163], a[20:23], v[192:207]
    ds_read_b64_tr_b16 a[192:193], v2 offset:32768
    ds_read_b64_tr_b16 a[194:195], v2 offset:33280
    v_rcp_f32 v66, v66
    v_rcp_f32 v67, v67
    v_mfma_f32_32x32x16_bf16 v[224:239], a[164:167], a[20:23], v[224:239]
    ds_read_b64_tr_b16 a[196:197], v2 offset:34816
    ds_read_b64_tr_b16 a[198:199], v2 offset:35328
    global_load_lds_dwordx4 v10, s[20:21] offset:0
    v_mul_f32 v68, v64, v180
    v_mul_f32 v69, v65, v181
    v_mul_f32 v70, v66, v182
    v_mfma_f32_32x32x16_bf16 v[208:223], a[168:171], a[20:23], v[208:223]
    ds_read_b64_tr_b16 a[160:161], v3 offset:32768
    ds_read_b64_tr_b16 a[162:163], v3 offset:33280
    v_mul_f32 v71, v67, v183
    v_cvt_pk_bf16_f32 v162, v68, v69
    v_cvt_pk_bf16_f32 v163, v70, v71
    v_mul_f32 v72, v29, v168
    v_mfma_f32_32x32x16_bf16 v[240:255], a[172:175], a[20:23], v[240:255]
    s_waitcnt lgkmcnt(6)
    ds_read_b64_tr_b16 a[164:165], v3 offset:34816
    ds_read_b64_tr_b16 a[166:167], v3 offset:35328
    v_mul_f32 v73, v29, v169
    v_mul_f32 v74, v29, v170
    v_mul_f32 v75, v29, v171
    v_mfma_f32_32x32x16_bf16 v[192:207], a[176:179], a[24:27], v[192:207]
    ds_read_b64_tr_b16 a[168:169], v12 offset:49152
    ds_read_b64_tr_b16 a[170:171], v12 offset:49664
    global_load_lds_dwordx4 v11, s[20:21] offset:1024
    v_exp_f32 v72, v72
    v_mfma_f32_32x32x16_bf16 v[224:239], a[180:183], a[24:27], v[224:239]
    ds_read_b64_tr_b16 a[172:173], v12 offset:51200
    ds_read_b64_tr_b16 a[174:175], v12 offset:51712
    v_xor_b32 v12, 0x10000, v12
    v_exp_f32 v73, v73
    v_mfma_f32_32x32x16_bf16 v[208:223], a[184:187], a[24:27], v[208:223]
    ds_read_b64_tr_b16 a[176:177], v13 offset:49152
    ds_read_b64_tr_b16 a[178:179], v13 offset:49664
    v_exp_f32 v74, v74
    v_exp_f32 v75, v75
    v_mfma_f32_32x32x16_bf16 v[240:255], a[188:191], a[24:27], v[240:255]
    s_waitcnt lgkmcnt(6)
    ds_read_b64_tr_b16 a[180:181], v13 offset:51200
    ds_read_b64_tr_b16 a[182:183], v13 offset:51712
    global_load_lds_dwordx4 v10, s[22:23] offset:2048
    v_xor_b32 v13, 0x10000, v13
    v_fma_f32 v72, v72, v28, v28
    v_fma_f32 v73, v73, v28, v28
    v_mfma_f32_32x32x16_bf16 v[192:207], a[192:195], a[28:31], v[192:207]
    ds_read_b64_tr_b16 a[184:185], v14 offset:49152
    ds_read_b64_tr_b16 a[186:187], v14 offset:49664
    v_fma_f32 v74, v74, v28, v28
    v_fma_f32 v75, v75, v28, v28
    v_rcp_f32 v72, v72
    v_mfma_f32_32x32x16_bf16 v[224:239], a[196:199], a[28:31], v[224:239]
    ds_read_b64_tr_b16 a[188:189], v14 offset:51200
    ds_read_b64_tr_b16 a[190:191], v14 offset:51712
    v_xor_b32 v14, 0x10000, v14
    v_rcp_f32 v73, v73
    v_mfma_f32_32x32x16_bf16 v[208:223], a[160:163], a[28:31], v[208:223]
    ds_read_b64_tr_b16 a[192:193], v15 offset:49152
    ds_read_b64_tr_b16 a[194:195], v15 offset:49664
    global_load_lds_dwordx4 v11, s[22:23] offset:3072
    v_add_u32 v10, 196608, v10
    v_add_u32 v11, 196608, v11
    v_mfma_f32_32x32x16_bf16 v[240:255], a[164:167], a[28:31], v[240:255]
    s_waitcnt lgkmcnt(6)
    ds_read_b64_tr_b16 a[196:197], v15 offset:51200
    ds_read_b64_tr_b16 a[198:199], v15 offset:51712
    v_xor_b32 v15, 0x10000, v15
    v_rcp_f32 v74, v74
    v_mfma_f32_32x32x16_bf16 v[192:207], a[168:171], a[32:35], v[192:207]
    ds_read_b64_tr_b16 a[160:161], v6 offset:49152
    ds_read_b64_tr_b16 a[162:163], v6 offset:49664
    v_rcp_f32 v75, v75
    v_mul_f32 v76, v72, v184
    v_mul_f32 v77, v73, v185
    v_mfma_f32_32x32x16_bf16 v[224:239], a[172:175], a[32:35], v[224:239]
    ds_read_b64_tr_b16 a[164:165], v6 offset:51200
    ds_read_b64_tr_b16 a[166:167], v6 offset:51712
    v_xor_b32 v6, 0x10000, v6
    v_mul_f32 v78, v74, v186
    v_mul_f32 v79, v75, v187
    v_smfmac_f32_16x16x64_bf16 v[100:103], a[242:245], a[168:175], v17
    v_cvt_pk_bf16_f32 v168, v76, v77
    v_cvt_pk_bf16_f32 v169, v78, v79
    v_mul_f32 v80, v29, v172
    v_mfma_f32_32x32x16_bf16 v[208:223], a[176:179], a[32:35], v[208:223]
    ds_read_b64_tr_b16 a[168:169], v7 offset:49152
    ds_read_b64_tr_b16 a[170:171], v7 offset:49664
    v_mul_f32 v81, v29, v173
    v_mul_f32 v82, v29, v174
    v_mul_f32 v83, v29, v175
    v_mfma_f32_32x32x16_bf16 v[240:255], a[180:183], a[32:35], v[240:255]
    s_waitcnt lgkmcnt(6)
    ds_read_b64_tr_b16 a[172:173], v7 offset:51200
    ds_read_b64_tr_b16 a[174:175], v7 offset:51712
    v_xor_b32 v7, 0x10000, v7
    v_exp_f32 v80, v80
    v_smfmac_f32_16x16x64_bf16 v[108:111], a[242:245], a[176:183], v17
    v_exp_f32 v81, v81
    v_mfma_f32_32x32x16_bf16 v[192:207], a[184:187], a[36:39], v[192:207]
    ds_read_b64_tr_b16 a[176:177], v2 offset:49152
    ds_read_b64_tr_b16 a[178:179], v2 offset:49664
    v_exp_f32 v82, v82
    v_exp_f32 v83, v83
    v_mfma_f32_32x32x16_bf16 v[224:239], a[188:191], a[36:39], v[224:239]
    ds_read_b64_tr_b16 a[180:181], v2 offset:51200
    ds_read_b64_tr_b16 a[182:183], v2 offset:51712
    v_xor_b32 v2, 0x10000, v2
    v_fma_f32 v80, v80, v28, v28
    v_fma_f32 v81, v81, v28, v28
    v_fma_f32 v82, v82, v28, v28
    v_mfma_f32_32x32x16_bf16 v[208:223], a[192:195], a[36:39], v[208:223]
    ds_read_b64_tr_b16 a[184:185], v3 offset:49152
    ds_read_b64_tr_b16 a[186:187], v3 offset:49664
    v_fma_f32 v83, v83, v28, v28
    v_rcp_f32 v80, v80
    v_mfma_f32_32x32x16_bf16 v[240:255], a[196:199], a[36:39], v[240:255]
    s_waitcnt lgkmcnt(6)
    ds_read_b64_tr_b16 a[188:189], v3 offset:51200
    ds_read_b64_tr_b16 a[190:191], v3 offset:51712
    v_xor_b32 v3, 0x10000, v3
    v_rcp_f32 v81, v81
    v_mfma_f32_32x32x16_bf16 v[192:207], a[160:163], a[40:43], v[192:207]
    s_waitcnt vmcnt(12)
    s_barrier
    ds_read_b64_tr_b16 a[192:193], v12 offset:0
    ds_read_b64_tr_b16 a[194:195], v12 offset:512
    v_mfma_f32_32x32x16_bf16 v[224:239], a[164:167], a[40:43], v[224:239]
    s_mov_b32 m0, s48
    ds_read_b64_tr_b16 a[196:197], v12 offset:2048
    ds_read_b64_tr_b16 a[198:199], v12 offset:2560
    global_load_lds_dwordx4 v10, s[20:21] offset:0
    v_rcp_f32 v82, v82
    v_mfma_f32_32x32x16_bf16 v[208:223], a[168:171], a[40:43], v[208:223]
    ds_read_b64_tr_b16 a[160:161], v13 offset:0
    ds_read_b64_tr_b16 a[162:163], v13 offset:512
    v_rcp_f32 v83, v83
    v_mul_f32 v84, v80, v188
    v_mul_f32 v85, v81, v189
    v_mfma_f32_32x32x16_bf16 v[240:255], a[172:175], a[40:43], v[240:255]
    s_waitcnt lgkmcnt(6)
    ds_read_b64_tr_b16 a[164:165], v13 offset:2048
    ds_read_b64_tr_b16 a[166:167], v13 offset:2560
    v_mul_f32 v86, v82, v190
    v_mul_f32 v87, v83, v191
    v_cvt_pk_bf16_f32 v170, v84, v85
    v_cvt_pk_bf16_f32 v171, v86, v87
    v_mfma_f32_32x32x16_bf16 v[192:207], a[176:179], a[44:47], v[192:207]
    ds_read_b64_tr_b16 a[168:169], v14 offset:0
    ds_read_b64_tr_b16 a[170:171], v14 offset:512
    global_load_lds_dwordx4 v11, s[20:21] offset:1024
    v_mfma_f32_32x32x16_bf16 v[224:239], a[180:183], a[44:47], v[224:239]
    ds_read_b64_tr_b16 a[172:173], v14 offset:2048
    ds_read_b64_tr_b16 a[174:175], v14 offset:2560
    v_mfma_f32_32x32x16_bf16 v[208:223], a[184:187], a[44:47], v[208:223]
    ds_read_b64_tr_b16 a[176:177], v15 offset:0
    ds_read_b64_tr_b16 a[178:179], v15 offset:512
    v_mfma_f32_32x32x16_bf16 v[240:255], a[188:191], a[44:47], v[240:255]
    s_waitcnt lgkmcnt(6)
    ds_read_b64_tr_b16 a[180:181], v15 offset:2048
    ds_read_b64_tr_b16 a[182:183], v15 offset:2560
    global_load_lds_dwordx4 v10, s[22:23] offset:2048
    v_mfma_f32_32x32x16_bf16 v[192:207], a[192:195], a[48:51], v[192:207]
    ds_read_b64_tr_b16 a[184:185], v6 offset:0
    ds_read_b64_tr_b16 a[186:187], v6 offset:512
    v_mfma_f32_32x32x16_bf16 v[224:239], a[196:199], a[48:51], v[224:239]
    ds_read_b64_tr_b16 a[188:189], v6 offset:2048
    ds_read_b64_tr_b16 a[190:191], v6 offset:2560
    v_smfmac_f32_16x16x64_bf16 v[100:103], a[242:245], a[192:199], v17
    v_mfma_f32_32x32x16_bf16 v[208:223], a[160:163], a[48:51], v[208:223]
    ds_read_b64_tr_b16 a[192:193], v7 offset:0
    ds_read_b64_tr_b16 a[194:195], v7 offset:512
    global_load_lds_dwordx4 v11, s[22:23] offset:3072
    v_add_u32 v10, 196608, v10
    v_add_u32 v11, 196608, v11
    v_mfma_f32_32x32x16_bf16 v[240:255], a[164:167], a[48:51], v[240:255]
    s_waitcnt lgkmcnt(6)
    s_mov_b32 m0, s49
    ds_read_b64_tr_b16 a[196:197], v7 offset:2048
    ds_read_b64_tr_b16 a[198:199], v7 offset:2560
    v_smfmac_f32_16x16x64_bf16 v[108:111], a[242:245], a[160:167], v17
    v_mfma_f32_32x32x16_bf16 v[192:207], a[168:171], a[52:55], v[192:207]
    ds_read_b64_tr_b16 a[160:161], v2 offset:0
    ds_read_b64_tr_b16 a[162:163], v2 offset:512
    v_mfma_f32_32x32x16_bf16 v[224:239], a[172:175], a[52:55], v[224:239]
    ds_read_b64_tr_b16 a[164:165], v2 offset:2048
    ds_read_b64_tr_b16 a[166:167], v2 offset:2560
    global_load_lds_dwordx4 v10, s[20:21] offset:0
    v_mfma_f32_32x32x16_bf16 v[208:223], a[176:179], a[52:55], v[208:223]
    ds_read_b64_tr_b16 a[168:169], v3 offset:0
    ds_read_b64_tr_b16 a[170:171], v3 offset:512
    global_load_lds_dwordx4 v11, s[20:21] offset:1024
    global_load_lds_dwordx4 v10, s[22:23] offset:2048
    global_load_lds_dwordx4 v11, s[22:23] offset:3072
    v_add_u32 v10, 196608, v10
    v_add_u32 v11, 196608, v11
    v_mfma_f32_32x32x16_bf16 v[240:255], a[180:183], a[52:55], v[240:255]
    s_waitcnt lgkmcnt(6)
    ds_read_b64_tr_b16 a[172:173], v3 offset:2048
    ds_read_b64_tr_b16 a[174:175], v3 offset:2560
L_p1c:
    v_mfma_f32_32x32x16_bf16 v[192:207], a[184:187], a[56:59], v[192:207]
    s_lshl_b32 s98, s5, 2
    s_add_u32 s98, s98, s3
    s_lshl_b32 s98, s98, 10
    s_min_u32 s98, s98, L_codeend-L_p1c-1024
    ds_read_b64_tr_b16 a[176:177], v12 offset:16384
    ds_read_b64_tr_b16 a[178:179], v12 offset:16896
    v_lshlrev_b32 v40, 4, v1
    v_mfma_f32_32x32x16_bf16 v[224:239], a[188:191], a[56:59], v[224:239]
    ds_read_b64_tr_b16 a[180:181], v12 offset:18432
    ds_read_b64_tr_b16 a[182:183], v12 offset:18944
    v_add_u32 v40, s98, v40
    v_mfma_f32_32x32x16_bf16 v[208:223], a[192:195], a[56:59], v[208:223]
    ds_read_b64_tr_b16 a[184:185], v13 offset:16384
    ds_read_b64_tr_b16 a[186:187], v13 offset:16896
    global_load_dwordx4 a[250:253], v40, s[0:1]
    v_mfma_f32_32x32x16_bf16 v[240:255], a[196:199], a[56:59], v[240:255]
    s_waitcnt lgkmcnt(6)
    ds_read_b64_tr_b16 a[188:189], v13 offset:18432
    ds_read_b64_tr_b16 a[190:191], v13 offset:18944
    v_mfma_f32_32x32x16_bf16 v[192:207], a[160:163], a[60:63], v[192:207]
    ds_read_b64_tr_b16 a[192:193], v14 offset:16384
    ds_read_b64_tr_b16 a[194:195], v14 offset:16896
    v_mfma_f32_32x32x16_bf16 v[224:239], a[164:167], a[60:63], v[224:239]
    ds_read_b64_tr_b16 a[196:197], v14 offset:18432
    ds_read_b64_tr_b16 a[198:199], v14 offset:18944
    v_mfma_f32_32x32x16_bf16 v[208:223], a[168:171], a[60:63], v[208:223]
    ds_read_b64_tr_b16 a[160:161], v15 offset:16384
    ds_read_b64_tr_b16 a[162:163], v15 offset:16896
    v_mfma_f32_32x32x16_bf16 v[240:255], a[172:175], a[60:63], v[240:255]
    s_waitcnt lgkmcnt(6)
    ds_read_b64_tr_b16 a[164:165], v15 offset:18432
    ds_read_b64_tr_b16 a[166:167], v15 offset:18944
    v_mfma_f32_32x32x16_bf16 v[192:207], a[176:179], a[64:67], v[192:207]
    ds_read_b64_tr_b16 a[168:169], v6 offset:16384
    ds_read_b64_tr_b16 a[170:171], v6 offset:16896
    v_mfma_f32_32x32x16_bf16 v[224:239], a[180:183], a[64:67], v[224:239]
    ds_read_b64_tr_b16 a[172:173], v6 offset:18432
    ds_read_b64_tr_b16 a[174:175], v6 offset:18944
    v_smfmac_f32_16x16x64_bf16 v[100:103], a[242:245], a[176:183], v17
    v_mfma_f32_32x32x16_bf16 v[208:223], a[184:187], a[64:67], v[208:223]
    ds_read_b64_tr_b16 a[176:177], v7 offset:16384
    ds_read_b64_tr_b16 a[178:179], v7 offset:16896
    v_mfma_f32_32x32x16_bf16 v[240:255], a[188:191], a[64:67], v[240:255]
    s_waitcnt lgkmcnt(6)
    ds_read_b64_tr_b16 a[180:181], v7 offset:18432
    ds_read_b64_tr_b16 a[182:183], v7 offset:18944
    v_smfmac_f32_16x16x64_bf16 v[108:111], a[242:245], a[184:191], v17
    v_mfma_f32_32x32x16_bf16 v[192:207], a[192:195], a[68:71], v[192:207]
    ds_read_b64_tr_b16 a[184:185], v2 offset:16384
    ds_read_b64_tr_b16 a[186:187], v2 offset:16896
    v_mfma_f32_32x32x16_bf16 v[224:239], a[196:199], a[68:71], v[224:239]
    ds_read_b64_tr_b16 a[188:189], v2 offset:18432
    ds_read_b64_tr_b16 a[190:191], v2 offset:18944
    v_mfma_f32_32x32x16_bf16 v[208:223], a[160:163], a[68:71], v[208:223]
    ds_read_b64_tr_b16 a[192:193], v3 offset:16384
    ds_read_b64_tr_b16 a[194:195], v3 offset:16896
    v_mfma_f32_32x32x16_bf16 v[240:255], a[164:167], a[68:71], v[240:255]
    s_waitcnt lgkmcnt(6)
    ds_read_b64_tr_b16 a[196:197], v3 offset:18432
    ds_read_b64_tr_b16 a[198:199], v3 offset:18944
    v_mfma_f32_32x32x16_bf16 v[192:207], a[168:171], a[72:75], v[192:207]
    s_waitcnt vmcnt(9)
    s_barrier
    ds_read_b64_tr_b16 a[160:161], v12 offset:32768
    ds_read_b64_tr_b16 a[162:163], v12 offset:33280
    v_mfma_f32_32x32x16_bf16 v[224:239], a[172:175], a[72:75], v[224:239]
    s_mov_b32 m0, s50
    ds_read_b64_tr_b16 a[164:165], v12 offset:34816
    ds_read_b64_tr_b16 a[166:167], v12 offset:35328
    global_load_lds_dwordx4 v10, s[20:21] offset:0
    v_xor_b32 v12, 0x10000, v12
    v_mfma_f32_32x32x16_bf16 v[208:223], a[176:179], a[72:75], v[208:223]
    ds_read_b64_tr_b16 a[168:169], v13 offset:32768
    ds_read_b64_tr_b16 a[170:171], v13 offset:33280
    v_mfma_f32_32x32x16_bf16 v[240:255], a[180:183], a[72:75], v[240:255]
    s_waitcnt lgkmcnt(6)
    ds_read_b64_tr_b16 a[172:173], v13 offset:34816
    ds_read_b64_tr_b16 a[174:175], v13 offset:35328
    v_xor_b32 v13, 0x10000, v13
    v_mfma_f32_32x32x16_bf16 v[192:207], a[184:187], a[76:79], v[192:207]
    ds_read_b64_tr_b16 a[176:177], v14 offset:32768
    ds_read_b64_tr_b16 a[178:179], v14 offset:33280
    global_load_lds_dwordx4 v11, s[20:21] offset:1024
    v_mfma_f32_32x32x16_bf16 v[224:239], a[188:191], a[76:79], v[224:239]
    ds_read_b64_tr_b16 a[180:181], v14 offset:34816
    ds_read_b64_tr_b16 a[182:183], v14 offset:35328
    v_xor_b32 v14, 0x10000, v14
    v_mfma_f32_32x32x16_bf16 v[208:223], a[192:195], a[76:79], v[208:223]
    ds_read_b64_tr_b16 a[184:185], v15 offset:32768
    ds_read_b64_tr_b16 a[186:187], v15 offset:33280
    v_mfma_f32_32x32x16_bf16 v[240:255], a[196:199], a[76:79], v[240:255]
    s_waitcnt lgkmcnt(6)
    ds_read_b64_tr_b16 a[188:189], v15 offset:34816
    ds_read_b64_tr_b16 a[190:191], v15 offset:35328
    global_load_lds_dwordx4 v10, s[22:23] offset:2048
    v_xor_b32 v15, 0x10000, v15
    v_mfma_f32_32x32x16_bf16 v[192:207], a[160:163], a[80:83], v[192:207]
    ds_read_b64_tr_b16 a[192:193], v6 offset:32768
    ds_read_b64_tr_b16 a[194:195], v6 offset:33280
    v_mfma_f32_32x32x16_bf16 v[224:239], a[164:167], a[80:83], v[224:239]
    ds_read_b64_tr_b16 a[196:197], v6 offset:34816
    ds_read_b64_tr_b16 a[198:199], v6 offset:35328
    v_xor_b32 v6, 0x10000, v6
    v_smfmac_f32_16x16x64_bf16 v[100:103], a[242:245], a[160:167], v17
    v_mfma_f32_32x32x16_bf16 v[208:223], a[168:171], a[80:83], v[208:223]
    ds_read_b64_tr_b16 a[160:161], v7 offset:32768
    ds_read_b64_tr_b16 a[162:163], v7 offset:33280
    global_load_lds_dwordx4 v11, s[22:23] offset:3072
    v_mfma_f32_32x32x16_bf16 v[240:255], a[172:175], a[80:83], v[240:255]
    s_waitcnt lgkmcnt(6)
    ds_read_b64_tr_b16 a[164:165], v7 offset:34816
    ds_read_b64_tr_b16 a[166:167], v7 offset:35328
    v_xor_b32 v7, 0x10000, v7
    v_smfmac_f32_16x16x64_bf16 v[108:111], a[242:245], a[168:175], v17
    v_mfma_f32_32x32x16_bf16 v[192:207], a[176:179], a[84:87], v[192:207]
    ds_read_b64_tr_b16 a[168:169], v2 offset:32768
    ds_read_b64_tr_b16 a[170:171], v2 offset:33280
    v_mfma_f32_32x32x16_bf16 v[224:239], a[180:183], a[84:87], v[224:239]
    ds_read_b64_tr_b16 a[172:173], v2 offset:34816
    ds_read_b64_tr_b16 a[174:175], v2 offset:35328
    v_xor_b32 v2, 0x10000, v2
    v_mfma_f32_32x32x16_bf16 v[208:223], a[184:187], a[84:87], v[208:223]
    ds_read_b64_tr_b16 a[176:177], v3 offset:32768
    ds_read_b64_tr_b16 a[178:179], v3 offset:33280
    buffer_load_dwordx4 v[44:47], v38, s[24:27], 0 offen sc1
    v_mfma_f32_32x32x16_bf16 v[240:255], a[188:191], a[84:87], v[240:255]
    s_waitcnt lgkmcnt(6)
    ds_read_b64_tr_b16 a[180:181], v3 offset:34816
    ds_read_b64_tr_b16 a[182:183], v3 offset:35328
    v_xor_b32 v3, 0x10000, v3
    v_mfma_f32_32x32x16_bf16 v[192:207], a[192:195], a[88:91], v[192:207]
    ds_read_b64_tr_b16 a[184:185], v12 offset:0
    ds_read_b64_tr_b16 a[186:187], v12 offset:512
    ds_read_b64_tr_b16 v[136:137], v13 offset:0
    ds_read_b64_tr_b16 v[138:139], v13 offset:512
    ds_read_b64_tr_b16 v[140:141], v13 offset:2048
    ds_read_b64_tr_b16 v[142:143], v13 offset:2560
    v_mfma_f32_32x32x16_bf16 v[224:239], a[196:199], a[88:91], v[224:239]
    ds_read_b64_tr_b16 a[188:189], v12 offset:2048
    ds_read_b64_tr_b16 a[190:191], v12 offset:2560
    v_mfma_f32_32x32x16_bf16 v[208:223], a[160:163], a[88:91], v[208:223]
    ds_read_b64_tr_b16 a[192:193], v14 offset:0
    ds_read_b64_tr_b16 a[194:195], v14 offset:512
    v_mfma_f32_32x32x16_bf16 v[240:255], a[164:167], a[88:91], v[240:255]
    s_waitcnt lgkmcnt(10)
    ds_read_b64_tr_b16 a[196:197], v14 offset:2048
    ds_read_b64_tr_b16 a[198:199], v14 offset:2560
    v_mfma_f32_32x32x16_bf16 v[192:207], a[168:171], a[92:95], v[192:207]
    ds_read_b64_tr_b16 a[160:161], v6 offset:0
    ds_read_b64_tr_b16 a[162:163], v6 offset:512
    s_waitcnt lgkmcnt(8)
    v_smfmac_f32_16x16x64_bf16 v[108:111], a[242:245], v[136:143], v17
    v_mfma_f32_32x32x16_bf16 v[224:239], a[172:175], a[92:95], v[224:239]
    ds_read_b64_tr_b16 a[164:165], v6 offset:2048
    ds_read_b64_tr_b16 a[166:167], v6 offset:2560
    v_mfma_f32_32x32x16_bf16 v[208:223], a[176:179], a[92:95], v[208:223]
    ds_read_b64_tr_b16 a[168:169], v2 offset:0
    ds_read_b64_tr_b16 a[170:171], v2 offset:512
    v_mfma_f32_32x32x16_bf16 v[240:255], a[180:183], a[92:95], v[240:255]
    s_waitcnt lgkmcnt(6)
    ds_read_b64_tr_b16 a[172:173], v2 offset:2048
    ds_read_b64_tr_b16 a[174:175], v2 offset:2560
    v_mfma_f32_32x32x16_bf16 v[192:207], a[184:187], a[96:99], v[192:207]
    s_waitcnt vmcnt(6)
    s_barrier
    ds_read_b64_tr_b16 a[176:177], v12 offset:16384
    ds_read_b64_tr_b16 a[178:179], v12 offset:16896
    ds_read_b64_tr_b16 v[136:137], v13 offset:16384
    ds_read_b64_tr_b16 v[138:139], v13 offset:16896
    ds_read_b64_tr_b16 v[140:141], v13 offset:18432
    ds_read_b64_tr_b16 v[142:143], v13 offset:18944
    v_mfma_f32_32x32x16_bf16 v[224:239], a[188:191], a[96:99], v[224:239]
    ds_read_b64_tr_b16 a[180:181], v12 offset:18432
    ds_read_b64_tr_b16 a[182:183], v12 offset:18944
    v_smfmac_f32_16x16x64_bf16 v[100:103], a[242:245], a[184:191], v17
    v_mfma_f32_32x32x16_bf16 v[192:207], a[192:195], a[100:103], v[192:207]
    ds_read_b64_tr_b16 a[184:185], v14 offset:16384
    ds_read_b64_tr_b16 a[186:187], v14 offset:16896
    v_mfma_f32_32x32x16_bf16 v[224:239], a[196:199], a[100:103], v[224:239]
    s_waitcnt lgkmcnt(10)
    ds_read_b64_tr_b16 a[188:189], v14 offset:18432
    ds_read_b64_tr_b16 a[190:191], v14 offset:18944
    v_mfma_f32_32x32x16_bf16 v[192:207], a[160:163], a[104:107], v[192:207]
    ds_read_b64_tr_b16 a[192:193], v6 offset:16384
    ds_read_b64_tr_b16 a[194:195], v6 offset:16896
    s_waitcnt lgkmcnt(8)
    v_smfmac_f32_16x16x64_bf16 v[108:111], a[242:245], v[136:143], v17
    v_mfma_f32_32x32x16_bf16 v[224:239], a[164:167], a[104:107], v[224:239]
    ds_read_b64_tr_b16 a[196:197], v6 offset:18432
    ds_read_b64_tr_b16 a[198:199], v6 offset:18944
    v_mfma_f32_32x32x16_bf16 v[192:207], a[168:171], a[108:111], v[192:207]
    ds_read_b64_tr_b16 a[160:161], v2 offset:16384
    ds_read_b64_tr_b16 a[162:163], v2 offset:16896
    s_waitcnt vmcnt(0)
    s_mov_b32 s44, 0x1000000
L_spQ:
    v_xor_b32 v44, s84, v44
    v_xor_b32 v45, s84, v45
    v_xor_b32 v46, s84, v46
    v_xor_b32 v47, s84, v47
    v_or3_b32 v44, v44, v45, v46
    v_or_b32 v44, v44, v47
    v_cmp_ne_u32 vcc, 0, v44
    s_nop 0
    s_cbranch_vccz L_okQ
    s_sub_u32 s44, s44, 1
    s_cbranch_scc1 L_okQ
    s_sleep 1
    buffer_load_dwordx4 v[44:47], v38, s[24:27], 0 offen sc1
    s_waitcnt vmcnt(0)
    s_branch L_spQ
L_okQ:
    v_mfma_f32_32x32x16_bf16 v[224:239], a[172:175], a[108:111], v[224:239]
    s_waitcnt lgkmcnt(6)
    ds_read_b64_tr_b16 a[164:165], v2 offset:18432
    ds_read_b64_tr_b16 a[166:167], v2 offset:18944
    global_load_dwordx4 a[200:203], v48, s[64:65] offset:-4096 sc1
    v_mfma_f32_32x32x16_bf16 v[192:207], a[176:179], a[112:115], v[192:207]
    ds_read_b64_tr_b16 a[168:169], v12 offset:32768
    ds_read_b64_tr_b16 a[170:171], v12 offset:33280
    ds_read_b64_tr_b16 v[136:137], v13 offset:32768
    ds_read_b64_tr_b16 v[138:139], v13 offset:33280
    ds_read_b64_tr_b16 v[140:141], v13 offset:34816
    ds_read_b64_tr_b16 v[142:143], v13 offset:35328
    v_mfma_f32_32x32x16_bf16 v[224:239], a[180:183], a[112:115], v[224:239]
    ds_read_b64_tr_b16 a[172:173], v12 offset:34816
    ds_read_b64_tr_b16 a[174:175], v12 offset:35328
    global_load_dwordx2 a[204:205], v50, s[64:65] offset:-4096 sc1
    v_mov_b32 v156, v23
    v_mov_b32 v157, v24
    v_smfmac_f32_16x16x64_bf16 v[100:103], a[242:245], a[176:183], v17
    v_mov_b32 v158, v18
    v_mfma_f32_32x32x16_bf16 v[192:207], a[184:187], a[116:119], v[192:207]
    ds_read_b64_tr_b16 a[176:177], v14 offset:32768
    ds_read_b64_tr_b16 a[178:179], v14 offset:33280
    v_mfma_f32_32x32x16_bf16 v[224:239], a[188:191], a[116:119], v[224:239]
    s_waitcnt lgkmcnt(10)
    ds_read_b64_tr_b16 a[180:181], v14 offset:34816
    ds_read_b64_tr_b16 a[182:183], v14 offset:35328
    global_load_dwordx4 a[64:67], v59, s[68:69] offset:0 sc1
    v_mfma_f32_32x32x16_bf16 v[192:207], a[192:195], a[120:123], v[192:207]
    ds_read_b64_tr_b16 a[184:185], v6 offset:32768
    ds_read_b64_tr_b16 a[186:187], v6 offset:33280
    s_waitcnt lgkmcnt(8)
    v_smfmac_f32_16x16x64_bf16 v[108:111], a[242:245], v[136:143], v17
    v_mfma_f32_32x32x16_bf16 v[224:239], a[196:199], a[120:123], v[224:239]
    ds_read_b64_tr_b16 a[188:189], v6 offset:34816
    ds_read_b64_tr_b16 a[190:191], v6 offset:35328
    global_load_dwordx2 a[68:69], v51, s[68:69] offset:0 sc1
    v_mfma_f32_32x32x16_bf16 v[192:207], a[160:163], a[124:127], v[192:207]
    ds_read_b64_tr_b16 a[192:193], v2 offset:32768
    ds_read_b64_tr_b16 a[194:195], v2 offset:33280
    v_mfma_f32_32x32x16_bf16 v[224:239], a[164:167], a[124:127], v[224:239]
    s_waitcnt lgkmcnt(6)
    ds_read_b64_tr_b16 a[196:197], v2 offset:34816
    ds_read_b64_tr_b16 a[198:199], v2 offset:35328
    global_load_dwordx4 a[70:73], v59, s[68:69] offset:512 sc1
    v_mfma_f32_32x32x16_bf16 v[192:207], a[168:171], a[128:131], v[192:207]
    s_waitcnt vmcnt(6)
    s_barrier
    ds_read_b64_tr_b16 a[160:161], v12 offset:49152
    ds_read_b64_tr_b16 a[162:163], v12 offset:49664
    ds_read_b64_tr_b16 v[144:145], v12 offset:49152
    ds_read_b64_tr_b16 v[146:147], v12 offset:49664
    ds_read_b64_tr_b16 v[148:149], v12 offset:51200
    ds_read_b64_tr_b16 v[150:151], v12 offset:51712
    v_mfma_f32_32x32x16_bf16 v[224:239], a[172:175], a[128:131], v[224:239]
    ds_read_b64_tr_b16 a[164:165], v12 offset:51200
    ds_read_b64_tr_b16 a[166:167], v12 offset:51712
    ds_read_b64_tr_b16 v[136:137], v13 offset:49152
    ds_read_b64_tr_b16 v[138:139], v13 offset:49664
    ds_read_b64_tr_b16 v[140:141], v13 offset:51200
    ds_read_b64_tr_b16 v[142:143], v13 offset:51712
    global_load_dwordx2 a[74:75], v51, s[68:69] offset:512 sc1
    v_smfmac_f32_16x16x64_bf16 v[100:103], a[242:245], a[168:175], v17
    v_mfma_f32_32x32x16_bf16 v[192:207], a[176:179], a[132:135], v[192:207]
    ds_read_b64_tr_b16 a[168:169], v14 offset:49152
    ds_read_b64_tr_b16 a[170:171], v14 offset:49664
    v_mfma_f32_32x32x16_bf16 v[224:239], a[180:183], a[132:135], v[224:239]
    s_waitcnt lgkmcnt(14)
    ds_read_b64_tr_b16 a[172:173], v14 offset:51200
    ds_read_b64_tr_b16 a[174:175], v14 offset:51712
    global_load_dwordx4 a[76:79], v59, s[70:71] offset:0 sc1
    v_mfma_f32_32x32x16_bf16 v[192:207], a[184:187], a[136:139], v[192:207]
    ds_read_b64_tr_b16 a[176:177], v6 offset:49152
    ds_read_b64_tr_b16 a[178:179], v6 offset:49664
    s_waitcnt lgkmcnt(12)
    v_smfmac_f32_16x16x64_bf16 v[100:103], a[242:245], v[144:151], v17
    v_mfma_f32_32x32x16_bf16 v[224:239], a[188:191], a[136:139], v[224:239]
    ds_read_b64_tr_b16 a[180:181], v6 offset:51200
    ds_read_b64_tr_b16 a[182:183], v6 offset:51712
    global_load_dwordx2 a[80:81], v51, s[70:71] offset:0 sc1
    s_waitcnt lgkmcnt(8)
    v_smfmac_f32_16x16x64_bf16 v[108:111], a[242:245], v[136:143], v17
    v_mfma_f32_32x32x16_bf16 v[192:207], a[192:195], a[140:143], v[192:207]
    ds_read_b64_tr_b16 a[184:185], v2 offset:49152
    ds_read_b64_tr_b16 a[186:187], v2 offset:49664
    v_mfma_f32_32x32x16_bf16 v[224:239], a[196:199], a[140:143], v[224:239]
    s_waitcnt lgkmcnt(6)
    ds_read_b64_tr_b16 a[188:189], v2 offset:51200
    ds_read_b64_tr_b16 a[190:191], v2 offset:51712
    v_add_f32 v92, v100, v101
    v_cvt_pk_bf16_f32 v93, v92, v92
    v_and_b32 v93, 0xffff0000, v93
    v_sub_f32 v92, v92, v93
    v_mfma_f32_32x32x16_bf16 v[192:207], a[160:163], a[144:147], v[192:207]
    ds_read_b64_tr_b16 a[192:193], v13 offset:0
    ds_read_b64_tr_b16 a[194:195], v13 offset:512
    v_cvt_pk_bf16_f32 v92, v93, v92
    v_add_f32 v94, v108, v109
    v_cvt_pk_bf16_f32 v95, v94, v94
    v_and_b32 v95, 0xffff0000, v95
    v_mfma_f32_32x32x16_bf16 v[224:239], a[164:167], a[144:147], v[224:239]
    ds_read_b64_tr_b16 a[196:197], v13 offset:2048
    ds_read_b64_tr_b16 a[198:199], v13 offset:2560
    global_load_dwordx4 a[82:85], v59, s[70:71] offset:512 sc1
    v_sub_f32 v94, v94, v95
    v_cvt_pk_bf16_f32 v94, v95, v94
    v_mfma_f32_32x32x16_bf16 v[192:207], a[168:171], a[148:151], v[192:207]
    ds_read_b64_tr_b16 a[160:161], v15 offset:0
    ds_read_b64_tr_b16 a[162:163], v15 offset:512
    ds_write_b32 v0, v92 offset:5120
    ds_write_b32 v0, v94 offset:6144
    v_mfma_f32_32x32x16_bf16 v[224:239], a[172:175], a[148:151], v[224:239]
    s_waitcnt lgkmcnt(8)
    ds_read_b64_tr_b16 a[164:165], v15 offset:2048
    ds_read_b64_tr_b16 a[166:167], v15 offset:2560
    global_load_dwordx2 a[86:87], v51, s[70:71] offset:512 sc1
    v_mfma_f32_32x32x16_bf16 v[192:207], a[176:179], a[152:155], v[192:207]
    s_waitcnt lgkmcnt(2)
    s_barrier
    ds_read_b64_tr_b16 a[168:169], v7 offset:0
    ds_read_b64_tr_b16 a[170:171], v7 offset:512
    v_mfma_f32_32x32x16_bf16 v[224:239], a[180:183], a[152:155], v[224:239]
    ds_read_b64_tr_b16 a[172:173], v7 offset:2048
    ds_read_b64_tr_b16 a[174:175], v7 offset:2560
    ds_read_b128 v[120:123], v39 offset:5120
    ds_read_b128 v[124:127], v39 offset:5632
    ds_read_b128 v[128:131], v39 offset:6144
    ds_read_b128 v[132:135], v39 offset:6656
    v_mfma_f32_32x32x16_bf16 v[192:207], a[184:187], a[156:159], v[192:207]
    ds_read_b64_tr_b16 a[176:177], v3 offset:0
    ds_read_b64_tr_b16 a[178:179], v3 offset:512
    global_load_dwordx4 a[206:209], v52, s[66:67] offset:-4096 sc1
    v_mfma_f32_32x32x16_bf16 v[224:239], a[188:191], a[156:159], v[224:239]
    s_waitcnt lgkmcnt(10)
    ds_read_b64_tr_b16 a[180:181], v3 offset:2048
    ds_read_b64_tr_b16 a[182:183], v3 offset:2560
    s_waitcnt lgkmcnt(7)
    v_mfma_f32_32x32x16_bf16 v[192:207], v[120:123], a[246:249], v[192:207]
    v_mfma_f32_32x32x16_bf16 v[208:223], a[192:195], a[96:99], v[208:223]
    ds_read_b64_tr_b16 a[184:185], v13 offset:16384
    ds_read_b64_tr_b16 a[186:187], v13 offset:16896
    global_load_dwordx4 a[210:213], v52, s[66:67] offset:-3968 sc1
    s_waitcnt lgkmcnt(8)
    v_mfma_f32_32x32x16_bf16 v[224:239], v[124:127], a[246:249], v[224:239]
    v_mfma_f32_32x32x16_bf16 v[240:255], a[196:199], a[96:99], v[240:255]
    ds_read_b64_tr_b16 a[188:189], v13 offset:18432
    ds_read_b64_tr_b16 a[190:191], v13 offset:18944
    v_mfma_f32_32x32x16_bf16 v[208:223], a[160:163], a[100:103], v[208:223]
    ds_read_b64_tr_b16 a[192:193], v15 offset:16384
    ds_read_b64_tr_b16 a[194:195], v15 offset:16896
    global_load_dwordx4 a[214:217], v48, s[64:65] offset:-3584 sc1
    v_mul_f32 v64, v29, v192
    v_mul_f32 v65, v29, v193
    v_mul_f32 v66, v29, v194
    v_mfma_f32_32x32x16_bf16 v[240:255], a[164:167], a[100:103], v[240:255]
    s_waitcnt lgkmcnt(6)
    ds_read_b64_tr_b16 a[196:197], v15 offset:18432
    ds_read_b64_tr_b16 a[198:199], v15 offset:18944
    v_mul_f32 v67, v29, v195
    v_exp_f32 v64, v64
    v_mfma_f32_32x32x16_bf16 v[208:223], a[168:171], a[104:107], v[208:223]
    ds_read_b64_tr_b16 a[160:161], v7 offset:16384
    ds_read_b64_tr_b16 a[162:163], v7 offset:16896
    global_load_dwordx2 a[218:219], v50, s[64:65] offset:-3584 sc1
    v_exp_f32 v65, v65
    v_mfma_f32_32x32x16_bf16 v[240:255], a[172:175], a[104:107], v[240:255]
    ds_read_b64_tr_b16 a[164:165], v7 offset:18432
    ds_read_b64_tr_b16 a[166:167], v7 offset:18944
    v_exp_f32 v66, v66
    v_exp_f32 v67, v67
    v_mfma_f32_32x32x16_bf16 v[208:223], a[176:179], a[108:111], v[208:223]
    ds_read_b64_tr_b16 a[168:169], v3 offset:16384
    ds_read_b64_tr_b16 a[170:171], v3 offset:16896
    global_load_dwordx4 a[220:223], v52, s[66:67] offset:-3840 sc1
    v_fma_f32 v64, v64, v28, v28
    v_fma_f32 v65, v65, v28, v28
    v_fma_f32 v66, v66, v28, v28
    v_mfma_f32_32x32x16_bf16 v[240:255], a[180:183], a[108:111], v[240:255]
    s_waitcnt lgkmcnt(6)
    ds_read_b64_tr_b16 a[172:173], v3 offset:18432
    ds_read_b64_tr_b16 a[174:175], v3 offset:18944
    v_fma_f32 v67, v67, v28, v28
    v_rcp_f32 v64, v64
    s_waitcnt lgkmcnt(15)
    v_mfma_f32_32x32x16_bf16 v[208:223], v[128:131], a[246:249], v[208:223]
    v_rcp_f32 v65, v65
    v_rcp_f32 v66, v66
    v_rcp_f32 v67, v67
    v_mul_f32 v68, v64, v224
    v_mfma_f32_32x32x16_bf16 v[208:223], a[184:187], a[112:115], v[208:223]
    ds_read_b64_tr_b16 a[176:177], v13 offset:32768
    ds_read_b64_tr_b16 a[178:179], v13 offset:33280
    global_load_dwordx4 a[224:227], v52, s[66:67] offset:-3712 sc1
    v_mul_f32 v69, v65, v225
    v_mul_f32 v70, v66, v226
    s_waitcnt lgkmcnt(15)
    v_mfma_f32_32x32x16_bf16 v[240:255], v[132:135], a[246:249], v[240:255]
    v_mul_f32 v71, v67, v227
    v_cvt_pk_bf16_f32 v192, v68, v69
    v_cvt_pk_bf16_f32 v193, v70, v71
    v_mul_f32 v72, v29, v196
    v_mul_f32 v73, v29, v197
    v_mul_f32 v74, v29, v198
    v_mul_f32 v75, v29, v199
    v_mfma_f32_32x32x16_bf16 v[240:255], a[188:191], a[112:115], v[240:255]
    ds_read_b64_tr_b16 a[180:181], v13 offset:34816
    ds_read_b64_tr_b16 a[182:183], v13 offset:35328
    v_exp_f32 v72, v72
    v_exp_f32 v73, v73
    v_mfma_f32_32x32x16_bf16 v[208:223], a[192:195], a[116:119], v[208:223]
    ds_read_b64_tr_b16 a[184:185], v15 offset:32768
    ds_read_b64_tr_b16 a[186:187], v15 offset:33280
    global_load_dwordx4 a[228:231], v48, s[64:65] offset:-3072 sc1
    v_exp_f32 v74, v74
    v_mfma_f32_32x32x16_bf16 v[240:255], a[196:199], a[116:119], v[240:255]
    s_waitcnt lgkmcnt(6)
    ds_read_b64_tr_b16 a[188:189], v15 offset:34816
    ds_read_b64_tr_b16 a[190:191], v15 offset:35328
    v_exp_f32 v75, v75
    v_fma_f32 v72, v72, v28, v28
    v_fma_f32 v73, v73, v28, v28
    v_mfma_f32_32x32x16_bf16 v[208:223], a[160:163], a[120:123], v[208:223]
    ds_read_b64_tr_b16 a[192:193], v7 offset:32768
    ds_read_b64_tr_b16 a[194:195], v7 offset:33280
    global_load_dwordx2 a[232:233], v50, s[64:65] offset:-3072 sc1
    v_fma_f32 v74, v74, v28, v28
    v_fma_f32 v75, v75, v28, v28
    v_mfma_f32_32x32x16_bf16 v[240:255], a[164:167], a[120:123], v[240:255]
    ds_read_b64_tr_b16 a[196:197], v7 offset:34816
    ds_read_b64_tr_b16 a[198:199], v7 offset:35328
    v_rcp_f32 v72, v72
    v_rcp_f32 v73, v73
    v_mfma_f32_32x32x16_bf16 v[208:223], a[168:171], a[124:127], v[208:223]
    ds_read_b64_tr_b16 a[160:161], v3 offset:32768
    ds_read_b64_tr_b16 a[162:163], v3 offset:33280
    global_load_dwordx4 a[234:237], v52, s[66:67] offset:-3584 sc1
    v_rcp_f32 v74, v74
    v_mfma_f32_32x32x16_bf16 v[240:255], a[172:175], a[124:127], v[240:255]
    s_waitcnt lgkmcnt(6)
    ds_read_b64_tr_b16 a[164:165], v3 offset:34816
    ds_read_b64_tr_b16 a[166:167], v3 offset:35328
    v_rcp_f32 v75, v75
    v_mul_f32 v76, v72, v228
    v_mul_f32 v77, v73, v229
    v_mfma_f32_32x32x16_bf16 v[208:223], a[176:179], a[128:131], v[208:223]
    ds_read_b64_tr_b16 a[168:169], v13 offset:49152
    ds_read_b64_tr_b16 a[170:171], v13 offset:49664
    global_load_dwordx4 a[238:241], v52, s[66:67] offset:-3456 sc1
    v_mul_f32 v78, v74, v230
    v_mul_f32 v79, v75, v231
    v_cvt_pk_bf16_f32 v194, v76, v77
    v_mfma_f32_32x32x16_bf16 v[240:255], a[180:183], a[128:131], v[240:255]
    ds_read_b64_tr_b16 a[172:173], v13 offset:51200
    ds_read_b64_tr_b16 a[174:175], v13 offset:51712
    v_cvt_pk_bf16_f32 v195, v78, v79
    v_mul_f32 v80, v29, v200
    v_mul_f32 v81, v29, v201
    v_mul_f32 v82, v29, v202
    v_mfma_f32_32x32x16_bf16 v[208:223], a[184:187], a[132:135], v[208:223]
    ds_read_b64_tr_b16 a[176:177], v15 offset:49152
    ds_read_b64_tr_b16 a[178:179], v15 offset:49664
    v_mul_f32 v83, v29, v203
    v_exp_f32 v80, v80
    v_mfma_f32_32x32x16_bf16 v[240:255], a[188:191], a[132:135], v[240:255]
    s_waitcnt lgkmcnt(6)
    ds_read_b64_tr_b16 a[180:181], v15 offset:51200
    ds_read_b64_tr_b16 a[182:183], v15 offset:51712
    v_exp_f32 v81, v81
    v_exp_f32 v82, v82
    v_mfma_f32_32x32x16_bf16 v[208:223], a[192:195], a[136:139], v[208:223]
    ds_read_b64_tr_b16 a[184:185], v7 offset:49152
    ds_read_b64_tr_b16 a[186:187], v7 offset:49664
    v_exp_f32 v83, v83
    v_fma_f32 v80, v80, v28, v28
    v_fma_f32 v81, v81, v28, v28
    v_mfma_f32_32x32x16_bf16 v[240:255], a[196:199], a[136:139], v[240:255]
    ds_read_b64_tr_b16 a[188:189], v7 offset:51200
    ds_read_b64_tr_b16 a[190:191], v7 offset:51712
    v_fma_f32 v82, v82, v28, v28
    v_fma_f32 v83, v83, v28, v28
    v_rcp_f32 v80, v80
    v_mfma_f32_32x32x16_bf16 v[208:223], a[160:163], a[140:143], v[208:223]
    ds_read_b64_tr_b16 a[192:193], v3 offset:49152
    ds_read_b64_tr_b16 a[194:195], v3 offset:49664
    v_rcp_f32 v81, v81
    v_rcp_f32 v82, v82
    v_mfma_f32_32x32x16_bf16 v[240:255], a[164:167], a[140:143], v[240:255]
    s_waitcnt lgkmcnt(6)
    ds_read_b64_tr_b16 a[196:197], v3 offset:51200
    ds_read_b64_tr_b16 a[198:199], v3 offset:51712
    v_rcp_f32 v83, v83
    v_mul_f32 v84, v80, v232
    v_mul_f32 v85, v81, v233
    v_mfma_f32_32x32x16_bf16 v[208:223], a[168:171], a[144:147], v[208:223]
    v_mul_f32 v86, v82, v234
    v_mul_f32 v87, v83, v235
    v_cvt_pk_bf16_f32 v200, v84, v85
    v_cvt_pk_bf16_f32 v201, v86, v87
    v_mul_f32 v64, v29, v204
    v_mul_f32 v65, v29, v205
    v_mfma_f32_32x32x16_bf16 v[240:255], a[172:175], a[144:147], v[240:255]
    v_mul_f32 v66, v29, v206
    v_mul_f32 v67, v29, v207
    v_exp_f32 v64, v64
    v_exp_f32 v65, v65
    v_mfma_f32_32x32x16_bf16 v[208:223], a[176:179], a[148:151], v[208:223]
    v_exp_f32 v66, v66
    v_exp_f32 v67, v67
    v_fma_f32 v64, v64, v28, v28
    v_fma_f32 v65, v65, v28, v28
    v_mfma_f32_32x32x16_bf16 v[240:255], a[180:183], a[148:151], v[240:255]
    s_waitcnt lgkmcnt(0)
    v_fma_f32 v66, v66, v28, v28
    v_fma_f32 v67, v67, v28, v28
    v_rcp_f32 v64, v64
    v_rcp_f32 v65, v65
    v_mfma_f32_32x32x16_bf16 v[208:223], a[184:187], a[152:155], v[208:223]
    v_rcp_f32 v66, v66
    v_rcp_f32 v67, v67
    v_mul_f32 v68, v64, v236
    v_mul_f32 v69, v65, v237
    v_mfma_f32_32x32x16_bf16 v[240:255], a[188:191], a[152:155], v[240:255]
    v_mul_f32 v70, v66, v238
    v_mul_f32 v71, v67, v239
    v_cvt_pk_bf16_f32 v202, v68, v69
    v_cvt_pk_bf16_f32 v203, v70, v71
    v_mfma_f32_32x32x16_bf16 v[208:223], a[192:195], a[156:159], v[208:223]
    v_mfma_f32_32x32x16_bf16 v[240:255], a[196:199], a[156:159], v[240:255]
    v_mov_b32 v46, 0
    v_mov_b32 v47, 0
    s_nop 1
    v_mul_f32 v72, v29, v208
    v_mul_f32 v73, v29, v209
    v_mul_f32 v74, v29, v210
    v_mul_f32 v75, v29, v211
    v_exp_f32 v72, v72
    v_exp_f32 v73, v73
    v_exp_f32 v74, v74
    v_exp_f32 v75, v75
    v_fma_f32 v72, v72, v28, v28
    v_fma_f32 v73, v73, v28, v28
    v_mfma_f32_32x32x8_bf16 a[0:15], v[46:47], v[46:47], 0
    v_fma_f32 v74, v74, v28, v28
    v_fma_f32 v75, v75, v28, v28
    v_rcp_f32 v72, v72
    v_rcp_f32 v73, v73
    v_rcp_f32 v74, v74
    v_rcp_f32 v75, v75
    v_mul_f32 v76, v72, v240
    v_mul_f32 v77, v73, v241
    v_mfma_f32_32x32x8_bf16 a[16:31], v[46:47], v[46:47], 0
    v_mul_f32 v78, v74, v242
    v_mul_f32 v79, v75, v243
    v_cvt_pk_bf16_f32 v208, v76, v77
    v_cvt_pk_bf16_f32 v209, v78, v79
    v_mul_f32 v80, v29, v212
    v_mul_f32 v81, v29, v213
    v_mul_f32 v82, v29, v214
    v_mul_f32 v83, v29, v215
    v_mfma_f32_32x32x8_bf16 a[32:47], v[46:47], v[46:47], 0
    v_exp_f32 v80, v80
    v_exp_f32 v81, v81
    v_exp_f32 v82, v82
    v_exp_f32 v83, v83
    v_fma_f32 v80, v80, v28, v28
    v_fma_f32 v81, v81, v28, v28
    v_fma_f32 v82, v82, v28, v28
    v_fma_f32 v83, v83, v28, v28
    v_mfma_f32_32x32x8_bf16 a[48:63], v[46:47], v[46:47], 0
    v_rcp_f32 v80, v80
    v_rcp_f32 v81, v81
    v_rcp_f32 v82, v82
    v_rcp_f32 v83, v83
    v_mul_f32 v84, v80, v244
    v_mul_f32 v85, v81, v245
    v_mul_f32 v86, v82, v246
    v_mul_f32 v87, v83, v247
    v_cvt_pk_bf16_f32 v210, v84, v85
    v_cvt_pk_bf16_f32 v211, v86, v87
    v_mul_f32 v64, v29, v216
    v_mul_f32 v65, v29, v217
    v_mul_f32 v66, v29, v218
    v_mul_f32 v67, v29, v219
    v_exp_f32 v64, v64
    v_exp_f32 v65, v65
    v_exp_f32 v66, v66
    v_exp_f32 v67, v67
    v_fma_f32 v64, v64, v28, v28
    v_fma_f32 v65, v65, v28, v28
    v_fma_f32 v66, v66, v28, v28
    v_fma_f32 v67, v67, v28, v28
    v_rcp_f32 v64, v64
    v_rcp_f32 v65, v65
    v_rcp_f32 v66, v66
    v_rcp_f32 v67, v67
    v_mul_f32 v68, v64, v248
    v_mul_f32 v69, v65, v249
    v_mul_f32 v70, v66, v250
    v_mul_f32 v71, v67, v251
    v_cvt_pk_bf16_f32 v216, v68, v69
    v_cvt_pk_bf16_f32 v217, v70, v71
    v_mul_f32 v72, v29, v220
    v_mul_f32 v73, v29, v221
    v_mul_f32 v74, v29, v222
    v_mul_f32 v75, v29, v223
    v_exp_f32 v72, v72
    v_exp_f32 v73, v73
    v_exp_f32 v74, v74
    v_exp_f32 v75, v75
    v_fma_f32 v72, v72, v28, v28
    v_fma_f32 v73, v73, v28, v28
    v_fma_f32 v74, v74, v28, v28
    v_fma_f32 v75, v75, v28, v28
    v_rcp_f32 v72, v72
    v_rcp_f32 v73, v73
    v_rcp_f32 v74, v74
    v_rcp_f32 v75, v75
    v_mul_f32 v76, v72, v252
    v_mul_f32 v77, v73, v253
    v_mul_f32 v78, v74, v254
    v_mul_f32 v79, v75, v255
    v_cvt_pk_bf16_f32 v218, v76, v77
    v_cvt_pk_bf16_f32 v219, v78, v79
L_att1:
    s_waitcnt vmcnt(10)
    v_mfma_f32_32x32x16_bf16 v[0:15], a[200:203], a[64:67], 0
    v_mfma_f32_32x32x8_bf16 v[0:15], a[204:205], a[68:69], v[0:15]
    v_mfma_f32_32x32x16_bf16 v[16:31], a[200:203], a[70:73], 0
    s_nop 3
    v_exp_f32 v0, v0
    v_exp_f32 v1, v1
    v_exp_f32 v2, v2
    v_exp_f32 v3, v3
    v_mfma_f32_32x32x8_bf16 v[16:31], a[204:205], a[74:75], v[16:31]
    v_exp_f32 v4, v4
    v_exp_f32 v5, v5
    v_exp_f32 v6, v6
    v_exp_f32 v7, v7
    global_load_dwordx4 a[242:245], v48, s[64:65] offset:-2560 sc1
    v_mov_b32 v112, -1
    s_waitcnt vmcnt(43)
    ds_read_b64_tr_b16 v[96:97], v157 offset:0
    v_exp_f32 v8, v8
    v_exp_f32 v9, v9
    v_exp_f32 v10, v10
    v_exp_f32 v11, v11
    global_load_dwordx2 a[246:247], v50, s[64:65] offset:-2560 sc1
    s_waitcnt vmcnt(10)
    v_mov_b32 v113, -1
    ds_read_b64_tr_b16 v[98:99], v157 offset:512
    v_exp_f32 v12, v12
    v_exp_f32 v13, v13
    v_exp_f32 v14, v14
    v_exp_f32 v15, v15
    v_mfma_f32_32x32x16_bf16 v[32:47], a[200:203], a[76:79], 0
    v_exp_f32 v16, v16
    v_exp_f32 v17, v17
    v_exp_f32 v18, v18
    v_exp_f32 v19, v19
    v_mfma_f32_32x32x8_bf16 v[32:47], a[204:205], a[80:81], v[32:47]
    v_exp_f32 v20, v20
    v_exp_f32 v21, v21
    v_exp_f32 v22, v22
    v_exp_f32 v23, v23
    v_smfmac_f32_32x32x32_bf16 a[0:15], a[206:209], v[0:7], v63
    global_load_dwordx4 a[248:251], v52, s[66:67] offset:-3328 sc1
    v_mov_b32 v114, -1
    ds_read_b64_tr_b16 v[100:101], v157 offset:32
    v_exp_f32 v24, v24
    v_exp_f32 v25, v25
    v_exp_f32 v26, v26
    v_exp_f32 v27, v27
    v_smfmac_f32_32x32x32_bf16 a[0:15], a[210:213], v[8:15], v63
    global_load_dwordx4 a[252:255], v52, s[66:67] offset:-3200 sc1
    v_mov_b32 v115, -1
    ds_read_b64_tr_b16 v[102:103], v157 offset:544
    v_exp_f32 v28, v28
    v_exp_f32 v29, v29
    v_exp_f32 v30, v30
    v_exp_f32 v31, v31
    v_mfma_f32_32x32x16_bf16 v[0:15], a[200:203], a[82:85], 0
    ds_read_b64_tr_b16 v[104:105], v157 offset:64
    buffer_store_dwordx4 v[160:163], v158, s[24:27], s59 offen offset:0 sc1
    v_exp_f32 v32, v32
    v_exp_f32 v33, v33
    v_exp_f32 v34, v34
    v_exp_f32 v35, v35
    v_mfma_f32_32x32x8_bf16 v[0:15], a[204:205], a[86:87], v[0:15]
    ds_read_b64_tr_b16 v[106:107], v157 offset:576
    v_exp_f32 v36, v36
    v_exp_f32 v37, v37
    v_exp_f32 v38, v38
    v_exp_f32 v39, v39
    v_smfmac_f32_32x32x32_bf16 a[16:31], a[206:209], v[16:23], v63
    ds_read_b64_tr_b16 v[108:109], v157 offset:96
    buffer_store_dwordx4 v[168:171], v158, s[24:27], s59 offen offset:512 sc1
    v_exp_f32 v40, v40
    v_exp_f32 v41, v41
    v_exp_f32 v42, v42
    v_exp_f32 v43, v43
    v_smfmac_f32_32x32x32_bf16 a[16:31], a[210:213], v[24:31], v63
    s_waitcnt vmcnt(10)
    v_exp_f32 v44, v44
    v_exp_f32 v45, v45
    v_exp_f32 v46, v46
    v_exp_f32 v47, v47
    v_mfma_f32_32x32x16_bf16 v[16:31], a[214:217], a[64:67], 0
    ds_read_b64_tr_b16 v[110:111], v157 offset:608
    v_exp_f32 v0, v0
    v_exp_f32 v1, v1
    v_exp_f32 v2, v2
    v_exp_f32 v3, v3
    v_mfma_f32_32x32x8_bf16 v[16:31], a[218:219], a[68:69], v[16:31]
    v_exp_f32 v4, v4
    v_exp_f32 v5, v5
    v_exp_f32 v6, v6
    v_exp_f32 v7, v7
    v_smfmac_f32_32x32x32_bf16 a[32:47], a[206:209], v[32:39], v63
    buffer_store_dwordx4 v[192:195], v158, s[24:27], s60 offen offset:0 sc1
    v_exp_f32 v8, v8
    v_exp_f32 v9, v9
    v_exp_f32 v10, v10
    v_exp_f32 v11, v11
    v_smfmac_f32_32x32x32_bf16 a[32:47], a[210:213], v[40:47], v63
    v_exp_f32 v12, v12
    v_exp_f32 v13, v13
    v_exp_f32 v14, v14
    v_exp_f32 v15, v15
    v_mfma_f32_32x32x16_bf16 v[32:47], a[214:217], a[70:73], 0
    v_exp_f32 v16, v16
    v_exp_f32 v17, v17
    v_exp_f32 v18, v18
    v_exp_f32 v19, v19
    v_mfma_f32_32x32x8_bf16 v[32:47], a[218:219], a[74:75], v[32:47]
    v_exp_f32 v20, v20
    v_exp_f32 v21, v21
    v_exp_f32 v22, v22
    v_exp_f32 v23, v23
    v_smfmac_f32_32x32x32_bf16 a[48:63], a[206:209], v[0:7], v63
    global_load_dwordx4 a[200:203], v48, s[64:65] offset:-2048 sc1
    v_exp_f32 v24, v24
    v_exp_f32 v25, v25
    v_exp_f32 v26, v26
    v_exp_f32 v27, v27
    v_smfmac_f32_32x32x32_bf16 a[48:63], a[210:213], v[8:15], v63
    global_load_dwordx2 a[204:205], v50, s[64:65] offset:-2048 sc1
    v_exp_f32 v28, v28
    v_exp_f32 v29, v29
    v_exp_f32 v30, v30
    v_exp_f32 v31, v31
    v_mfma_f32_32x32x16_bf16 v[0:15], a[214:217], a[76:79], 0
    v_exp_f32 v32, v32
    v_exp_f32 v33, v33
    v_exp_f32 v34, v34
    v_exp_f32 v35, v35
    v_mfma_f32_32x32x8_bf16 v[0:15], a[218:219], a[80:81], v[0:15]
    v_exp_f32 v36, v36
    v_exp_f32 v37, v37
    v_exp_f32 v38, v38
    v_exp_f32 v39, v39
    v_smfmac_f32_32x32x32_bf16 a[0:15], a[220:223], v[16:23], v63
    global_load_dwordx4 a[206:209], v52, s[66:67] offset:-3072 sc1
    v_exp_f32 v40, v40
    v_exp_f32 v41, v41
    v_exp_f32 v42, v42
    v_exp_f32 v43, v43
    v_smfmac_f32_32x32x32_bf16 a[0:15], a[224:227], v[24:31], v63
    global_load_dwordx4 a[210:213], v52, s[66:67] offset:-2944 sc1
    v_exp_f32 v44, v44
    v_exp_f32 v45, v45
    v_exp_f32 v46, v46
    v_exp_f32 v47, v47
    v_mfma_f32_32x32x16_bf16 v[16:31], a[214:217], a[82:85], 0
    buffer_store_dwordx4 v[200:203], v158, s[24:27], s60 offen offset:512 sc1
    v_exp_f32 v0, v0
    v_exp_f32 v1, v1
    v_exp_f32 v2, v2
    v_exp_f32 v3, v3
    v_mfma_f32_32x32x8_bf16 v[16:31], a[218:219], a[86:87], v[16:31]
    v_exp_f32 v4, v4
    v_exp_f32 v5, v5
    v_exp_f32 v6, v6
    v_exp_f32 v7, v7
    v_smfmac_f32_32x32x32_bf16 a[16:31], a[220:223], v[32:39], v63
    buffer_store_dwordx4 v[208:211], v158, s[24:27], s60 offen offset:1024 sc1
    v_exp_f32 v8, v8
    v_exp_f32 v9, v9
    v_exp_f32 v10, v10
    v_exp_f32 v11, v11
    v_smfmac_f32_32x32x32_bf16 a[16:31], a[224:227], v[40:47], v63
    s_waitcnt vmcnt(13)
    v_exp_f32 v12, v12
    v_exp_f32 v13, v13
    v_exp_f32 v14, v14
    v_exp_f32 v15, v15
    v_mfma_f32_32x32x16_bf16 v[32:47], a[228:231], a[64:67], 0
    v_exp_f32 v16, v16
    v_exp_f32 v17, v17
    v_exp_f32 v18, v18
    v_exp_f32 v19, v19
    v_mfma_f32_32x32x8_bf16 v[32:47], a[232:233], a[68:69], v[32:47]
    v_exp_f32 v20, v20
    v_exp_f32 v21, v21
    v_exp_f32 v22, v22
    v_exp_f32 v23, v23
    v_smfmac_f32_32x32x32_bf16 a[32:47], a[220:223], v[0:7], v63
    buffer_store_dwordx4 v[216:219], v158, s[24:27], s60 offen offset:1536 sc1
    v_exp_f32 v24, v24
    v_exp_f32 v25, v25
    v_exp_f32 v26, v26
    v_exp_f32 v27, v27
    v_smfmac_f32_32x32x32_bf16 a[32:47], a[224:227], v[8:15], v63
    v_exp_f32 v28, v28
    v_exp_f32 v29, v29
    v_exp_f32 v30, v30
    v_exp_f32 v31, v31
    v_mfma_f32_32x32x16_bf16 v[0:15], a[228:231], a[70:73], 0
    v_exp_f32 v32, v32
    v_exp_f32 v33, v33
    v_exp_f32 v34, v34
    v_exp_f32 v35, v35
    v_mfma_f32_32x32x8_bf16 v[0:15], a[232:233], a[74:75], v[0:15]
    v_exp_f32 v36, v36
    v_exp_f32 v37, v37
    v_exp_f32 v38, v38
    v_exp_f32 v39, v39
    v_smfmac_f32_32x32x32_bf16 a[48:63], a[220:223], v[16:23], v63
    global_load_dwordx4 a[214:217], v48, s[64:65] offset:-1536 sc1
    v_exp_f32 v40, v40
    v_exp_f32 v41, v41
    v_exp_f32 v42, v42
    v_exp_f32 v43, v43
    v_smfmac_f32_32x32x32_bf16 a[48:63], a[224:227], v[24:31], v63
    global_load_dwordx2 a[218:219], v50, s[64:65] offset:-1536 sc1
    v_exp_f32 v44, v44
    v_exp_f32 v45, v45
    v_exp_f32 v46, v46
    v_exp_f32 v47, v47
    v_mfma_f32_32x32x16_bf16 v[16:31], a[228:231], a[76:79], 0
    v_exp_f32 v0, v0
    v_exp_f32 v1, v1
    v_exp_f32 v2, v2
    v_exp_f32 v3, v3
    v_mfma_f32_32x32x8_bf16 v[16:31], a[232:233], a[80:81], v[16:31]
    v_exp_f32 v4, v4
    v_exp_f32 v5, v5
    v_exp_f32 v6, v6
    v_exp_f32 v7, v7
    v_smfmac_f32_32x32x32_bf16 a[0:15], a[234:237], v[32:39], v63
    global_load_dwordx4 a[220:223], v52, s[66:67] offset:-2816 sc1
    v_exp_f32 v8, v8
    v_exp_f32 v9, v9
    v_exp_f32 v10, v10
    v_exp_f32 v11, v11
    v_smfmac_f32_32x32x32_bf16 a[0:15], a[238:241], v[40:47], v63
    global_load_dwordx4 a[224:227], v52, s[66:67] offset:-2688 sc1
    v_exp_f32 v12, v12
    v_exp_f32 v13, v13
    v_exp_f32 v14, v14
    v_exp_f32 v15, v15
    v_mfma_f32_32x32x16_bf16 v[32:47], a[228:231], a[82:85], 0
    buffer_store_dwordx4 v[112:115], v58, s[24:27], s77 offen sc1
    v_exp_f32 v16, v16
    v_exp_f32 v17, v17
    v_exp_f32 v18, v18
    v_exp_f32 v19, v19
    v_mfma_f32_32x32x8_bf16 v[32:47], a[232:233], a[86:87], v[32:47]
    v_exp_f32 v20, v20
    v_exp_f32 v21, v21
    v_exp_f32 v22, v22
    v_exp_f32 v23, v23
    v_smfmac_f32_32x32x32_bf16 a[16:31], a[234:237], v[0:7], v63
    buffer_store_dwordx4 v[112:115], v58, s[24:27], s77 offen offset:512 sc1
    v_exp_f32 v24, v24
    v_exp_f32 v25, v25
    v_exp_f32 v26, v26
    v_exp_f32 v27, v27
    v_smfmac_f32_32x32x32_bf16 a[16:31], a[238:241], v[8:15], v63
    s_waitcnt vmcnt(16)
    v_exp_f32 v28, v28
    v_exp_f32 v29, v29
    v_exp_f32 v30, v30
    v_exp_f32 v31, v31
    v_mfma_f32_32x32x16_bf16 v[0:15], a[242:245], a[64:67], 0
    v_exp_f32 v32, v32
    v_exp_f32 v33, v33
    v_exp_f32 v34, v34
    v_exp_f32 v35, v35
    v_mfma_f32_32x32x8_bf16 v[0:15], a[246:247], a[68:69], v[0:15]
    v_exp_f32 v36, v36
    v_exp_f32 v37, v37
    v_exp_f32 v38, v38
    v_exp_f32 v39, v39
    v_smfmac_f32_32x32x32_bf16 a[32:47], a[234:237], v[16:23], v63
    buffer_store_dwordx2 v[112:113], v53, s[24:27], s83 offen sc1
    v_exp_f32 v40, v40
    v_exp_f32 v41, v41
    v_exp_f32 v42, v42
    v_exp_f32 v43, v43
    v_smfmac_f32_32x32x32_bf16 a[32:47], a[238:241], v[24:31], v63
    v_exp_f32 v44, v44
    v_exp_f32 v45, v45
    v_exp_f32 v46, v46
    v_exp_f32 v47, v47
    v_mfma_f32_32x32x16_bf16 v[16:31], a[242:245], a[70:73], 0
    v_exp_f32 v0, v0
    v_exp_f32 v1, v1
    v_exp_f32 v2, v2
    v_exp_f32 v3, v3
    v_mfma_f32_32x32x8_bf16 v[16:31], a[246:247], a[74:75], v[16:31]
    v_exp_f32 v4, v4
    v_exp_f32 v5, v5
    v_exp_f32 v6, v6
    v_exp_f32 v7, v7
    v_smfmac_f32_32x32x32_bf16 a[48:63], a[234:237], v[32:39], v63
    global_load_dwordx4 a[228:231], v48, s[64:65] offset:-1024 sc1
    v_exp_f32 v8, v8
    v_exp_f32 v9, v9
    v_exp_f32 v10, v10
    v_exp_f32 v11, v11
    v_smfmac_f32_32x32x32_bf16 a[48:63], a[238:241], v[40:47], v63
    global_load_dwordx2 a[232:233], v50, s[64:65] offset:-1024 sc1
    v_exp_f32 v12, v12
    v_exp_f32 v13, v13
    v_exp_f32 v14, v14
    v_exp_f32 v15, v15
    v_mfma_f32_32x32x16_bf16 v[32:47], a[242:245], a[76:79], 0
    v_exp_f32 v16, v16
    v_exp_f32 v17, v17
    v_exp_f32 v18, v18
    v_exp_f32 v19, v19
    v_mfma_f32_32x32x8_bf16 v[32:47], a[246:247], a[80:81], v[32:47]
    v_exp_f32 v20, v20
    v_exp_f32 v21, v21
    v_exp_f32 v22, v22
    v_exp_f32 v23, v23
    v_smfmac_f32_32x32x32_bf16 a[0:15], a[248:251], v[0:7], v63
    global_load_dwordx4 a[234:237], v52, s[66:67] offset:-2560 sc1
    v_exp_f32 v24, v24
    v_exp_f32 v25, v25
    v_exp_f32 v26, v26
    v_exp_f32 v27, v27
    v_smfmac_f32_32x32x32_bf16 a[0:15], a[252:255], v[8:15], v63
    global_load_dwordx4 a[238:241], v52, s[66:67] offset:-2432 sc1
    v_exp_f32 v28, v28
    v_exp_f32 v29, v29
    v_exp_f32 v30, v30
    v_exp_f32 v31, v31
    v_mfma_f32_32x32x16_bf16 v[0:15], a[242:245], a[82:85], 0
    s_waitcnt lgkmcnt(0)
    buffer_store_dwordx4 v[96:99], v156, s[24:27], s72 offen sc1
    v_exp_f32 v32, v32
    v_exp_f32 v33, v33
    v_exp_f32 v34, v34
    v_exp_f32 v35, v35
    v_mfma_f32_32x32x8_bf16 v[0:15], a[246:247], a[86:87], v[0:15]
    v_exp_f32 v36, v36
    v_exp_f32 v37, v37
    v_exp_f32 v38, v38
    v_exp_f32 v39, v39
    v_smfmac_f32_32x32x32_bf16 a[16:31], a[248:251], v[16:23], v63
    buffer_store_dwordx4 v[100:103], v156, s[24:27], s73 offen sc1
    v_exp_f32 v40, v40
    v_exp_f32 v41, v41
    v_exp_f32 v42, v42
    v_exp_f32 v43, v43
    v_smfmac_f32_32x32x32_bf16 a[16:31], a[252:255], v[24:31], v63
    s_waitcnt vmcnt(16)
    v_exp_f32 v44, v44
    v_exp_f32 v45, v45
    v_exp_f32 v46, v46
    v_exp_f32 v47, v47
    v_mfma_f32_32x32x16_bf16 v[16:31], a[200:203], a[64:67], 0
    v_exp_f32 v0, v0
    v_exp_f32 v1, v1
    v_exp_f32 v2, v2
    v_exp_f32 v3, v3
    v_mfma_f32_32x32x8_bf16 v[16:31], a[204:205], a[68:69], v[16:31]
    v_exp_f32 v4, v4
    v_exp_f32 v5, v5
    v_exp_f32 v6, v6
    v_exp_f32 v7, v7
    v_smfmac_f32_32x32x32_bf16 a[32:47], a[248:251], v[32:39], v63
    buffer_store_dwordx4 v[104:107], v156, s[24:27], s79 offen sc1
    v_exp_f32 v8, v8
    v_exp_f32 v9, v9
    v_exp_f32 v10, v10
    v_exp_f32 v11, v11
    v_smfmac_f32_32x32x32_bf16 a[32:47], a[252:255], v[40:47], v63
    v_exp_f32 v12, v12
    v_exp_f32 v13, v13
    v_exp_f32 v14, v14
    v_exp_f32 v15, v15
    v_mfma_f32_32x32x16_bf16 v[32:47], a[200:203], a[70:73], 0
    v_exp_f32 v16, v16
    v_exp_f32 v17, v17
    v_exp_f32 v18, v18
    v_exp_f32 v19, v19
    v_mfma_f32_32x32x8_bf16 v[32:47], a[204:205], a[74:75], v[32:47]
    v_exp_f32 v20, v20
    v_exp_f32 v21, v21
    v_exp_f32 v22, v22
    v_exp_f32 v23, v23
    v_smfmac_f32_32x32x32_bf16 a[48:63], a[248:251], v[0:7], v63
    global_load_dwordx4 a[242:245], v48, s[64:65] offset:-512 sc1
    v_exp_f32 v24, v24
    v_exp_f32 v25, v25
    v_exp_f32 v26, v26
    v_exp_f32 v27, v27
    v_smfmac_f32_32x32x32_bf16 a[48:63], a[252:255], v[8:15], v63
    global_load_dwordx2 a[246:247], v50, s[64:65] offset:-512 sc1
    v_exp_f32 v28, v28
    v_exp_f32 v29, v29
    v_exp_f32 v30, v30
    v_exp_f32 v31, v31
    v_mfma_f32_32x32x16_bf16 v[0:15], a[200:203], a[76:79], 0
    v_exp_f32 v32, v32
    v_exp_f32 v33, v33
    v_exp_f32 v34, v34
    v_exp_f32 v35, v35
    v_mfma_f32_32x32x8_bf16 v[0:15], a[204:205], a[80:81], v[0:15]
    v_exp_f32 v36, v36
    v_exp_f32 v37, v37
    v_exp_f32 v38, v38
    v_exp_f32 v39, v39
    v_smfmac_f32_32x32x32_bf16 a[0:15], a[206:209], v[16:23], v63
    global_load_dwordx4 a[248:251], v52, s[66:67] offset:-2304 sc1
    v_exp_f32 v40, v40
    v_exp_f32 v41, v41
    v_exp_f32 v42, v42
    v_exp_f32 v43, v43
    v_smfmac_f32_32x32x32_bf16 a[0:15], a[210:213], v[24:31], v63
    global_load_dwordx4 a[252:255], v52, s[66:67] offset:-2176 sc1
    v_exp_f32 v44, v44
    v_exp_f32 v45, v45
    v_exp_f32 v46, v46
    v_exp_f32 v47, v47
    v_mfma_f32_32x32x16_bf16 v[16:31], a[200:203], a[82:85], 0
    buffer_store_dwordx4 v[108:111], v156, s[24:27], s55 offen sc1
    v_exp_f32 v0, v0
    v_exp_f32 v1, v1
    v_exp_f32 v2, v2
    v_exp_f32 v3, v3
    v_mfma_f32_32x32x8_bf16 v[16:31], a[204:205], a[86:87], v[16:31]
    v_exp_f32 v4, v4
    v_exp_f32 v5, v5
    v_exp_f32 v6, v6
    v_exp_f32 v7, v7
    v_smfmac_f32_32x32x32_bf16 a[16:31], a[206:209], v[32:39], v63
    v_exp_f32 v8, v8
    v_exp_f32 v9, v9
    v_exp_f32 v10, v10
    v_exp_f32 v11, v11
    v_smfmac_f32_32x32x32_bf16 a[16:31], a[210:213], v[40:47], v63
    s_waitcnt vmcnt(15)
    v_exp_f32 v12, v12
    v_exp_f32 v13, v13
    v_exp_f32 v14, v14
    v_exp_f32 v15, v15
    v_mfma_f32_32x32x16_bf16 v[32:47], a[214:217], a[64:67], 0
    v_exp_f32 v16, v16
    v_exp_f32 v17, v17
    v_exp_f32 v18, v18
    v_exp_f32 v19, v19
    v_mfma_f32_32x32x8_bf16 v[32:47], a[218:219], a[68:69], v[32:47]
    v_exp_f32 v20, v20
    v_exp_f32 v21, v21
    v_exp_f32 v22, v22
    v_exp_f32 v23, v23
    v_smfmac_f32_32x32x32_bf16 a[32:47], a[206:209], v[0:7], v63
    v_exp_f32 v24, v24
    v_exp_f32 v25, v25
    v_exp_f32 v26, v26
    v_exp_f32 v27, v27
    v_smfmac_f32_32x32x32_bf16 a[32:47], a[210:213], v[8:15], v63
    v_exp_f32 v28, v28
    v_exp_f32 v29, v29
    v_exp_f32 v30, v30
    v_exp_f32 v31, v31
    v_mfma_f32_32x32x16_bf16 v[0:15], a[214:217], a[70:73], 0
    v_exp_f32 v32, v32
    v_exp_f32 v33, v33
    v_exp_f32 v34, v34
    v_exp_f32 v35, v35
    v_mfma_f32_32x32x8_bf16 v[0:15], a[218:219], a[74:75], v[0:15]
    v_exp_f32 v36, v36
    v_exp_f32 v37, v37
    v_exp_f32 v38, v38
    v_exp_f32 v39, v39
    v_smfmac_f32_32x32x32_bf16 a[48:63], a[206:209], v[16:23], v63
    global_load_dwordx4 a[200:203], v48, s[64:65] offset:0 sc1
    v_exp_f32 v40, v40
    v_exp_f32 v41, v41
    v_exp_f32 v42, v42
    v_exp_f32 v43, v43
    v_smfmac_f32_32x32x32_bf16 a[48:63], a[210:213], v[24:31], v63
    global_load_dwordx2 a[204:205], v50, s[64:65] offset:0 sc1
    v_exp_f32 v44, v44
    v_exp_f32 v45, v45
    v_exp_f32 v46, v46
    v_exp_f32 v47, v47
    v_mfma_f32_32x32x16_bf16 v[16:31], a[214:217], a[76:79], 0
    v_exp_f32 v0, v0
    v_exp_f32 v1, v1
    v_exp_f32 v2, v2
    v_exp_f32 v3, v3
    v_mfma_f32_32x32x8_bf16 v[16:31], a[218:219], a[80:81], v[16:31]
    v_exp_f32 v4, v4
    v_exp_f32 v5, v5
    v_exp_f32 v6, v6
    v_exp_f32 v7, v7
    v_smfmac_f32_32x32x32_bf16 a[0:15], a[220:223], v[32:39], v63
    global_load_dwordx4 a[206:209], v52, s[66:67] offset:-2048 sc1
    v_exp_f32 v8, v8
    v_exp_f32 v9, v9
    v_exp_f32 v10, v10
    v_exp_f32 v11, v11
    v_smfmac_f32_32x32x32_bf16 a[0:15], a[224:227], v[40:47], v63
    global_load_dwordx4 a[210:213], v52, s[66:67] offset:-1920 sc1
    v_exp_f32 v12, v12
    v_exp_f32 v13, v13
    v_exp_f32 v14, v14
    v_exp_f32 v15, v15
    v_mfma_f32_32x32x16_bf16 v[32:47], a[214:217], a[82:85], 0
    v_exp_f32 v16, v16
    v_exp_f32 v17, v17
    v_exp_f32 v18, v18
    v_exp_f32 v19, v19
    v_mfma_f32_32x32x8_bf16 v[32:47], a[218:219], a[86:87], v[32:47]
    v_exp_f32 v20, v20
    v_exp_f32 v21, v21
    v_exp_f32 v22, v22
    v_exp_f32 v23, v23
    v_smfmac_f32_32x32x32_bf16 a[16:31], a[220:223], v[0:7], v63
    v_exp_f32 v24, v24
    v_exp_f32 v25, v25
    v_exp_f32 v26, v26
    v_exp_f32 v27, v27
    v_smfmac_f32_32x32x32_bf16 a[16:31], a[224:227], v[8:15], v63
    s_waitcnt vmcnt(12)
    v_exp_f32 v28, v28
    v_exp_f32 v29, v29
    v_exp_f32 v30, v30
    v_exp_f32 v31, v31
    v_mfma_f32_32x32x16_bf16 v[0:15], a[228:231], a[64:67], 0
    v_exp_f32 v32, v32
    v_exp_f32 v33, v33
    v_exp_f32 v34, v34
    v_exp_f32 v35, v35
    v_mfma_f32_32x32x8_bf16 v[0:15], a[232:233], a[68:69], v[0:15]
    v_exp_f32 v36, v36
    v_exp_f32 v37, v37
    v_exp_f32 v38, v38
    v_exp_f32 v39, v39
    v_smfmac_f32_32x32x32_bf16 a[32:47], a[220:223], v[16:23], v63
    v_exp_f32 v40, v40
    v_exp_f32 v41, v41
    v_exp_f32 v42, v42
    v_exp_f32 v43, v43
    v_smfmac_f32_32x32x32_bf16 a[32:47], a[224:227], v[24:31], v63
    v_exp_f32 v44, v44
    v_exp_f32 v45, v45
    v_exp_f32 v46, v46
    v_exp_f32 v47, v47
    v_mfma_f32_32x32x16_bf16 v[16:31], a[228:231], a[70:73], 0
    v_exp_f32 v0, v0
    v_exp_f32 v1, v1
    v_exp_f32 v2, v2
    v_exp_f32 v3, v3
    v_mfma_f32_32x32x8_bf16 v[16:31], a[232:233], a[74:75], v[16:31]
    v_exp_f32 v4, v4
    v_exp_f32 v5, v5
    v_exp_f32 v6, v6
    v_exp_f32 v7, v7
    v_smfmac_f32_32x32x32_bf16 a[48:63], a[220:223], v[32:39], v63
    global_load_dwordx4 a[214:217], v48, s[64:65] offset:512 sc1
    v_exp_f32 v8, v8
    v_exp_f32 v9, v9
    v_exp_f32 v10, v10
    v_exp_f32 v11, v11
    v_smfmac_f32_32x32x32_bf16 a[48:63], a[224:227], v[40:47], v63
    global_load_dwordx2 a[218:219], v50, s[64:65] offset:512 sc1
    v_exp_f32 v12, v12
    v_exp_f32 v13, v13
    v_exp_f32 v14, v14
    v_exp_f32 v15, v15
    v_mfma_f32_32x32x16_bf16 v[32:47], a[228:231], a[76:79], 0
    v_exp_f32 v16, v16
    v_exp_f32 v17, v17
    v_exp_f32 v18, v18
    v_exp_f32 v19, v19
    v_mfma_f32_32x32x8_bf16 v[32:47], a[232:233], a[80:81], v[32:47]
    v_exp_f32 v20, v20
    v_exp_f32 v21, v21
    v_exp_f32 v22, v22
    v_exp_f32 v23, v23
    v_smfmac_f32_32x32x32_bf16 a[0:15], a[234:237], v[0:7], v63
    global_load_dwordx4 a[220:223], v52, s[66:67] offset:-1792 sc1
    v_exp_f32 v24, v24
    v_exp_f32 v25, v25
    v_exp_f32 v26, v26
    v_exp_f32 v27, v27
    v_smfmac_f32_32x32x32_bf16 a[0:15], a[238:241], v[8:15], v63
    global_load_dwordx4 a[224:227], v52, s[66:67] offset:-1664 sc1
    v_exp_f32 v28, v28
    v_exp_f32 v29, v29
    v_exp_f32 v30, v30
    v_exp_f32 v31, v31
    v_mfma_f32_32x32x16_bf16 v[0:15], a[228:231], a[82:85], 0
    s_waitcnt vmcnt(8)
    s_barrier
    s_cmp_lg_u32 s3, 0
    s_cbranch_scc1 L_flH
    s_mov_b64 exec, 1
    v_mov_b32 v64, s84
    v_mov_b32 v65, 0
    buffer_store_dword v64, v65, s[24:27], s78 offen sc1
    s_mov_b64 exec, -1
L_flH:
    v_exp_f32 v32, v32
    v_exp_f32 v33, v33
    v_exp_f32 v34, v34
    v_exp_f32 v35, v35
    v_mfma_f32_32x32x8_bf16 v[0:15], a[232:233], a[86:87], v[0:15]
    v_exp_f32 v36, v36
    v_exp_f32 v37, v37
    v_exp_f32 v38, v38
    v_exp_f32 v39, v39
    v_smfmac_f32_32x32x32_bf16 a[16:31], a[234:237], v[16:23], v63
    v_exp_f32 v40, v40
    v_exp_f32 v41, v41
    v_exp_f32 v42, v42
    v_exp_f32 v43, v43
    v_smfmac_f32_32x32x32_bf16 a[16:31], a[238:241], v[24:31], v63
    s_waitcnt vmcnt(9)
    v_exp_f32 v44, v44
    v_exp_f32 v45, v45
    v_exp_f32 v46, v46
    v_exp_f32 v47, v47
    v_mfma_f32_32x32x16_bf16 v[16:31], a[242:245], a[64:67], 0
    v_exp_f32 v0, v0
    v_exp_f32 v1, v1
    v_exp_f32 v2, v2
    v_exp_f32 v3, v3
    v_mfma_f32_32x32x8_bf16 v[16:31], a[246:247], a[68:69], v[16:31]
    v_exp_f32 v4, v4
    v_exp_f32 v5, v5
    v_exp_f32 v6, v6
    v_exp_f32 v7, v7
    v_smfmac_f32_32x32x32_bf16 a[32:47], a[234:237], v[32:39], v63
    v_exp_f32 v8, v8
    v_exp_f32 v9, v9
    v_exp_f32 v10, v10
    v_exp_f32 v11, v11
    v_smfmac_f32_32x32x32_bf16 a[32:47], a[238:241], v[40:47], v63
    v_exp_f32 v12, v12
    v_exp_f32 v13, v13
    v_exp_f32 v14, v14
    v_exp_f32 v15, v15
    v_mfma_f32_32x32x16_bf16 v[32:47], a[242:245], a[70:73], 0
    v_exp_f32 v16, v16
    v_exp_f32 v17, v17
    v_exp_f32 v18, v18
    v_exp_f32 v19, v19
    v_mfma_f32_32x32x8_bf16 v[32:47], a[246:247], a[74:75], v[32:47]
    v_exp_f32 v20, v20
    v_exp_f32 v21, v21
    v_exp_f32 v22, v22
    v_exp_f32 v23, v23
    v_smfmac_f32_32x32x32_bf16 a[48:63], a[234:237], v[0:7], v63
    global_load_dwordx4 a[228:231], v48, s[64:65] offset:1024 sc1
    v_exp_f32 v24, v24
    v_exp_f32 v25, v25
    v_exp_f32 v26, v26
    v_exp_f32 v27, v27
    v_smfmac_f32_32x32x32_bf16 a[48:63], a[238:241], v[8:15], v63
    global_load_dwordx2 a[232:233], v50, s[64:65] offset:1024 sc1
    v_exp_f32 v28, v28
    v_exp_f32 v29, v29
    v_exp_f32 v30, v30
    v_exp_f32 v31, v31
    v_mfma_f32_32x32x16_bf16 v[0:15], a[242:245], a[76:79], 0
    v_exp_f32 v32, v32
    v_exp_f32 v33, v33
    v_exp_f32 v34, v34
    v_exp_f32 v35, v35
    v_mfma_f32_32x32x8_bf16 v[0:15], a[246:247], a[80:81], v[0:15]
    v_exp_f32 v36, v36
    v_exp_f32 v37, v37
    v_exp_f32 v38, v38
    v_exp_f32 v39, v39
    v_smfmac_f32_32x32x32_bf16 a[0:15], a[248:251], v[16:23], v63
    global_load_dwordx4 a[234:237], v52, s[66:67] offset:-1536 sc1
    v_exp_f32 v40, v40
    v_exp_f32 v41, v41
    v_exp_f32 v42, v42
    v_exp_f32 v43, v43
    v_smfmac_f32_32x32x32_bf16 a[0:15], a[252:255], v[24:31], v63
    global_load_dwordx4 a[238:241], v52, s[66:67] offset:-1408 sc1
    v_exp_f32 v44, v44
    v_exp_f32 v45, v45
    v_exp_f32 v46, v46
    v_exp_f32 v47, v47
    v_mfma_f32_32x32x16_bf16 v[16:31], a[242:245], a[82:85], 0
    v_exp_f32 v0, v0
    v_exp_f32 v1, v1
    v_exp_f32 v2, v2
    v_exp_f32 v3, v3
    v_mfma_f32_32x32x8_bf16 v[16:31], a[246:247], a[86:87], v[16:31]
    v_exp_f32 v4, v4
    v_exp_f32 v5, v5
    v_exp_f32 v6, v6
    v_exp_f32 v7, v7
    v_smfmac_f32_32x32x32_bf16 a[16:31], a[248:251], v[32:39], v63
    v_exp_f32 v8, v8
    v_exp_f32 v9, v9
    v_exp_f32 v10, v10
    v_exp_f32 v11, v11
    v_smfmac_f32_32x32x32_bf16 a[16:31], a[252:255], v[40:47], v63
    s_waitcnt vmcnt(8)
    v_exp_f32 v12, v12
    v_exp_f32 v13, v13
    v_exp_f32 v14, v14
    v_exp_f32 v15, v15
    v_mfma_f32_32x32x16_bf16 v[32:47], a[200:203], a[64:67], 0
    v_exp_f32 v16, v16
    v_exp_f32 v17, v17
    v_exp_f32 v18, v18
    v_exp_f32 v19, v19
    v_mfma_f32_32x32x8_bf16 v[32:47], a[204:205], a[68:69], v[32:47]
    v_exp_f32 v20, v20
    v_exp_f32 v21, v21
    v_exp_f32 v22, v22
    v_exp_f32 v23, v23
    v_smfmac_f32_32x32x32_bf16 a[32:47], a[248:251], v[0:7], v63
    v_exp_f32 v24, v24
    v_exp_f32 v25, v25
    v_exp_f32 v26, v26
    v_exp_f32 v27, v27
    v_smfmac_f32_32x32x32_bf16 a[32:47], a[252:255], v[8:15], v63
    v_exp_f32 v28, v28
    v_exp_f32 v29, v29
    v_exp_f32 v30, v30
    v_exp_f32 v31, v31
    v_mfma_f32_32x32x16_bf16 v[0:15], a[200:203], a[70:73], 0
    v_exp_f32 v32, v32
    v_exp_f32 v33, v33
    v_exp_f32 v34, v34
    v_exp_f32 v35, v35
    v_mfma_f32_32x32x8_bf16 v[0:15], a[204:205], a[74:75], v[0:15]
    v_exp_f32 v36, v36
    v_exp_f32 v37, v37
    v_exp_f32 v38, v38
    v_exp_f32 v39, v39
    v_smfmac_f32_32x32x32_bf16 a[48:63], a[248:251], v[16:23], v63
    global_load_dwordx4 a[242:245], v48, s[64:65] offset:1536 sc1
    v_exp_f32 v40, v40
    v_exp_f32 v41, v41
    v_exp_f32 v42, v42
    v_exp_f32 v43, v43
    v_smfmac_f32_32x32x32_bf16 a[48:63], a[252:255], v[24:31], v63
    global_load_dwordx2 a[246:247], v50, s[64:65] offset:1536 sc1
    v_exp_f32 v44, v44
    v_exp_f32 v45, v45
    v_exp_f32 v46, v46
    v_exp_f32 v47, v47
    v_mfma_f32_32x32x16_bf16 v[16:31], a[200:203], a[76:79], 0
    v_exp_f32 v0, v0
    v_exp_f32 v1, v1
    v_exp_f32 v2, v2
    v_exp_f32 v3, v3
    v_mfma_f32_32x32x8_bf16 v[16:31], a[204:205], a[80:81], v[16:31]
    v_exp_f32 v4, v4
    v_exp_f32 v5, v5
    v_exp_f32 v6, v6
    v_exp_f32 v7, v7
    v_smfmac_f32_32x32x32_bf16 a[0:15], a[206:209], v[32:39], v63
    global_load_dwordx4 a[248:251], v52, s[66:67] offset:-1280 sc1
    v_exp_f32 v8, v8
    v_exp_f32 v9, v9
    v_exp_f32 v10, v10
    v_exp_f32 v11, v11
    v_smfmac_f32_32x32x32_bf16 a[0:15], a[210:213], v[40:47], v63
    global_load_dwordx4 a[252:255], v52, s[66:67] offset:-1152 sc1
    v_exp_f32 v12, v12
    v_exp_f32 v13, v13
    v_exp_f32 v14, v14
    v_exp_f32 v15, v15
    v_mfma_f32_32x32x16_bf16 v[32:47], a[200:203], a[82:85], 0
    v_exp_f32 v16, v16
    v_exp_f32 v17, v17
    v_exp_f32 v18, v18
    v_exp_f32 v19, v19
    v_mfma_f32_32x32x8_bf16 v[32:47], a[204:205], a[86:87], v[32:47]
    v_exp_f32 v20, v20
    v_exp_f32 v21, v21
    v_exp_f32 v22, v22
    v_exp_f32 v23, v23
    v_smfmac_f32_32x32x32_bf16 a[16:31], a[206:209], v[0:7], v63
    v_exp_f32 v24, v24
    v_exp_f32 v25, v25
    v_exp_f32 v26, v26
    v_exp_f32 v27, v27
    v_smfmac_f32_32x32x32_bf16 a[16:31], a[210:213], v[8:15], v63
    s_waitcnt vmcnt(8)
    v_exp_f32 v28, v28
    v_exp_f32 v29, v29
    v_exp_f32 v30, v30
    v_exp_f32 v31, v31
    v_mfma_f32_32x32x16_bf16 v[0:15], a[214:217], a[64:67], 0
    v_exp_f32 v32, v32
    v_exp_f32 v33, v33
    v_exp_f32 v34, v34
    v_exp_f32 v35, v35
    v_mfma_f32_32x32x8_bf16 v[0:15], a[218:219], a[68:69], v[0:15]
    v_exp_f32 v36, v36
    v_exp_f32 v37, v37
    v_exp_f32 v38, v38
    v_exp_f32 v39, v39
    v_smfmac_f32_32x32x32_bf16 a[32:47], a[206:209], v[16:23], v63
    v_exp_f32 v40, v40
    v_exp_f32 v41, v41
    v_exp_f32 v42, v42
    v_exp_f32 v43, v43
    v_smfmac_f32_32x32x32_bf16 a[32:47], a[210:213], v[24:31], v63
    v_exp_f32 v44, v44
    v_exp_f32 v45, v45
    v_exp_f32 v46, v46
    v_exp_f32 v47, v47
    v_mfma_f32_32x32x16_bf16 v[16:31], a[214:217], a[70:73], 0
    v_exp_f32 v0, v0
    v_exp_f32 v1, v1
    v_exp_f32 v2, v2
    v_exp_f32 v3, v3
    v_mfma_f32_32x32x8_bf16 v[16:31], a[218:219], a[74:75], v[16:31]
    v_exp_f32 v4, v4
    v_exp_f32 v5, v5
    v_exp_f32 v6, v6
    v_exp_f32 v7, v7
    v_smfmac_f32_32x32x32_bf16 a[48:63], a[206:209], v[32:39], v63
    global_load_dwordx4 a[200:203], v48, s[64:65] offset:2048 sc1
    v_exp_f32 v8, v8
    v_exp_f32 v9, v9
    v_exp_f32 v10, v10
    v_exp_f32 v11, v11
    v_smfmac_f32_32x32x32_bf16 a[48:63], a[210:213], v[40:47], v63
    global_load_dwordx2 a[204:205], v50, s[64:65] offset:2048 sc1
    v_exp_f32 v12, v12
    v_exp_f32 v13, v13
    v_exp_f32 v14, v14
    v_exp_f32 v15, v15
    v_mfma_f32_32x32x16_bf16 v[32:47], a[214:217], a[76:79], 0
    v_exp_f32 v16, v16
    v_exp_f32 v17, v17
    v_exp_f32 v18, v18
    v_exp_f32 v19, v19
    v_mfma_f32_32x32x8_bf16 v[32:47], a[218:219], a[80:81], v[32:47]
    v_exp_f32 v20, v20
    v_exp_f32 v21, v21
    v_exp_f32 v22, v22
    v_exp_f32 v23, v23
    v_smfmac_f32_32x32x32_bf16 a[0:15], a[220:223], v[0:7], v63
    global_load_dwordx4 a[206:209], v52, s[66:67] offset:-1024 sc1
    v_exp_f32 v24, v24
    v_exp_f32 v25, v25
    v_exp_f32 v26, v26
    v_exp_f32 v27, v27
    v_smfmac_f32_32x32x32_bf16 a[0:15], a[224:227], v[8:15], v63
    global_load_dwordx4 a[210:213], v52, s[66:67] offset:-896 sc1
    v_exp_f32 v28, v28
    v_exp_f32 v29, v29
    v_exp_f32 v30, v30
    v_exp_f32 v31, v31
    v_mfma_f32_32x32x16_bf16 v[0:15], a[214:217], a[82:85], 0
    v_exp_f32 v32, v32
    v_exp_f32 v33, v33
    v_exp_f32 v34, v34
    v_exp_f32 v35, v35
    v_mfma_f32_32x32x8_bf16 v[0:15], a[218:219], a[86:87], v[0:15]
    v_exp_f32 v36, v36
    v_exp_f32 v37, v37
    v_exp_f32 v38, v38
    v_exp_f32 v39, v39
    v_smfmac_f32_32x32x32_bf16 a[16:31], a[220:223], v[16:23], v63
    v_exp_f32 v40, v40
    v_exp_f32 v41, v41
    v_exp_f32 v42, v42
    v_exp_f32 v43, v43
    v_smfmac_f32_32x32x32_bf16 a[16:31], a[224:227], v[24:31], v63
    s_waitcnt vmcnt(8)
    v_exp_f32 v44, v44
    v_exp_f32 v45, v45
    v_exp_f32 v46, v46
    v_exp_f32 v47, v47
    v_mfma_f32_32x32x16_bf16 v[16:31], a[228:231], a[64:67], 0
    v_exp_f32 v0, v0
    v_exp_f32 v1, v1
    v_exp_f32 v2, v2
    v_exp_f32 v3, v3
    v_mfma_f32_32x32x8_bf16 v[16:31], a[232:233], a[68:69], v[16:31]
    v_exp_f32 v4, v4
    v_exp_f32 v5, v5
    v_exp_f32 v6, v6
    v_exp_f32 v7, v7
    v_smfmac_f32_32x32x32_bf16 a[32:47], a[220:223], v[32:39], v63
    v_exp_f32 v8, v8
    v_exp_f32 v9, v9
    v_exp_f32 v10, v10
    v_exp_f32 v11, v11
    v_smfmac_f32_32x32x32_bf16 a[32:47], a[224:227], v[40:47], v63
    v_exp_f32 v12, v12
    v_exp_f32 v13, v13
    v_exp_f32 v14, v14
    v_exp_f32 v15, v15
    v_mfma_f32_32x32x16_bf16 v[32:47], a[228:231], a[70:73], 0
    v_exp_f32 v16, v16
    v_exp_f32 v17, v17
    v_exp_f32 v18, v18
    v_exp_f32 v19, v19
    v_mfma_f32_32x32x8_bf16 v[32:47], a[232:233], a[74:75], v[32:47]
    v_exp_f32 v20, v20
    v_exp_f32 v21, v21
    v_exp_f32 v22, v22
    v_exp_f32 v23, v23
    v_smfmac_f32_32x32x32_bf16 a[48:63], a[220:223], v[0:7], v63
    global_load_dwordx4 a[214:217], v48, s[64:65] offset:2560 sc1
    v_exp_f32 v24, v24
    v_exp_f32 v25, v25
    v_exp_f32 v26, v26
    v_exp_f32 v27, v27
    v_smfmac_f32_32x32x32_bf16 a[48:63], a[224:227], v[8:15], v63
    global_load_dwordx2 a[218:219], v50, s[64:65] offset:2560 sc1
    v_exp_f32 v28, v28
    v_exp_f32 v29, v29
    v_exp_f32 v30, v30
    v_exp_f32 v31, v31
    v_mfma_f32_32x32x16_bf16 v[0:15], a[228:231], a[76:79], 0
    v_exp_f32 v32, v32
    v_exp_f32 v33, v33
    v_exp_f32 v34, v34
    v_exp_f32 v35, v35
    v_mfma_f32_32x32x8_bf16 v[0:15], a[232:233], a[80:81], v[0:15]
    v_exp_f32 v36, v36
    v_exp_f32 v37, v37
    v_exp_f32 v38, v38
    v_exp_f32 v39, v39
    v_smfmac_f32_32x32x32_bf16 a[0:15], a[234:237], v[16:23], v63
    global_load_dwordx4 a[220:223], v52, s[66:67] offset:-768 sc1
    v_exp_f32 v40, v40
    v_exp_f32 v41, v41
    v_exp_f32 v42, v42
    v_exp_f32 v43, v43
    v_smfmac_f32_32x32x32_bf16 a[0:15], a[238:241], v[24:31], v63
    global_load_dwordx4 a[224:227], v52, s[66:67] offset:-640 sc1
    v_exp_f32 v44, v44
    v_exp_f32 v45, v45
    v_exp_f32 v46, v46
    v_exp_f32 v47, v47
    v_mfma_f32_32x32x16_bf16 v[16:31], a[228:231], a[82:85], 0
    v_exp_f32 v0, v0
    v_exp_f32 v1, v1
    v_exp_f32 v2, v2
    v_exp_f32 v3, v3
    v_mfma_f32_32x32x8_bf16 v[16:31], a[232:233], a[86:87], v[16:31]
    v_exp_f32 v4, v4
    v_exp_f32 v5, v5
    v_exp_f32 v6, v6
    v_exp_f32 v7, v7
    v_smfmac_f32_32x32x32_bf16 a[16:31], a[234:237], v[32:39], v63
    v_exp_f32 v8, v8
    v_exp_f32 v9, v9
    v_exp_f32 v10, v10
    v_exp_f32 v11, v11
    v_smfmac_f32_32x32x32_bf16 a[16:31], a[238:241], v[40:47], v63
    s_waitcnt vmcnt(8)
    v_exp_f32 v12, v12
    v_exp_f32 v13, v13
    v_exp_f32 v14, v14
    v_exp_f32 v15, v15
    v_mfma_f32_32x32x16_bf16 v[32:47], a[242:245], a[64:67], 0
    v_exp_f32 v16, v16
    v_exp_f32 v17, v17
    v_exp_f32 v18, v18
    v_exp_f32 v19, v19
    v_mfma_f32_32x32x8_bf16 v[32:47], a[246:247], a[68:69], v[32:47]
    v_exp_f32 v20, v20
    v_exp_f32 v21, v21
    v_exp_f32 v22, v22
    v_exp_f32 v23, v23
    v_smfmac_f32_32x32x32_bf16 a[32:47], a[234:237], v[0:7], v63
    v_exp_f32 v24, v24
    v_exp_f32 v25, v25
    v_exp_f32 v26, v26
    v_exp_f32 v27, v27
    v_smfmac_f32_32x32x32_bf16 a[32:47], a[238:241], v[8:15], v63
    v_exp_f32 v28, v28
    v_exp_f32 v29, v29
    v_exp_f32 v30, v30
    v_exp_f32 v31, v31
    v_mfma_f32_32x32x16_bf16 v[0:15], a[242:245], a[70:73], 0
    v_exp_f32 v32, v32
    v_exp_f32 v33, v33
    v_exp_f32 v34, v34
    v_exp_f32 v35, v35
    v_mfma_f32_32x32x8_bf16 v[0:15], a[246:247], a[74:75], v[0:15]
    v_exp_f32 v36, v36
    v_exp_f32 v37, v37
    v_exp_f32 v38, v38
    v_exp_f32 v39, v39
    v_smfmac_f32_32x32x32_bf16 a[48:63], a[234:237], v[16:23], v63
    global_load_dwordx4 a[228:231], v48, s[64:65] offset:3072 sc1
    v_exp_f32 v40, v40
    v_exp_f32 v41, v41
    v_exp_f32 v42, v42
    v_exp_f32 v43, v43
    v_smfmac_f32_32x32x32_bf16 a[48:63], a[238:241], v[24:31], v63
    global_load_dwordx2 a[232:233], v50, s[64:65] offset:3072 sc1
    v_exp_f32 v44, v44
    v_exp_f32 v45, v45
    v_exp_f32 v46, v46
    v_exp_f32 v47, v47
    v_mfma_f32_32x32x16_bf16 v[16:31], a[242:245], a[76:79], 0
    v_exp_f32 v0, v0
    v_exp_f32 v1, v1
    v_exp_f32 v2, v2
    v_exp_f32 v3, v3
    v_mfma_f32_32x32x8_bf16 v[16:31], a[246:247], a[80:81], v[16:31]
    v_exp_f32 v4, v4
    v_exp_f32 v5, v5
    v_exp_f32 v6, v6
    v_exp_f32 v7, v7
    v_smfmac_f32_32x32x32_bf16 a[0:15], a[248:251], v[32:39], v63
    global_load_dwordx4 a[234:237], v52, s[66:67] offset:-512 sc1
    v_exp_f32 v8, v8
    v_exp_f32 v9, v9
    v_exp_f32 v10, v10
    v_exp_f32 v11, v11
    v_smfmac_f32_32x32x32_bf16 a[0:15], a[252:255], v[40:47], v63
    global_load_dwordx4 a[238:241], v52, s[66:67] offset:-384 sc1
    v_exp_f32 v12, v12
    v_exp_f32 v13, v13
    v_exp_f32 v14, v14
    v_exp_f32 v15, v15
    v_mfma_f32_32x32x16_bf16 v[32:47], a[242:245], a[82:85], 0
    v_exp_f32 v16, v16
    v_exp_f32 v17, v17
    v_exp_f32 v18, v18
    v_exp_f32 v19, v19
    v_mfma_f32_32x32x8_bf16 v[32:47], a[246:247], a[86:87], v[32:47]
    v_exp_f32 v20, v20
    v_exp_f32 v21, v21
    v_exp_f32 v22, v22
    v_exp_f32 v23, v23
    v_smfmac_f32_32x32x32_bf16 a[16:31], a[248:251], v[0:7], v63
    buffer_load_dwordx4 v[68:71], v62, s[24:27], 0 offen sc1
    v_exp_f32 v24, v24
    v_exp_f32 v25, v25
    v_exp_f32 v26, v26
    v_exp_f32 v27, v27
    v_smfmac_f32_32x32x32_bf16 a[16:31], a[252:255], v[8:15], v63
    s_waitcnt vmcnt(9)
    v_exp_f32 v28, v28
    v_exp_f32 v29, v29
    v_exp_f32 v30, v30
    v_exp_f32 v31, v31
    v_mfma_f32_32x32x16_bf16 v[0:15], a[200:203], a[64:67], 0
    v_exp_f32 v32, v32
    v_exp_f32 v33, v33
    v_exp_f32 v34, v34
    v_exp_f32 v35, v35
    v_mfma_f32_32x32x8_bf16 v[0:15], a[204:205], a[68:69], v[0:15]
    v_exp_f32 v36, v36
    v_exp_f32 v37, v37
    v_exp_f32 v38, v38
    v_exp_f32 v39, v39
    v_smfmac_f32_32x32x32_bf16 a[32:47], a[248:251], v[16:23], v63
    v_exp_f32 v40, v40
    v_exp_f32 v41, v41
    v_exp_f32 v42, v42
    v_exp_f32 v43, v43
    v_smfmac_f32_32x32x32_bf16 a[32:47], a[252:255], v[24:31], v63
    v_exp_f32 v44, v44
    v_exp_f32 v45, v45
    v_exp_f32 v46, v46
    v_exp_f32 v47, v47
    v_mfma_f32_32x32x16_bf16 v[16:31], a[200:203], a[70:73], 0
    v_exp_f32 v0, v0
    v_exp_f32 v1, v1
    v_exp_f32 v2, v2
    v_exp_f32 v3, v3
    v_mfma_f32_32x32x8_bf16 v[16:31], a[204:205], a[74:75], v[16:31]
    v_exp_f32 v4, v4
    v_exp_f32 v5, v5
    v_exp_f32 v6, v6
    v_exp_f32 v7, v7
    v_smfmac_f32_32x32x32_bf16 a[48:63], a[248:251], v[32:39], v63
    global_load_dwordx4 a[242:245], v48, s[64:65] offset:3584 sc1
    v_exp_f32 v8, v8
    v_exp_f32 v9, v9
    v_exp_f32 v10, v10
    v_exp_f32 v11, v11
    v_smfmac_f32_32x32x32_bf16 a[48:63], a[252:255], v[40:47], v63
    global_load_dwordx2 a[246:247], v50, s[64:65] offset:3584 sc1
    v_exp_f32 v12, v12
    v_exp_f32 v13, v13
    v_exp_f32 v14, v14
    v_exp_f32 v15, v15
    v_mfma_f32_32x32x16_bf16 v[32:47], a[200:203], a[76:79], 0
    v_exp_f32 v16, v16
    v_exp_f32 v17, v17
    v_exp_f32 v18, v18
    v_exp_f32 v19, v19
    v_mfma_f32_32x32x8_bf16 v[32:47], a[204:205], a[80:81], v[32:47]
    v_exp_f32 v20, v20
    v_exp_f32 v21, v21
    v_exp_f32 v22, v22
    v_exp_f32 v23, v23
    v_smfmac_f32_32x32x32_bf16 a[0:15], a[206:209], v[0:7], v63
    global_load_dwordx4 a[248:251], v52, s[66:67] offset:-256 sc1
    v_exp_f32 v24, v24
    v_exp_f32 v25, v25
    v_exp_f32 v26, v26
    v_exp_f32 v27, v27
    v_smfmac_f32_32x32x32_bf16 a[0:15], a[210:213], v[8:15], v63
    global_load_dwordx4 a[252:255], v52, s[66:67] offset:-128 sc1
    v_exp_f32 v28, v28
    v_exp_f32 v29, v29
    v_exp_f32 v30, v30
    v_exp_f32 v31, v31
    v_mfma_f32_32x32x16_bf16 v[0:15], a[200:203], a[82:85], 0
    v_exp_f32 v32, v32
    v_exp_f32 v33, v33
    v_exp_f32 v34, v34
    v_exp_f32 v35, v35
    v_mfma_f32_32x32x8_bf16 v[0:15], a[204:205], a[86:87], v[0:15]
    v_exp_f32 v36, v36
    v_exp_f32 v37, v37
    v_exp_f32 v38, v38
    v_exp_f32 v39, v39
    v_smfmac_f32_32x32x32_bf16 a[16:31], a[206:209], v[16:23], v63
    v_exp_f32 v40, v40
    v_exp_f32 v41, v41
    v_exp_f32 v42, v42
    v_exp_f32 v43, v43
    v_smfmac_f32_32x32x32_bf16 a[16:31], a[210:213], v[24:31], v63
    s_waitcnt vmcnt(9)
    v_exp_f32 v44, v44
    v_exp_f32 v45, v45
    v_exp_f32 v46, v46
    v_exp_f32 v47, v47
    v_mfma_f32_32x32x16_bf16 v[16:31], a[214:217], a[64:67], 0
    v_exp_f32 v0, v0
    v_exp_f32 v1, v1
    v_exp_f32 v2, v2
    v_exp_f32 v3, v3
    v_mfma_f32_32x32x8_bf16 v[16:31], a[218:219], a[68:69], v[16:31]
    v_exp_f32 v4, v4
    v_exp_f32 v5, v5
    v_exp_f32 v6, v6
    v_exp_f32 v7, v7
    v_smfmac_f32_32x32x32_bf16 a[32:47], a[206:209], v[32:39], v63
    v_exp_f32 v8, v8
    v_exp_f32 v9, v9
    v_exp_f32 v10, v10
    v_exp_f32 v11, v11
    v_smfmac_f32_32x32x32_bf16 a[32:47], a[210:213], v[40:47], v63
    v_exp_f32 v12, v12
    v_exp_f32 v13, v13
    v_exp_f32 v14, v14
    v_exp_f32 v15, v15
    v_mfma_f32_32x32x16_bf16 v[32:47], a[214:217], a[70:73], 0
    s_add_u32 s64, s64, 8192
    s_addc_u32 s65, s65, 0
    v_exp_f32 v16, v16
    v_exp_f32 v17, v17
    v_exp_f32 v18, v18
    v_exp_f32 v19, v19
    v_mfma_f32_32x32x8_bf16 v[32:47], a[218:219], a[74:75], v[32:47]
    v_exp_f32 v20, v20
    v_exp_f32 v21, v21
    v_exp_f32 v22, v22
    v_exp_f32 v23, v23
    v_smfmac_f32_32x32x32_bf16 a[48:63], a[206:209], v[0:7], v63
    global_load_dwordx4 a[200:203], v48, s[64:65] offset:-4096 sc1
    v_exp_f32 v24, v24
    v_exp_f32 v25, v25
    v_exp_f32 v26, v26
    v_exp_f32 v27, v27
    v_smfmac_f32_32x32x32_bf16 a[48:63], a[210:213], v[8:15], v63
    global_load_dwordx2 a[204:205], v50, s[64:65] offset:-4096 sc1
    v_exp_f32 v28, v28
    v_exp_f32 v29, v29
    v_exp_f32 v30, v30
    v_exp_f32 v31, v31
    v_mfma_f32_32x32x16_bf16 v[0:15], a[214:217], a[76:79], 0
    v_exp_f32 v32, v32
    v_exp_f32 v33, v33
    v_exp_f32 v34, v34
    v_exp_f32 v35, v35
    v_mfma_f32_32x32x8_bf16 v[0:15], a[218:219], a[80:81], v[0:15]
    v_exp_f32 v36, v36
    v_exp_f32 v37, v37
    v_exp_f32 v38, v38
    v_exp_f32 v39, v39
    v_smfmac_f32_32x32x32_bf16 a[0:15], a[220:223], v[16:23], v63
    global_load_dwordx4 a[206:209], v52, s[66:67] offset:0 sc1
    v_exp_f32 v40, v40
    v_exp_f32 v41, v41
    v_exp_f32 v42, v42
    v_exp_f32 v43, v43
    v_smfmac_f32_32x32x32_bf16 a[0:15], a[224:227], v[24:31], v63
    global_load_dwordx4 a[210:213], v52, s[66:67] offset:128 sc1
    v_exp_f32 v44, v44
    v_exp_f32 v45, v45
    v_exp_f32 v46, v46
    v_exp_f32 v47, v47
    v_mfma_f32_32x32x16_bf16 v[16:31], a[214:217], a[82:85], 0
    s_waitcnt vmcnt(8)
    s_mov_b32 s44, 0x1000000
L_spH:
    v_xor_b32 v68, s84, v68
    v_xor_b32 v69, s84, v69
    v_xor_b32 v70, s84, v70
    v_xor_b32 v71, s84, v71
    v_or3_b32 v68, v68, v69, v70
    v_or_b32 v68, v68, v71
    v_cmp_ne_u32 vcc, 0, v68
    s_nop 0
    s_cbranch_vccz L_okH
    s_sub_u32 s44, s44, 1
    s_cbranch_scc1 L_okH
    s_sleep 1
    buffer_load_dwordx4 v[68:71], v62, s[24:27], 0 offen sc1
    s_waitcnt vmcnt(0)
    s_branch L_spH
L_okH:
    v_exp_f32 v0, v0
    v_exp_f32 v1, v1
    v_exp_f32 v2, v2
    v_exp_f32 v3, v3
    v_mfma_f32_32x32x8_bf16 v[16:31], a[218:219], a[86:87], v[16:31]
    v_exp_f32 v4, v4
    v_exp_f32 v5, v5
    v_exp_f32 v6, v6
    v_exp_f32 v7, v7
    v_smfmac_f32_32x32x32_bf16 a[16:31], a[220:223], v[32:39], v63
    s_add_u32 m0, s45, 6144
    s_add_u32 s70, s74, 53248
    s_add_u32 s70, s24, s70
    s_addc_u32 s71, s25, 0
    global_load_lds_dwordx4 v53, s[70:71] offset:0 sc1
    v_exp_f32 v8, v8
    v_exp_f32 v9, v9
    v_exp_f32 v10, v10
    v_exp_f32 v11, v11
    v_smfmac_f32_32x32x32_bf16 a[16:31], a[224:227], v[40:47], v63
    s_waitcnt vmcnt(10)
    global_load_lds_dwordx4 v53, s[70:71] offset:1024 sc1
    v_exp_f32 v12, v12
    v_exp_f32 v13, v13
    v_exp_f32 v14, v14
    v_exp_f32 v15, v15
    v_mfma_f32_32x32x16_bf16 v[32:47], a[228:231], a[64:67], 0
    v_exp_f32 v16, v16
    v_exp_f32 v17, v17
    v_exp_f32 v18, v18
    v_exp_f32 v19, v19
    v_mfma_f32_32x32x8_bf16 v[32:47], a[232:233], a[68:69], v[32:47]
    v_exp_f32 v20, v20
    v_exp_f32 v21, v21
    v_exp_f32 v22, v22
    v_exp_f32 v23, v23
    v_smfmac_f32_32x32x32_bf16 a[32:47], a[220:223], v[0:7], v63
    global_load_lds_dwordx4 v53, s[70:71] offset:2048 sc1
    v_exp_f32 v24, v24
    v_exp_f32 v25, v25
    v_exp_f32 v26, v26
    v_exp_f32 v27, v27
    v_smfmac_f32_32x32x32_bf16 a[32:47], a[224:227], v[8:15], v63
    global_load_lds_dwordx4 v53, s[70:71] offset:3072 sc1
    s_add_u32 m0, s45, 10240
    v_exp_f32 v28, v28
    v_exp_f32 v29, v29
    v_exp_f32 v30, v30
    v_exp_f32 v31, v31
    v_mfma_f32_32x32x16_bf16 v[0:15], a[228:231], a[70:73], 0
    s_add_u32 s70, s74, 57344
    v_exp_f32 v32, v32
    v_exp_f32 v33, v33
    v_exp_f32 v34, v34
    v_exp_f32 v35, v35
    v_mfma_f32_32x32x8_bf16 v[0:15], a[232:233], a[74:75], v[0:15]
    v_exp_f32 v36, v36
    v_exp_f32 v37, v37
    v_exp_f32 v38, v38
    v_exp_f32 v39, v39
    v_smfmac_f32_32x32x32_bf16 a[48:63], a[220:223], v[16:23], v63
    global_load_dwordx4 a[214:217], v48, s[64:65] offset:-3584 sc1
    s_add_u32 s70, s24, s70
    v_exp_f32 v40, v40
    v_exp_f32 v41, v41
    v_exp_f32 v42, v42
    v_exp_f32 v43, v43
    v_smfmac_f32_32x32x32_bf16 a[48:63], a[224:227], v[24:31], v63
    global_load_dwordx2 a[218:219], v50, s[64:65] offset:-3584 sc1
    s_addc_u32 s71, s25, 0
    v_exp_f32 v44, v44
    v_exp_f32 v45, v45
    v_exp_f32 v46, v46
    v_exp_f32 v47, v47
    v_mfma_f32_32x32x16_bf16 v[16:31], a[228:231], a[76:79], 0
    v_exp_f32 v0, v0
    v_exp_f32 v1, v1
    v_exp_f32 v2, v2
    v_exp_f32 v3, v3
    v_mfma_f32_32x32x8_bf16 v[16:31], a[232:233], a[80:81], v[16:31]
    v_exp_f32 v4, v4
    v_exp_f32 v5, v5
    v_exp_f32 v6, v6
    v_exp_f32 v7, v7
    v_smfmac_f32_32x32x32_bf16 a[0:15], a[234:237], v[32:39], v63
    global_load_dwordx4 a[220:223], v52, s[66:67] offset:256 sc1
    v_exp_f32 v8, v8
    v_exp_f32 v9, v9
    v_exp_f32 v10, v10
    v_exp_f32 v11, v11
    v_smfmac_f32_32x32x32_bf16 a[0:15], a[238:241], v[40:47], v63
    global_load_dwordx4 a[224:227], v52, s[66:67] offset:384 sc1
    v_exp_f32 v12, v12
    v_exp_f32 v13, v13
    v_exp_f32 v14, v14
    v_exp_f32 v15, v15
    v_mfma_f32_32x32x16_bf16 v[32:47], a[228:231], a[82:85], 0
    global_load_lds_dwordx4 v53, s[70:71] offset:0 sc1
    v_exp_f32 v16, v16
    v_exp_f32 v17, v17
    v_exp_f32 v18, v18
    v_exp_f32 v19, v19
    v_mfma_f32_32x32x8_bf16 v[32:47], a[232:233], a[86:87], v[32:47]
    v_exp_f32 v20, v20
    v_exp_f32 v21, v21
    v_exp_f32 v22, v22
    v_exp_f32 v23, v23
    v_smfmac_f32_32x32x32_bf16 a[16:31], a[234:237], v[0:7], v63
    global_load_lds_dwordx4 v53, s[70:71] offset:1024 sc1
    v_exp_f32 v24, v24
    v_exp_f32 v25, v25
    v_exp_f32 v26, v26
    v_exp_f32 v27, v27
    v_smfmac_f32_32x32x32_bf16 a[16:31], a[238:241], v[8:15], v63
    s_waitcnt vmcnt(14)
    global_load_lds_dwordx4 v53, s[70:71] offset:2048 sc1
    v_exp_f32 v28, v28
    v_exp_f32 v29, v29
    v_exp_f32 v30, v30
    v_exp_f32 v31, v31
    v_mfma_f32_32x32x16_bf16 v[0:15], a[242:245], a[64:67], 0
    v_exp_f32 v32, v32
    v_exp_f32 v33, v33
    v_exp_f32 v34, v34
    v_exp_f32 v35, v35
    v_mfma_f32_32x32x8_bf16 v[0:15], a[246:247], a[68:69], v[0:15]
    v_exp_f32 v36, v36
    v_exp_f32 v37, v37
    v_exp_f32 v38, v38
    v_exp_f32 v39, v39
    v_smfmac_f32_32x32x32_bf16 a[32:47], a[234:237], v[16:23], v63
    global_load_lds_dwordx4 v53, s[70:71] offset:3072 sc1
    s_add_u32 m0, s45, 14336
    v_exp_f32 v40, v40
    v_exp_f32 v41, v41
    v_exp_f32 v42, v42
    v_exp_f32 v43, v43
    v_smfmac_f32_32x32x32_bf16 a[32:47], a[238:241], v[24:31], v63
    s_add_u32 s70, s80, 0
    s_add_u32 s70, s24, s70
    s_addc_u32 s71, s25, 0
    global_load_lds_dwordx4 v53, s[70:71] offset:0 sc1
    v_exp_f32 v44, v44
    v_exp_f32 v45, v45
    v_exp_f32 v46, v46
    v_exp_f32 v47, v47
    v_mfma_f32_32x32x16_bf16 v[16:31], a[242:245], a[70:73], 0
    v_exp_f32 v0, v0
    v_exp_f32 v1, v1
    v_exp_f32 v2, v2
    v_exp_f32 v3, v3
    v_mfma_f32_32x32x8_bf16 v[16:31], a[246:247], a[74:75], v[16:31]
    v_exp_f32 v4, v4
    v_exp_f32 v5, v5
    v_exp_f32 v6, v6
    v_exp_f32 v7, v7
    v_smfmac_f32_32x32x32_bf16 a[48:63], a[234:237], v[32:39], v63
    global_load_dwordx4 a[228:231], v48, s[64:65] offset:-3072 sc1
    v_exp_f32 v8, v8
    v_exp_f32 v9, v9
    v_exp_f32 v10, v10
    v_exp_f32 v11, v11
    v_smfmac_f32_32x32x32_bf16 a[48:63], a[238:241], v[40:47], v63
    global_load_dwordx2 a[232:233], v50, s[64:65] offset:-3072 sc1
    v_exp_f32 v12, v12
    v_exp_f32 v13, v13
    v_exp_f32 v14, v14
    v_exp_f32 v15, v15
    v_mfma_f32_32x32x16_bf16 v[32:47], a[242:245], a[76:79], 0
    v_exp_f32 v16, v16
    v_exp_f32 v17, v17
    v_exp_f32 v18, v18
    v_exp_f32 v19, v19
    v_mfma_f32_32x32x8_bf16 v[32:47], a[246:247], a[80:81], v[32:47]
    v_exp_f32 v20, v20
    v_exp_f32 v21, v21
    v_exp_f32 v22, v22
    v_exp_f32 v23, v23
    v_smfmac_f32_32x32x32_bf16 a[0:15], a[248:251], v[0:7], v63
    global_load_dwordx4 a[234:237], v52, s[66:67] offset:512 sc1
    v_exp_f32 v24, v24
    v_exp_f32 v25, v25
    v_exp_f32 v26, v26
    v_exp_f32 v27, v27
    v_smfmac_f32_32x32x32_bf16 a[0:15], a[252:255], v[8:15], v63
    global_load_dwordx4 a[238:241], v52, s[66:67] offset:640 sc1
    v_exp_f32 v28, v28
    v_exp_f32 v29, v29
    v_exp_f32 v30, v30
    v_exp_f32 v31, v31
    v_mfma_f32_32x32x16_bf16 v[0:15], a[242:245], a[82:85], 0
    global_load_lds_dwordx4 v53, s[70:71] offset:1024 sc1
    v_exp_f32 v32, v32
    v_exp_f32 v33, v33
    v_exp_f32 v34, v34
    v_exp_f32 v35, v35
    v_mfma_f32_32x32x8_bf16 v[0:15], a[246:247], a[86:87], v[0:15]
    v_exp_f32 v36, v36
    v_exp_f32 v37, v37
    v_exp_f32 v38, v38
    v_exp_f32 v39, v39
    v_smfmac_f32_32x32x32_bf16 a[16:31], a[248:251], v[16:23], v63
    global_load_lds_dwordx4 v53, s[70:71] offset:2048 sc1
    v_exp_f32 v40, v40
    v_exp_f32 v41, v41
    v_exp_f32 v42, v42
    v_exp_f32 v43, v43
    v_smfmac_f32_32x32x32_bf16 a[16:31], a[252:255], v[24:31], v63
    s_waitcnt vmcnt(19)
    global_load_lds_dwordx4 v53, s[70:71] offset:3072 sc1
    v_exp_f32 v44, v44
    v_exp_f32 v45, v45
    v_exp_f32 v46, v46
    v_exp_f32 v47, v47
    v_mfma_f32_32x32x16_bf16 v[16:31], a[200:203], a[64:67], 0
    s_add_u32 m0, s45, 18432
    s_add_u32 s70, s80, 4096
    s_add_u32 s70, s24, s70
    s_addc_u32 s71, s25, 0
    global_load_lds_dwordx4 v53, s[70:71] offset:0 sc1
    v_exp_f32 v0, v0
    v_exp_f32 v1, v1
    v_exp_f32 v2, v2
    v_exp_f32 v3, v3
    v_mfma_f32_32x32x8_bf16 v[16:31], a[204:205], a[68:69], v[16:31]
    v_exp_f32 v4, v4
    v_exp_f32 v5, v5
    v_exp_f32 v6, v6
    v_exp_f32 v7, v7
    v_smfmac_f32_32x32x32_bf16 a[32:47], a[248:251], v[32:39], v63
    global_load_lds_dwordx4 v53, s[70:71] offset:1024 sc1
    v_exp_f32 v8, v8
    v_exp_f32 v9, v9
    v_exp_f32 v10, v10
    v_exp_f32 v11, v11
    v_smfmac_f32_32x32x32_bf16 a[32:47], a[252:255], v[40:47], v63
    global_load_lds_dwordx4 v53, s[70:71] offset:2048 sc1
    v_exp_f32 v12, v12
    v_exp_f32 v13, v13
    v_exp_f32 v14, v14
    v_exp_f32 v15, v15
    v_mfma_f32_32x32x16_bf16 v[32:47], a[200:203], a[70:73], 0
    v_exp_f32 v16, v16
    v_exp_f32 v17, v17
    v_exp_f32 v18, v18
    v_exp_f32 v19, v19
    v_mfma_f32_32x32x8_bf16 v[32:47], a[204:205], a[74:75], v[32:47]
    v_exp_f32 v20, v20
    v_exp_f32 v21, v21
    v_exp_f32 v22, v22
    v_exp_f32 v23, v23
    v_smfmac_f32_32x32x32_bf16 a[48:63], a[248:251], v[0:7], v63
    global_load_dwordx4 a[242:245], v48, s[64:65] offset:-2560 sc1
    v_exp_f32 v24, v24
    v_exp_f32 v25, v25
    v_exp_f32 v26, v26
    v_exp_f32 v27, v27
    v_smfmac_f32_32x32x32_bf16 a[48:63], a[252:255], v[8:15], v63
    global_load_dwordx2 a[246:247], v50, s[64:65] offset:-2560 sc1
    v_exp_f32 v28, v28
    v_exp_f32 v29, v29
    v_exp_f32 v30, v30
    v_exp_f32 v31, v31
    v_mfma_f32_32x32x16_bf16 v[0:15], a[200:203], a[76:79], 0
    v_exp_f32 v32, v32
    v_exp_f32 v33, v33
    v_exp_f32 v34, v34
    v_exp_f32 v35, v35
    v_mfma_f32_32x32x8_bf16 v[0:15], a[204:205], a[80:81], v[0:15]
    v_exp_f32 v36, v36
    v_exp_f32 v37, v37
    v_exp_f32 v38, v38
    v_exp_f32 v39, v39
    v_smfmac_f32_32x32x32_bf16 a[0:15], a[206:209], v[16:23], v63
    global_load_dwordx4 a[248:251], v52, s[66:67] offset:768 sc1
    v_exp_f32 v40, v40
    v_exp_f32 v41, v41
    v_exp_f32 v42, v42
    v_exp_f32 v43, v43
    v_smfmac_f32_32x32x32_bf16 a[0:15], a[210:213], v[24:31], v63
    global_load_dwordx4 a[252:255], v52, s[66:67] offset:896 sc1
    v_exp_f32 v44, v44
    v_exp_f32 v45, v45
    v_exp_f32 v46, v46
    v_exp_f32 v47, v47
    v_mfma_f32_32x32x16_bf16 v[16:31], a[200:203], a[82:85], 0
    global_load_lds_dwordx4 v53, s[70:71] offset:3072 sc1
    v_exp_f32 v0, v0
    v_exp_f32 v1, v1
    v_exp_f32 v2, v2
    v_exp_f32 v3, v3
    v_mfma_f32_32x32x8_bf16 v[16:31], a[204:205], a[86:87], v[16:31]
    v_exp_f32 v4, v4
    v_exp_f32 v5, v5
    v_exp_f32 v6, v6
    v_exp_f32 v7, v7
    v_smfmac_f32_32x32x32_bf16 a[16:31], a[206:209], v[32:39], v63
    s_add_u32 m0, s45, 22528
    s_add_u32 s70, s80, 8192
    s_add_u32 s70, s24, s70
    s_addc_u32 s71, s25, 0
    global_load_lds_dwordx4 v53, s[70:71] offset:0 sc1
    v_exp_f32 v8, v8
    v_exp_f32 v9, v9
    v_exp_f32 v10, v10
    v_exp_f32 v11, v11
    v_smfmac_f32_32x32x32_bf16 a[16:31], a[210:213], v[40:47], v63
    s_waitcnt vmcnt(21)
    global_load_lds_dwordx4 v53, s[70:71] offset:1024 sc1
    v_exp_f32 v12, v12
    v_exp_f32 v13, v13
    v_exp_f32 v14, v14
    v_exp_f32 v15, v15
    v_mfma_f32_32x32x16_bf16 v[32:47], a[214:217], a[64:67], 0
    v_exp_f32 v16, v16
    v_exp_f32 v17, v17
    v_exp_f32 v18, v18
    v_exp_f32 v19, v19
    v_mfma_f32_32x32x8_bf16 v[32:47], a[218:219], a[68:69], v[32:47]
    v_exp_f32 v20, v20
    v_exp_f32 v21, v21
    v_exp_f32 v22, v22
    v_exp_f32 v23, v23
    v_smfmac_f32_32x32x32_bf16 a[32:47], a[206:209], v[0:7], v63
    global_load_lds_dwordx4 v53, s[70:71] offset:2048 sc1
    v_exp_f32 v24, v24
    v_exp_f32 v25, v25
    v_exp_f32 v26, v26
    v_exp_f32 v27, v27
    v_smfmac_f32_32x32x32_bf16 a[32:47], a[210:213], v[8:15], v63
    global_load_lds_dwordx4 v53, s[70:71] offset:3072 sc1
    s_add_u32 m0, s45, 26624
    v_exp_f32 v28, v28
    v_exp_f32 v29, v29
    v_exp_f32 v30, v30
    v_exp_f32 v31, v31
    v_mfma_f32_32x32x16_bf16 v[0:15], a[214:217], a[70:73], 0
    s_add_u32 s70, s80, 12288
    v_exp_f32 v32, v32
    v_exp_f32 v33, v33
    v_exp_f32 v34, v34
    v_exp_f32 v35, v35
    v_mfma_f32_32x32x8_bf16 v[0:15], a[218:219], a[74:75], v[0:15]
    v_exp_f32 v36, v36
    v_exp_f32 v37, v37
    v_exp_f32 v38, v38
    v_exp_f32 v39, v39
    v_smfmac_f32_32x32x32_bf16 a[48:63], a[206:209], v[16:23], v63
    global_load_dwordx4 a[200:203], v48, s[64:65] offset:-2048 sc1
    s_add_u32 s70, s24, s70
    v_exp_f32 v40, v40
    v_exp_f32 v41, v41
    v_exp_f32 v42, v42
    v_exp_f32 v43, v43
    v_smfmac_f32_32x32x32_bf16 a[48:63], a[210:213], v[24:31], v63
    global_load_dwordx2 a[204:205], v50, s[64:65] offset:-2048 sc1
    s_addc_u32 s71, s25, 0
    v_exp_f32 v44, v44
    v_exp_f32 v45, v45
    v_exp_f32 v46, v46
    v_exp_f32 v47, v47
    v_mfma_f32_32x32x16_bf16 v[16:31], a[214:217], a[76:79], 0
    v_exp_f32 v0, v0
    v_exp_f32 v1, v1
    v_exp_f32 v2, v2
    v_exp_f32 v3, v3
    v_mfma_f32_32x32x8_bf16 v[16:31], a[218:219], a[80:81], v[16:31]
    v_exp_f32 v4, v4
    v_exp_f32 v5, v5
    v_exp_f32 v6, v6
    v_exp_f32 v7, v7
    v_smfmac_f32_32x32x32_bf16 a[0:15], a[220:223], v[32:39], v63
    global_load_dwordx4 a[206:209], v52, s[66:67] offset:1024 sc1
    v_exp_f32 v8, v8
    v_exp_f32 v9, v9
    v_exp_f32 v10, v10
    v_exp_f32 v11, v11
    v_smfmac_f32_32x32x32_bf16 a[0:15], a[224:227], v[40:47], v63
    global_load_dwordx4 a[210:213], v52, s[66:67] offset:1152 sc1
    v_exp_f32 v12, v12
    v_exp_f32 v13, v13
    v_exp_f32 v14, v14
    v_exp_f32 v15, v15
    v_mfma_f32_32x32x16_bf16 v[32:47], a[214:217], a[82:85], 0
    global_load_lds_dwordx4 v53, s[70:71] offset:0 sc1
    v_exp_f32 v16, v16
    v_exp_f32 v17, v17
    v_exp_f32 v18, v18
    v_exp_f32 v19, v19
    v_mfma_f32_32x32x8_bf16 v[32:47], a[218:219], a[86:87], v[32:47]
    v_exp_f32 v20, v20
    v_exp_f32 v21, v21
    v_exp_f32 v22, v22
    v_exp_f32 v23, v23
    v_smfmac_f32_32x32x32_bf16 a[16:31], a[220:223], v[0:7], v63
    global_load_lds_dwordx4 v53, s[70:71] offset:1024 sc1
    v_exp_f32 v24, v24
    v_exp_f32 v25, v25
    v_exp_f32 v26, v26
    v_exp_f32 v27, v27
    v_smfmac_f32_32x32x32_bf16 a[16:31], a[224:227], v[8:15], v63
    s_waitcnt vmcnt(21)
    global_load_lds_dwordx4 v53, s[70:71] offset:2048 sc1
    v_exp_f32 v28, v28
    v_exp_f32 v29, v29
    v_exp_f32 v30, v30
    v_exp_f32 v31, v31
    v_mfma_f32_32x32x16_bf16 v[0:15], a[228:231], a[64:67], 0
    global_load_lds_dwordx4 v53, s[70:71] offset:3072 sc1
    v_exp_f32 v32, v32
    v_exp_f32 v33, v33
    v_exp_f32 v34, v34
    v_exp_f32 v35, v35
    v_mfma_f32_32x32x8_bf16 v[0:15], a[232:233], a[68:69], v[0:15]
    v_exp_f32 v36, v36
    v_exp_f32 v37, v37
    v_exp_f32 v38, v38
    v_exp_f32 v39, v39
    v_smfmac_f32_32x32x32_bf16 a[32:47], a[220:223], v[16:23], v63
    s_add_u32 m0, s45, 30720
    s_add_u32 s70, s80, 16384
    s_add_u32 s70, s24, s70
    s_addc_u32 s71, s25, 0
    global_load_lds_dwordx4 v53, s[70:71] offset:0 sc1
    v_exp_f32 v40, v40
    v_exp_f32 v41, v41
    v_exp_f32 v42, v42
    v_exp_f32 v43, v43
    v_smfmac_f32_32x32x32_bf16 a[32:47], a[224:227], v[24:31], v63
    global_load_lds_dwordx4 v53, s[70:71] offset:1024 sc1
    v_exp_f32 v44, v44
    v_exp_f32 v45, v45
    v_exp_f32 v46, v46
    v_exp_f32 v47, v47
    v_mfma_f32_32x32x16_bf16 v[16:31], a[228:231], a[70:73], 0
    v_exp_f32 v0, v0
    v_exp_f32 v1, v1
    v_exp_f32 v2, v2
    v_exp_f32 v3, v3
    v_mfma_f32_32x32x8_bf16 v[16:31], a[232:233], a[74:75], v[16:31]
    v_exp_f32 v4, v4
    v_exp_f32 v5, v5
    v_exp_f32 v6, v6
    v_exp_f32 v7, v7
    v_smfmac_f32_32x32x32_bf16 a[48:63], a[220:223], v[32:39], v63
    global_load_dwordx4 a[214:217], v48, s[64:65] offset:-1536 sc1
    v_exp_f32 v8, v8
    v_exp_f32 v9, v9
    v_exp_f32 v10, v10
    v_exp_f32 v11, v11
    v_smfmac_f32_32x32x32_bf16 a[48:63], a[224:227], v[40:47], v63
    global_load_dwordx2 a[218:219], v50, s[64:65] offset:-1536 sc1
    v_exp_f32 v12, v12
    v_exp_f32 v13, v13
    v_exp_f32 v14, v14
    v_exp_f32 v15, v15
    v_mfma_f32_32x32x16_bf16 v[32:47], a[228:231], a[76:79], 0
    v_exp_f32 v16, v16
    v_exp_f32 v17, v17
    v_exp_f32 v18, v18
    v_exp_f32 v19, v19
    v_mfma_f32_32x32x8_bf16 v[32:47], a[232:233], a[80:81], v[32:47]
    v_exp_f32 v20, v20
    v_exp_f32 v21, v21
    v_exp_f32 v22, v22
    v_exp_f32 v23, v23
    v_smfmac_f32_32x32x32_bf16 a[0:15], a[234:237], v[0:7], v63
    global_load_dwordx4 a[220:223], v52, s[66:67] offset:1280 sc1
    v_exp_f32 v24, v24
    v_exp_f32 v25, v25
    v_exp_f32 v26, v26
    v_exp_f32 v27, v27
    v_smfmac_f32_32x32x32_bf16 a[0:15], a[238:241], v[8:15], v63
    global_load_dwordx4 a[224:227], v52, s[66:67] offset:1408 sc1
    v_exp_f32 v28, v28
    v_exp_f32 v29, v29
    v_exp_f32 v30, v30
    v_exp_f32 v31, v31
    v_mfma_f32_32x32x16_bf16 v[0:15], a[228:231], a[82:85], 0
    global_load_lds_dwordx4 v53, s[70:71] offset:2048 sc1
    v_exp_f32 v32, v32
    v_exp_f32 v33, v33
    v_exp_f32 v34, v34
    v_exp_f32 v35, v35
    v_mfma_f32_32x32x8_bf16 v[0:15], a[232:233], a[86:87], v[0:15]
    v_exp_f32 v36, v36
    v_exp_f32 v37, v37
    v_exp_f32 v38, v38
    v_exp_f32 v39, v39
    v_smfmac_f32_32x32x32_bf16 a[16:31], a[234:237], v[16:23], v63
    global_load_lds_dwordx4 v53, s[70:71] offset:3072 sc1
    s_add_u32 m0, s45, 34816
    v_exp_f32 v40, v40
    v_exp_f32 v41, v41
    v_exp_f32 v42, v42
    v_exp_f32 v43, v43
    v_smfmac_f32_32x32x32_bf16 a[16:31], a[238:241], v[24:31], v63
    s_waitcnt vmcnt(21)
    s_add_u32 s70, s80, 20480
    s_add_u32 s70, s24, s70
    s_addc_u32 s71, s25, 0
    global_load_lds_dwordx4 v53, s[70:71] offset:0 sc1
    v_exp_f32 v44, v44
    v_exp_f32 v45, v45
    v_exp_f32 v46, v46
    v_exp_f32 v47, v47
    v_mfma_f32_32x32x16_bf16 v[16:31], a[242:245], a[64:67], 0
    v_exp_f32 v0, v0
    v_exp_f32 v1, v1
    v_exp_f32 v2, v2
    v_exp_f32 v3, v3
    v_mfma_f32_32x32x8_bf16 v[16:31], a[246:247], a[68:69], v[16:31]
    v_exp_f32 v4, v4
    v_exp_f32 v5, v5
    v_exp_f32 v6, v6
    v_exp_f32 v7, v7
    v_smfmac_f32_32x32x32_bf16 a[32:47], a[234:237], v[32:39], v63
    global_load_lds_dwordx4 v53, s[70:71] offset:1024 sc1
    v_exp_f32 v8, v8
    v_exp_f32 v9, v9
    v_exp_f32 v10, v10
    v_exp_f32 v11, v11
    v_smfmac_f32_32x32x32_bf16 a[32:47], a[238:241], v[40:47], v63
    global_load_lds_dwordx4 v53, s[70:71] offset:2048 sc1
    v_exp_f32 v12, v12
    v_exp_f32 v13, v13
    v_exp_f32 v14, v14
    v_exp_f32 v15, v15
    v_mfma_f32_32x32x16_bf16 v[32:47], a[242:245], a[70:73], 0
    v_exp_f32 v16, v16
    v_exp_f32 v17, v17
    v_exp_f32 v18, v18
    v_exp_f32 v19, v19
    v_mfma_f32_32x32x8_bf16 v[32:47], a[246:247], a[74:75], v[32:47]
    v_exp_f32 v20, v20
    v_exp_f32 v21, v21
    v_exp_f32 v22, v22
    v_exp_f32 v23, v23
    v_smfmac_f32_32x32x32_bf16 a[48:63], a[234:237], v[0:7], v63
    global_load_dwordx4 a[228:231], v48, s[64:65] offset:-1024 sc1
    v_exp_f32 v24, v24
    v_exp_f32 v25, v25
    v_exp_f32 v26, v26
    v_exp_f32 v27, v27
    v_smfmac_f32_32x32x32_bf16 a[48:63], a[238:241], v[8:15], v63
    global_load_dwordx2 a[232:233], v50, s[64:65] offset:-1024 sc1
    v_exp_f32 v28, v28
    v_exp_f32 v29, v29
    v_exp_f32 v30, v30
    v_exp_f32 v31, v31
    v_mfma_f32_32x32x16_bf16 v[0:15], a[242:245], a[76:79], 0
    v_exp_f32 v32, v32
    v_exp_f32 v33, v33
    v_exp_f32 v34, v34
    v_exp_f32 v35, v35
    v_mfma_f32_32x32x8_bf16 v[0:15], a[246:247], a[80:81], v[0:15]
    v_exp_f32 v36, v36
    v_exp_f32 v37, v37
    v_exp_f32 v38, v38
    v_exp_f32 v39, v39
    v_smfmac_f32_32x32x32_bf16 a[0:15], a[248:251], v[16:23], v63
    global_load_dwordx4 a[234:237], v52, s[66:67] offset:1536 sc1
    v_exp_f32 v40, v40
    v_exp_f32 v41, v41
    v_exp_f32 v42, v42
    v_exp_f32 v43, v43
    v_smfmac_f32_32x32x32_bf16 a[0:15], a[252:255], v[24:31], v63
    global_load_dwordx4 a[238:241], v52, s[66:67] offset:1664 sc1
    v_exp_f32 v44, v44
    v_exp_f32 v45, v45
    v_exp_f32 v46, v46
    v_exp_f32 v47, v47
    v_mfma_f32_32x32x16_bf16 v[16:31], a[242:245], a[82:85], 0
    global_load_lds_dwordx4 v53, s[70:71] offset:3072 sc1
    v_exp_f32 v0, v0
    v_exp_f32 v1, v1
    v_exp_f32 v2, v2
    v_exp_f32 v3, v3
    v_mfma_f32_32x32x8_bf16 v[16:31], a[246:247], a[86:87], v[16:31]
    v_exp_f32 v4, v4
    v_exp_f32 v5, v5
    v_exp_f32 v6, v6
    v_exp_f32 v7, v7
    v_smfmac_f32_32x32x32_bf16 a[16:31], a[248:251], v[32:39], v63
    s_add_u32 m0, s45, 38912
    s_add_u32 s70, s80, 24576
    s_add_u32 s70, s24, s70
    s_addc_u32 s71, s25, 0
    global_load_lds_dwordx4 v53, s[70:71] offset:0 sc1
    v_exp_f32 v8, v8
    v_exp_f32 v9, v9
    v_exp_f32 v10, v10
    v_exp_f32 v11, v11
    v_smfmac_f32_32x32x32_bf16 a[16:31], a[252:255], v[40:47], v63
    s_waitcnt vmcnt(21)
    s_add_u32 s70, s74, 4096
    s_add_u32 s70, s24, s70
    s_addc_u32 s71, s25, 0
    global_load_dwordx4 a[88:91], v53, s[70:71] offset:-4096 sc1
    v_exp_f32 v12, v12
    v_exp_f32 v13, v13
    v_exp_f32 v14, v14
    v_exp_f32 v15, v15
    v_mfma_f32_32x32x16_bf16 v[32:47], a[200:203], a[64:67], 0
    v_exp_f32 v16, v16
    v_exp_f32 v17, v17
    v_exp_f32 v18, v18
    v_exp_f32 v19, v19
    v_mfma_f32_32x32x8_bf16 v[32:47], a[204:205], a[68:69], v[32:47]
    v_exp_f32 v20, v20
    v_exp_f32 v21, v21
    v_exp_f32 v22, v22
    v_exp_f32 v23, v23
    v_smfmac_f32_32x32x32_bf16 a[32:47], a[248:251], v[0:7], v63
    global_load_dwordx4 a[92:95], v53, s[70:71] offset:-3072 sc1
    v_exp_f32 v24, v24
    v_exp_f32 v25, v25
    v_exp_f32 v26, v26
    v_exp_f32 v27, v27
    v_smfmac_f32_32x32x32_bf16 a[32:47], a[252:255], v[8:15], v63
    global_load_dwordx4 a[96:99], v53, s[70:71] offset:-2048 sc1
    v_exp_f32 v28, v28
    v_exp_f32 v29, v29
    v_exp_f32 v30, v30
    v_exp_f32 v31, v31
    v_mfma_f32_32x32x16_bf16 v[0:15], a[200:203], a[70:73], 0
    v_exp_f32 v32, v32
    v_exp_f32 v33, v33
    v_exp_f32 v34, v34
    v_exp_f32 v35, v35
    v_mfma_f32_32x32x8_bf16 v[0:15], a[204:205], a[74:75], v[0:15]
    v_exp_f32 v36, v36
    v_exp_f32 v37, v37
    v_exp_f32 v38, v38
    v_exp_f32 v39, v39
    v_smfmac_f32_32x32x32_bf16 a[48:63], a[248:251], v[16:23], v63
    global_load_dwordx4 a[242:245], v48, s[64:65] offset:-512 sc1
    v_exp_f32 v40, v40
    v_exp_f32 v41, v41
    v_exp_f32 v42, v42
    v_exp_f32 v43, v43
    v_smfmac_f32_32x32x32_bf16 a[48:63], a[252:255], v[24:31], v63
    global_load_dwordx2 a[246:247], v50, s[64:65] offset:-512 sc1
    v_exp_f32 v44, v44
    v_exp_f32 v45, v45
    v_exp_f32 v46, v46
    v_exp_f32 v47, v47
    v_mfma_f32_32x32x16_bf16 v[16:31], a[200:203], a[76:79], 0
    v_exp_f32 v0, v0
    v_exp_f32 v1, v1
    v_exp_f32 v2, v2
    v_exp_f32 v3, v3
    v_mfma_f32_32x32x8_bf16 v[16:31], a[204:205], a[80:81], v[16:31]
    v_exp_f32 v4, v4
    v_exp_f32 v5, v5
    v_exp_f32 v6, v6
    v_exp_f32 v7, v7
    v_smfmac_f32_32x32x32_bf16 a[0:15], a[206:209], v[32:39], v63
    global_load_dwordx4 a[248:251], v52, s[66:67] offset:1792 sc1
    v_exp_f32 v8, v8
    v_exp_f32 v9, v9
    v_exp_f32 v10, v10
    v_exp_f32 v11, v11
    v_smfmac_f32_32x32x32_bf16 a[0:15], a[210:213], v[40:47], v63
    global_load_dwordx4 a[252:255], v52, s[66:67] offset:1920 sc1
    v_exp_f32 v12, v12
    v_exp_f32 v13, v13
    v_exp_f32 v14, v14
    v_exp_f32 v15, v15
    v_mfma_f32_32x32x16_bf16 v[32:47], a[200:203], a[82:85], 0
    global_load_dwordx4 a[100:103], v53, s[70:71] offset:-1024 sc1
    v_exp_f32 v16, v16
    v_exp_f32 v17, v17
    v_exp_f32 v18, v18
    v_exp_f32 v19, v19
    v_mfma_f32_32x32x8_bf16 v[32:47], a[204:205], a[86:87], v[32:47]
    v_exp_f32 v20, v20
    v_exp_f32 v21, v21
    v_exp_f32 v22, v22
    v_exp_f32 v23, v23
    v_smfmac_f32_32x32x32_bf16 a[16:31], a[206:209], v[0:7], v63
    global_load_dwordx4 a[104:107], v53, s[70:71] offset:0 sc1
    s_add_u32 s72, s75, 4096
    v_exp_f32 v24, v24
    v_exp_f32 v25, v25
    v_exp_f32 v26, v26
    v_exp_f32 v27, v27
    v_smfmac_f32_32x32x32_bf16 a[16:31], a[210:213], v[8:15], v63
    s_waitcnt vmcnt(20)
    s_add_u32 s72, s24, s72
    s_addc_u32 s73, s25, 0
    global_load_dwordx4 a[108:111], v54, s[72:73] offset:-4096 sc1
    v_exp_f32 v28, v28
    v_exp_f32 v29, v29
    v_exp_f32 v30, v30
    v_exp_f32 v31, v31
    v_mfma_f32_32x32x16_bf16 v[0:15], a[214:217], a[64:67], 0
    global_load_dwordx4 a[112:115], v55, s[72:73] offset:-4096 sc1
    v_exp_f32 v32, v32
    v_exp_f32 v33, v33
    v_exp_f32 v34, v34
    v_exp_f32 v35, v35
    v_mfma_f32_32x32x8_bf16 v[0:15], a[218:219], a[68:69], v[0:15]
    v_exp_f32 v36, v36
    v_exp_f32 v37, v37
    v_exp_f32 v38, v38
    v_exp_f32 v39, v39
    v_smfmac_f32_32x32x32_bf16 a[32:47], a[206:209], v[16:23], v63
    global_load_dwordx4 a[116:119], v56, s[72:73] offset:-4096 sc1
    v_exp_f32 v40, v40
    v_exp_f32 v41, v41
    v_exp_f32 v42, v42
    v_exp_f32 v43, v43
    v_smfmac_f32_32x32x32_bf16 a[32:47], a[210:213], v[24:31], v63
    global_load_dwordx4 a[120:123], v57, s[72:73] offset:-4096 sc1
    v_exp_f32 v44, v44
    v_exp_f32 v45, v45
    v_exp_f32 v46, v46
    v_exp_f32 v47, v47
    v_mfma_f32_32x32x16_bf16 v[16:31], a[214:217], a[70:73], 0
    v_exp_f32 v0, v0
    v_exp_f32 v1, v1
    v_exp_f32 v2, v2
    v_exp_f32 v3, v3
    v_mfma_f32_32x32x8_bf16 v[16:31], a[218:219], a[74:75], v[16:31]
    v_exp_f32 v4, v4
    v_exp_f32 v5, v5
    v_exp_f32 v6, v6
    v_exp_f32 v7, v7
    v_smfmac_f32_32x32x32_bf16 a[48:63], a[206:209], v[32:39], v63
    global_load_dwordx4 a[200:203], v48, s[64:65] offset:0 sc1
    v_exp_f32 v8, v8
    v_exp_f32 v9, v9
    v_exp_f32 v10, v10
    v_exp_f32 v11, v11
    v_smfmac_f32_32x32x32_bf16 a[48:63], a[210:213], v[40:47], v63
    global_load_dwordx2 a[204:205], v50, s[64:65] offset:0 sc1
    v_exp_f32 v12, v12
    v_exp_f32 v13, v13
    v_exp_f32 v14, v14
    v_exp_f32 v15, v15
    v_mfma_f32_32x32x16_bf16 v[32:47], a[214:217], a[76:79], 0
    v_exp_f32 v16, v16
    v_exp_f32 v17, v17
    v_exp_f32 v18, v18
    v_exp_f32 v19, v19
    v_mfma_f32_32x32x8_bf16 v[32:47], a[218:219], a[80:81], v[32:47]
    v_exp_f32 v20, v20
    v_exp_f32 v21, v21
    v_exp_f32 v22, v22
    v_exp_f32 v23, v23
    v_smfmac_f32_32x32x32_bf16 a[0:15], a[220:223], v[0:7], v63
    global_load_dwordx4 a[206:209], v52, s[66:67] offset:2048 sc1
    v_exp_f32 v24, v24
    v_exp_f32 v25, v25
    v_exp_f32 v26, v26
    v_exp_f32 v27, v27
    v_smfmac_f32_32x32x32_bf16 a[0:15], a[224:227], v[8:15], v63
    global_load_dwordx4 a[210:213], v52, s[66:67] offset:2176 sc1
    v_exp_f32 v28, v28
    v_exp_f32 v29, v29
    v_exp_f32 v30, v30
    v_exp_f32 v31, v31
    v_mfma_f32_32x32x16_bf16 v[0:15], a[214:217], a[82:85], 0
    global_load_dwordx4 a[124:127], v53, s[70:71] offset:1024 sc1
    v_exp_f32 v32, v32
    v_exp_f32 v33, v33
    v_exp_f32 v34, v34
    v_exp_f32 v35, v35
    v_mfma_f32_32x32x8_bf16 v[0:15], a[218:219], a[86:87], v[0:15]
    v_exp_f32 v36, v36
    v_exp_f32 v37, v37
    v_exp_f32 v38, v38
    v_exp_f32 v39, v39
    v_smfmac_f32_32x32x32_bf16 a[16:31], a[220:223], v[16:23], v63
    global_load_dwordx4 a[128:131], v53, s[70:71] offset:2048 sc1
    v_exp_f32 v40, v40
    v_exp_f32 v41, v41
    v_exp_f32 v42, v42
    v_exp_f32 v43, v43
    v_smfmac_f32_32x32x32_bf16 a[16:31], a[224:227], v[24:31], v63
    s_waitcnt vmcnt(21)
    global_load_dwordx4 a[132:135], v53, s[70:71] offset:3072 sc1
    v_exp_f32 v44, v44
    v_exp_f32 v45, v45
    v_exp_f32 v46, v46
    v_exp_f32 v47, v47
    v_mfma_f32_32x32x16_bf16 v[16:31], a[228:231], a[64:67], 0
    s_add_u32 s70, s74, 12288
    v_exp_f32 v0, v0
    v_exp_f32 v1, v1
    v_exp_f32 v2, v2
    v_exp_f32 v3, v3
    v_mfma_f32_32x32x8_bf16 v[16:31], a[232:233], a[68:69], v[16:31]
    v_exp_f32 v4, v4
    v_exp_f32 v5, v5
    v_exp_f32 v6, v6
    v_exp_f32 v7, v7
    v_smfmac_f32_32x32x32_bf16 a[32:47], a[220:223], v[32:39], v63
    s_add_u32 s70, s24, s70
    s_addc_u32 s71, s25, 0
    global_load_dwordx4 a[136:139], v53, s[70:71] offset:-4096 sc1
    v_exp_f32 v8, v8
    v_exp_f32 v9, v9
    v_exp_f32 v10, v10
    v_exp_f32 v11, v11
    v_smfmac_f32_32x32x32_bf16 a[32:47], a[224:227], v[40:47], v63
    global_load_dwordx4 a[140:143], v53, s[70:71] offset:-3072 sc1
    v_exp_f32 v12, v12
    v_exp_f32 v13, v13
    v_exp_f32 v14, v14
    v_exp_f32 v15, v15
    v_mfma_f32_32x32x16_bf16 v[32:47], a[228:231], a[70:73], 0
    v_exp_f32 v16, v16
    v_exp_f32 v17, v17
    v_exp_f32 v18, v18
    v_exp_f32 v19, v19
    v_mfma_f32_32x32x8_bf16 v[32:47], a[232:233], a[74:75], v[32:47]
    v_exp_f32 v20, v20
    v_exp_f32 v21, v21
    v_exp_f32 v22, v22
    v_exp_f32 v23, v23
    v_smfmac_f32_32x32x32_bf16 a[48:63], a[220:223], v[0:7], v63
    global_load_dwordx4 a[214:217], v48, s[64:65] offset:512 sc1
    v_exp_f32 v24, v24
    v_exp_f32 v25, v25
    v_exp_f32 v26, v26
    v_exp_f32 v27, v27
    v_smfmac_f32_32x32x32_bf16 a[48:63], a[224:227], v[8:15], v63
    global_load_dwordx2 a[218:219], v50, s[64:65] offset:512 sc1
    v_exp_f32 v28, v28
    v_exp_f32 v29, v29
    v_exp_f32 v30, v30
    v_exp_f32 v31, v31
    v_mfma_f32_32x32x16_bf16 v[0:15], a[228:231], a[76:79], 0
    v_exp_f32 v32, v32
    v_exp_f32 v33, v33
    v_exp_f32 v34, v34
    v_exp_f32 v35, v35
    v_mfma_f32_32x32x8_bf16 v[0:15], a[232:233], a[80:81], v[0:15]
    v_exp_f32 v36, v36
    v_exp_f32 v37, v37
    v_exp_f32 v38, v38
    v_exp_f32 v39, v39
    v_smfmac_f32_32x32x32_bf16 a[0:15], a[234:237], v[16:23], v63
    global_load_dwordx4 a[220:223], v52, s[66:67] offset:2304 sc1
    v_exp_f32 v40, v40
    v_exp_f32 v41, v41
    v_exp_f32 v42, v42
    v_exp_f32 v43, v43
    v_smfmac_f32_32x32x32_bf16 a[0:15], a[238:241], v[24:31], v63
    global_load_dwordx4 a[224:227], v52, s[66:67] offset:2432 sc1
    v_exp_f32 v44, v44
    v_exp_f32 v45, v45
    v_exp_f32 v46, v46
    v_exp_f32 v47, v47
    v_mfma_f32_32x32x16_bf16 v[16:31], a[228:231], a[82:85], 0
    global_load_dwordx4 a[144:147], v54, s[72:73] offset:-3072 sc1
    v_exp_f32 v0, v0
    v_exp_f32 v1, v1
    v_exp_f32 v2, v2
    v_exp_f32 v3, v3
    v_mfma_f32_32x32x8_bf16 v[16:31], a[232:233], a[86:87], v[16:31]
    v_exp_f32 v4, v4
    v_exp_f32 v5, v5
    v_exp_f32 v6, v6
    v_exp_f32 v7, v7
    v_smfmac_f32_32x32x32_bf16 a[16:31], a[234:237], v[32:39], v63
    global_load_dwordx4 a[148:151], v55, s[72:73] offset:-3072 sc1
    v_exp_f32 v8, v8
    v_exp_f32 v9, v9
    v_exp_f32 v10, v10
    v_exp_f32 v11, v11
    v_smfmac_f32_32x32x32_bf16 a[16:31], a[238:241], v[40:47], v63
    s_waitcnt vmcnt(21)
    global_load_dwordx4 a[152:155], v56, s[72:73] offset:-3072 sc1
    v_exp_f32 v12, v12
    v_exp_f32 v13, v13
    v_exp_f32 v14, v14
    v_exp_f32 v15, v15
    v_mfma_f32_32x32x16_bf16 v[32:47], a[242:245], a[64:67], 0
    global_load_dwordx4 a[156:159], v57, s[72:73] offset:-3072 sc1
    v_exp_f32 v16, v16
    v_exp_f32 v17, v17
    v_exp_f32 v18, v18
    v_exp_f32 v19, v19
    v_mfma_f32_32x32x8_bf16 v[32:47], a[246:247], a[68:69], v[32:47]
    v_exp_f32 v20, v20
    v_exp_f32 v21, v21
    v_exp_f32 v22, v22
    v_exp_f32 v23, v23
    v_smfmac_f32_32x32x32_bf16 a[32:47], a[234:237], v[0:7], v63
    global_load_dwordx4 a[160:163], v53, s[70:71] offset:-2048 sc1
    v_exp_f32 v24, v24
    v_exp_f32 v25, v25
    v_exp_f32 v26, v26
    v_exp_f32 v27, v27
    v_smfmac_f32_32x32x32_bf16 a[32:47], a[238:241], v[8:15], v63
    global_load_dwordx4 a[164:167], v53, s[70:71] offset:-1024 sc1
    v_exp_f32 v28, v28
    v_exp_f32 v29, v29
    v_exp_f32 v30, v30
    v_exp_f32 v31, v31
    v_mfma_f32_32x32x16_bf16 v[0:15], a[242:245], a[70:73], 0
    v_exp_f32 v32, v32
    v_exp_f32 v33, v33
    v_exp_f32 v34, v34
    v_exp_f32 v35, v35
    v_mfma_f32_32x32x8_bf16 v[0:15], a[246:247], a[74:75], v[0:15]
    v_exp_f32 v36, v36
    v_exp_f32 v37, v37
    v_exp_f32 v38, v38
    v_exp_f32 v39, v39
    v_smfmac_f32_32x32x32_bf16 a[48:63], a[234:237], v[16:23], v63
    global_load_dwordx4 a[228:231], v48, s[64:65] offset:1024 sc1
    v_exp_f32 v40, v40
    v_exp_f32 v41, v41
    v_exp_f32 v42, v42
    v_exp_f32 v43, v43
    v_smfmac_f32_32x32x32_bf16 a[48:63], a[238:241], v[24:31], v63
    global_load_dwordx2 a[232:233], v50, s[64:65] offset:1024 sc1
    v_exp_f32 v44, v44
    v_exp_f32 v45, v45
    v_exp_f32 v46, v46
    v_exp_f32 v47, v47
    v_mfma_f32_32x32x16_bf16 v[16:31], a[242:245], a[76:79], 0
    v_exp_f32 v0, v0
    v_exp_f32 v1, v1
    v_exp_f32 v2, v2
    v_exp_f32 v3, v3
    v_mfma_f32_32x32x8_bf16 v[16:31], a[246:247], a[80:81], v[16:31]
    v_exp_f32 v4, v4
    v_exp_f32 v5, v5
    v_exp_f32 v6, v6
    v_exp_f32 v7, v7
    v_smfmac_f32_32x32x32_bf16 a[0:15], a[248:251], v[32:39], v63
    global_load_dwordx4 a[234:237], v52, s[66:67] offset:2560 sc1
    v_exp_f32 v8, v8
    v_exp_f32 v9, v9
    v_exp_f32 v10, v10
    v_exp_f32 v11, v11
    v_smfmac_f32_32x32x32_bf16 a[0:15], a[252:255], v[40:47], v63
    global_load_dwordx4 a[238:241], v52, s[66:67] offset:2688 sc1
    v_exp_f32 v12, v12
    v_exp_f32 v13, v13
    v_exp_f32 v14, v14
    v_exp_f32 v15, v15
    v_mfma_f32_32x32x16_bf16 v[32:47], a[242:245], a[82:85], 0
    global_load_dwordx4 a[168:171], v53, s[70:71] offset:0 sc1
    v_exp_f32 v16, v16
    v_exp_f32 v17, v17
    v_exp_f32 v18, v18
    v_exp_f32 v19, v19
    v_mfma_f32_32x32x8_bf16 v[32:47], a[246:247], a[86:87], v[32:47]
    v_exp_f32 v20, v20
    v_exp_f32 v21, v21
    v_exp_f32 v22, v22
    v_exp_f32 v23, v23
    v_smfmac_f32_32x32x32_bf16 a[16:31], a[248:251], v[0:7], v63
    global_load_dwordx4 a[172:175], v53, s[70:71] offset:1024 sc1
    v_exp_f32 v24, v24
    v_exp_f32 v25, v25
    v_exp_f32 v26, v26
    v_exp_f32 v27, v27
    v_smfmac_f32_32x32x32_bf16 a[16:31], a[252:255], v[8:15], v63
    s_waitcnt vmcnt(21)
    global_load_dwordx4 a[176:179], v53, s[70:71] offset:2048 sc1
    v_exp_f32 v28, v28
    v_exp_f32 v29, v29
    v_exp_f32 v30, v30
    v_exp_f32 v31, v31
    v_mfma_f32_32x32x16_bf16 v[0:15], a[200:203], a[64:67], 0
    v_exp_f32 v32, v32
    v_exp_f32 v33, v33
    v_exp_f32 v34, v34
    v_exp_f32 v35, v35
    v_mfma_f32_32x32x8_bf16 v[0:15], a[204:205], a[68:69], v[0:15]
    v_exp_f32 v36, v36
    v_exp_f32 v37, v37
    v_exp_f32 v38, v38
    v_exp_f32 v39, v39
    v_smfmac_f32_32x32x32_bf16 a[32:47], a[248:251], v[16:23], v63
    global_load_dwordx4 a[180:183], v54, s[72:73] offset:-2048 sc1
    v_exp_f32 v40, v40
    v_exp_f32 v41, v41
    v_exp_f32 v42, v42
    v_exp_f32 v43, v43
    v_smfmac_f32_32x32x32_bf16 a[32:47], a[252:255], v[24:31], v63
    global_load_dwordx4 a[184:187], v55, s[72:73] offset:-2048 sc1
    v_exp_f32 v44, v44
    v_exp_f32 v45, v45
    v_exp_f32 v46, v46
    v_exp_f32 v47, v47
    v_mfma_f32_32x32x16_bf16 v[16:31], a[200:203], a[70:73], 0
    v_exp_f32 v0, v0
    v_exp_f32 v1, v1
    v_exp_f32 v2, v2
    v_exp_f32 v3, v3
    v_mfma_f32_32x32x8_bf16 v[16:31], a[204:205], a[74:75], v[16:31]
    v_exp_f32 v4, v4
    v_exp_f32 v5, v5
    v_exp_f32 v6, v6
    v_exp_f32 v7, v7
    v_smfmac_f32_32x32x32_bf16 a[48:63], a[248:251], v[32:39], v63
    global_load_dwordx4 a[242:245], v48, s[64:65] offset:1536 sc1
    v_exp_f32 v8, v8
    v_exp_f32 v9, v9
    v_exp_f32 v10, v10
    v_exp_f32 v11, v11
    v_smfmac_f32_32x32x32_bf16 a[48:63], a[252:255], v[40:47], v63
    global_load_dwordx2 a[246:247], v50, s[64:65] offset:1536 sc1
    v_exp_f32 v12, v12
    v_exp_f32 v13, v13
    v_exp_f32 v14, v14
    v_exp_f32 v15, v15
    v_mfma_f32_32x32x16_bf16 v[32:47], a[200:203], a[76:79], 0
    v_exp_f32 v16, v16
    v_exp_f32 v17, v17
    v_exp_f32 v18, v18
    v_exp_f32 v19, v19
    v_mfma_f32_32x32x8_bf16 v[32:47], a[204:205], a[80:81], v[32:47]
    v_exp_f32 v20, v20
    v_exp_f32 v21, v21
    v_exp_f32 v22, v22
    v_exp_f32 v23, v23
    v_smfmac_f32_32x32x32_bf16 a[0:15], a[206:209], v[0:7], v63
    global_load_dwordx4 a[248:251], v52, s[66:67] offset:2816 sc1
    v_exp_f32 v24, v24
    v_exp_f32 v25, v25
    v_exp_f32 v26, v26
    v_exp_f32 v27, v27
    v_smfmac_f32_32x32x32_bf16 a[0:15], a[210:213], v[8:15], v63
    global_load_dwordx4 a[252:255], v52, s[66:67] offset:2944 sc1
    v_exp_f32 v28, v28
    v_exp_f32 v29, v29
    v_exp_f32 v30, v30
    v_exp_f32 v31, v31
    v_mfma_f32_32x32x16_bf16 v[0:15], a[200:203], a[82:85], 0
    global_load_dwordx4 a[188:191], v56, s[72:73] offset:-2048 sc1
    v_exp_f32 v32, v32
    v_exp_f32 v33, v33
    v_exp_f32 v34, v34
    v_exp_f32 v35, v35
    v_mfma_f32_32x32x8_bf16 v[0:15], a[204:205], a[86:87], v[0:15]
    v_exp_f32 v36, v36
    v_exp_f32 v37, v37
    v_exp_f32 v38, v38
    v_exp_f32 v39, v39
    v_smfmac_f32_32x32x32_bf16 a[16:31], a[206:209], v[16:23], v63
    global_load_dwordx4 a[192:195], v57, s[72:73] offset:-2048 sc1
    v_exp_f32 v40, v40
    v_exp_f32 v41, v41
    v_exp_f32 v42, v42
    v_exp_f32 v43, v43
    v_smfmac_f32_32x32x32_bf16 a[16:31], a[210:213], v[24:31], v63
    s_waitcnt vmcnt(21)
    global_load_dwordx4 a[196:199], v53, s[70:71] offset:3072 sc1
    v_exp_f32 v44, v44
    v_exp_f32 v45, v45
    v_exp_f32 v46, v46
    v_exp_f32 v47, v47
    v_mfma_f32_32x32x16_bf16 v[16:31], a[214:217], a[64:67], 0
    s_add_u32 s70, s74, 20480
    v_exp_f32 v0, v0
    v_exp_f32 v1, v1
    v_exp_f32 v2, v2
    v_exp_f32 v3, v3
    v_mfma_f32_32x32x8_bf16 v[16:31], a[218:219], a[68:69], v[16:31]
    v_exp_f32 v4, v4
    v_exp_f32 v5, v5
    v_exp_f32 v6, v6
    v_exp_f32 v7, v7
    v_smfmac_f32_32x32x32_bf16 a[32:47], a[206:209], v[32:39], v63
    s_add_u32 s70, s24, s70
    s_addc_u32 s71, s25, 0
    global_load_dwordx4 v[64:67], v53, s[70:71] offset:-4096 sc1
    v_exp_f32 v8, v8
    v_exp_f32 v9, v9
    v_exp_f32 v10, v10
    v_exp_f32 v11, v11
    v_smfmac_f32_32x32x32_bf16 a[32:47], a[210:213], v[40:47], v63
    global_load_dwordx4 v[68:71], v53, s[70:71] offset:-3072 sc1
    v_exp_f32 v12, v12
    v_exp_f32 v13, v13
    v_exp_f32 v14, v14
    v_exp_f32 v15, v15
    v_mfma_f32_32x32x16_bf16 v[32:47], a[214:217], a[70:73], 0
    v_exp_f32 v16, v16
    v_exp_f32 v17, v17
    v_exp_f32 v18, v18
    v_exp_f32 v19, v19
    v_mfma_f32_32x32x8_bf16 v[32:47], a[218:219], a[74:75], v[32:47]
    v_exp_f32 v20, v20
    v_exp_f32 v21, v21
    v_exp_f32 v22, v22
    v_exp_f32 v23, v23
    v_smfmac_f32_32x32x32_bf16 a[48:63], a[206:209], v[0:7], v63
    global_load_dwordx4 a[200:203], v48, s[64:65] offset:2048 sc1
    v_exp_f32 v24, v24
    v_exp_f32 v25, v25
    v_exp_f32 v26, v26
    v_exp_f32 v27, v27
    v_smfmac_f32_32x32x32_bf16 a[48:63], a[210:213], v[8:15], v63
    global_load_dwordx2 a[204:205], v50, s[64:65] offset:2048 sc1
    v_exp_f32 v28, v28
    v_exp_f32 v29, v29
    v_exp_f32 v30, v30
    v_exp_f32 v31, v31
    v_mfma_f32_32x32x16_bf16 v[0:15], a[214:217], a[76:79], 0
    v_exp_f32 v32, v32
    v_exp_f32 v33, v33
    v_exp_f32 v34, v34
    v_exp_f32 v35, v35
    v_mfma_f32_32x32x8_bf16 v[0:15], a[218:219], a[80:81], v[0:15]
    v_exp_f32 v36, v36
    v_exp_f32 v37, v37
    v_exp_f32 v38, v38
    v_exp_f32 v39, v39
    v_smfmac_f32_32x32x32_bf16 a[0:15], a[220:223], v[16:23], v63
    global_load_dwordx4 a[206:209], v52, s[66:67] offset:3072 sc1
    v_exp_f32 v40, v40
    v_exp_f32 v41, v41
    v_exp_f32 v42, v42
    v_exp_f32 v43, v43
    v_smfmac_f32_32x32x32_bf16 a[0:15], a[224:227], v[24:31], v63
    global_load_dwordx4 a[210:213], v52, s[66:67] offset:3200 sc1
    v_exp_f32 v44, v44
    v_exp_f32 v45, v45
    v_exp_f32 v46, v46
    v_exp_f32 v47, v47
    v_mfma_f32_32x32x16_bf16 v[16:31], a[214:217], a[82:85], 0
    global_load_dwordx4 v[72:75], v53, s[70:71] offset:-2048 sc1
    v_exp_f32 v0, v0
    v_exp_f32 v1, v1
    v_exp_f32 v2, v2
    v_exp_f32 v3, v3
    v_mfma_f32_32x32x8_bf16 v[16:31], a[218:219], a[86:87], v[16:31]
    v_exp_f32 v4, v4
    v_exp_f32 v5, v5
    v_exp_f32 v6, v6
    v_exp_f32 v7, v7
    v_smfmac_f32_32x32x32_bf16 a[16:31], a[220:223], v[32:39], v63
    global_load_dwordx4 v[76:79], v53, s[70:71] offset:-1024 sc1
    v_exp_f32 v8, v8
    v_exp_f32 v9, v9
    v_exp_f32 v10, v10
    v_exp_f32 v11, v11
    v_smfmac_f32_32x32x32_bf16 a[16:31], a[224:227], v[40:47], v63
    s_waitcnt vmcnt(20)
    global_load_dwordx4 v[80:83], v54, s[72:73] offset:-1024 sc1
    v_exp_f32 v12, v12
    v_exp_f32 v13, v13
    v_exp_f32 v14, v14
    v_exp_f32 v15, v15
    v_mfma_f32_32x32x16_bf16 v[32:47], a[228:231], a[64:67], 0
    global_load_dwordx4 v[84:87], v55, s[72:73] offset:-1024 sc1
    v_exp_f32 v16, v16
    v_exp_f32 v17, v17
    v_exp_f32 v18, v18
    v_exp_f32 v19, v19
    v_mfma_f32_32x32x8_bf16 v[32:47], a[232:233], a[68:69], v[32:47]
    v_exp_f32 v20, v20
    v_exp_f32 v21, v21
    v_exp_f32 v22, v22
    v_exp_f32 v23, v23
    v_smfmac_f32_32x32x32_bf16 a[32:47], a[220:223], v[0:7], v63
    global_load_dwordx4 v[88:91], v56, s[72:73] offset:-1024 sc1
    v_exp_f32 v24, v24
    v_exp_f32 v25, v25
    v_exp_f32 v26, v26
    v_exp_f32 v27, v27
    v_smfmac_f32_32x32x32_bf16 a[32:47], a[224:227], v[8:15], v63
    global_load_dwordx4 v[92:95], v57, s[72:73] offset:-1024 sc1
    v_exp_f32 v28, v28
    v_exp_f32 v29, v29
    v_exp_f32 v30, v30
    v_exp_f32 v31, v31
    v_mfma_f32_32x32x16_bf16 v[0:15], a[228:231], a[70:73], 0
    v_exp_f32 v32, v32
    v_exp_f32 v33, v33
    v_exp_f32 v34, v34
    v_exp_f32 v35, v35
    v_mfma_f32_32x32x8_bf16 v[0:15], a[232:233], a[74:75], v[0:15]
    v_exp_f32 v36, v36
    v_exp_f32 v37, v37
    v_exp_f32 v38, v38
    v_exp_f32 v39, v39
    v_smfmac_f32_32x32x32_bf16 a[48:63], a[220:223], v[16:23], v63
    global_load_dwordx4 a[214:217], v48, s[64:65] offset:2560 sc1
    v_exp_f32 v40, v40
    v_exp_f32 v41, v41
    v_exp_f32 v42, v42
    v_exp_f32 v43, v43
    v_smfmac_f32_32x32x32_bf16 a[48:63], a[224:227], v[24:31], v63
    global_load_dwordx2 a[218:219], v50, s[64:65] offset:2560 sc1
    v_exp_f32 v44, v44
    v_exp_f32 v45, v45
    v_exp_f32 v46, v46
    v_exp_f32 v47, v47
    v_mfma_f32_32x32x16_bf16 v[16:31], a[228:231], a[76:79], 0
    v_exp_f32 v0, v0
    v_exp_f32 v1, v1
    v_exp_f32 v2, v2
    v_exp_f32 v3, v3
    v_mfma_f32_32x32x8_bf16 v[16:31], a[232:233], a[80:81], v[16:31]
    v_exp_f32 v4, v4
    v_exp_f32 v5, v5
    v_exp_f32 v6, v6
    v_exp_f32 v7, v7
    v_smfmac_f32_32x32x32_bf16 a[0:15], a[234:237], v[32:39], v63
    global_load_dwordx4 a[220:223], v52, s[66:67] offset:3328 sc1
    v_exp_f32 v8, v8
    v_exp_f32 v9, v9
    v_exp_f32 v10, v10
    v_exp_f32 v11, v11
    v_smfmac_f32_32x32x32_bf16 a[0:15], a[238:241], v[40:47], v63
    global_load_dwordx4 a[224:227], v52, s[66:67] offset:3456 sc1
    v_exp_f32 v12, v12
    v_exp_f32 v13, v13
    v_exp_f32 v14, v14
    v_exp_f32 v15, v15
    v_mfma_f32_32x32x16_bf16 v[32:47], a[228:231], a[82:85], 0
    global_load_dwordx4 v[96:99], v53, s[70:71] offset:0 sc1
    v_exp_f32 v16, v16
    v_exp_f32 v17, v17
    v_exp_f32 v18, v18
    v_exp_f32 v19, v19
    v_mfma_f32_32x32x8_bf16 v[32:47], a[232:233], a[86:87], v[32:47]
    v_exp_f32 v20, v20
    v_exp_f32 v21, v21
    v_exp_f32 v22, v22
    v_exp_f32 v23, v23
    v_smfmac_f32_32x32x32_bf16 a[16:31], a[234:237], v[0:7], v63
    global_load_dwordx4 v[100:103], v53, s[70:71] offset:1024 sc1
    v_exp_f32 v24, v24
    v_exp_f32 v25, v25
    v_exp_f32 v26, v26
    v_exp_f32 v27, v27
    v_smfmac_f32_32x32x32_bf16 a[16:31], a[238:241], v[8:15], v63
    s_waitcnt vmcnt(21)
    global_load_dwordx4 v[104:107], v53, s[70:71] offset:2048 sc1
    v_exp_f32 v28, v28
    v_exp_f32 v29, v29
    v_exp_f32 v30, v30
    v_exp_f32 v31, v31
    v_mfma_f32_32x32x16_bf16 v[0:15], a[242:245], a[64:67], 0
    v_exp_f32 v32, v32
    v_exp_f32 v33, v33
    v_exp_f32 v34, v34
    v_exp_f32 v35, v35
    v_mfma_f32_32x32x8_bf16 v[0:15], a[246:247], a[68:69], v[0:15]
    v_exp_f32 v36, v36
    v_exp_f32 v37, v37
    v_exp_f32 v38, v38
    v_exp_f32 v39, v39
    v_smfmac_f32_32x32x32_bf16 a[32:47], a[234:237], v[16:23], v63
    global_load_dwordx4 v[108:111], v53, s[70:71] offset:3072 sc1
    s_add_u32 s70, s74, 28672
    v_exp_f32 v40, v40
    v_exp_f32 v41, v41
    v_exp_f32 v42, v42
    v_exp_f32 v43, v43
    v_smfmac_f32_32x32x32_bf16 a[32:47], a[238:241], v[24:31], v63
    s_add_u32 s70, s24, s70
    s_addc_u32 s71, s25, 0
    global_load_dwordx4 v[112:115], v53, s[70:71] offset:-4096 sc1
    v_exp_f32 v44, v44
    v_exp_f32 v45, v45
    v_exp_f32 v46, v46
    v_exp_f32 v47, v47
    v_mfma_f32_32x32x16_bf16 v[16:31], a[242:245], a[70:73], 0
    v_exp_f32 v0, v0
    v_exp_f32 v1, v1
    v_exp_f32 v2, v2
    v_exp_f32 v3, v3
    v_mfma_f32_32x32x8_bf16 v[16:31], a[246:247], a[74:75], v[16:31]
    v_exp_f32 v4, v4
    v_exp_f32 v5, v5
    v_exp_f32 v6, v6
    v_exp_f32 v7, v7
    v_smfmac_f32_32x32x32_bf16 a[48:63], a[234:237], v[32:39], v63
    global_load_dwordx4 a[228:231], v48, s[64:65] offset:3072 sc1
    v_exp_f32 v8, v8
    v_exp_f32 v9, v9
    v_exp_f32 v10, v10
    v_exp_f32 v11, v11
    v_smfmac_f32_32x32x32_bf16 a[48:63], a[238:241], v[40:47], v63
    global_load_dwordx2 a[232:233], v50, s[64:65] offset:3072 sc1
    v_exp_f32 v12, v12
    v_exp_f32 v13, v13
    v_exp_f32 v14, v14
    v_exp_f32 v15, v15
    v_mfma_f32_32x32x16_bf16 v[32:47], a[242:245], a[76:79], 0
    v_exp_f32 v16, v16
    v_exp_f32 v17, v17
    v_exp_f32 v18, v18
    v_exp_f32 v19, v19
    v_mfma_f32_32x32x8_bf16 v[32:47], a[246:247], a[80:81], v[32:47]
    v_exp_f32 v20, v20
    v_exp_f32 v21, v21
    v_exp_f32 v22, v22
    v_exp_f32 v23, v23
    v_smfmac_f32_32x32x32_bf16 a[0:15], a[248:251], v[0:7], v63
    global_load_dwordx4 a[234:237], v52, s[66:67] offset:3584 sc1
    v_exp_f32 v24, v24
    v_exp_f32 v25, v25
    v_exp_f32 v26, v26
    v_exp_f32 v27, v27
    v_smfmac_f32_32x32x32_bf16 a[0:15], a[252:255], v[8:15], v63
    global_load_dwordx4 a[238:241], v52, s[66:67] offset:3712 sc1
    v_exp_f32 v28, v28
    v_exp_f32 v29, v29
    v_exp_f32 v30, v30
    v_exp_f32 v31, v31
    v_mfma_f32_32x32x16_bf16 v[0:15], a[242:245], a[82:85], 0
    global_load_dwordx4 v[116:119], v54, s[72:73] offset:0 sc1
    v_exp_f32 v32, v32
    v_exp_f32 v33, v33
    v_exp_f32 v34, v34
    v_exp_f32 v35, v35
    v_mfma_f32_32x32x8_bf16 v[0:15], a[246:247], a[86:87], v[0:15]
    v_exp_f32 v36, v36
    v_exp_f32 v37, v37
    v_exp_f32 v38, v38
    v_exp_f32 v39, v39
    v_smfmac_f32_32x32x32_bf16 a[16:31], a[248:251], v[16:23], v63
    global_load_dwordx4 v[120:123], v55, s[72:73] offset:0 sc1
    v_exp_f32 v40, v40
    v_exp_f32 v41, v41
    v_exp_f32 v42, v42
    v_exp_f32 v43, v43
    v_smfmac_f32_32x32x32_bf16 a[16:31], a[252:255], v[24:31], v63
    s_waitcnt vmcnt(21)
    global_load_dwordx4 v[124:127], v56, s[72:73] offset:0 sc1
    v_exp_f32 v44, v44
    v_exp_f32 v45, v45
    v_exp_f32 v46, v46
    v_exp_f32 v47, v47
    v_mfma_f32_32x32x16_bf16 v[16:31], a[200:203], a[64:67], 0
    global_load_dwordx4 v[128:131], v57, s[72:73] offset:0 sc1
    v_exp_f32 v0, v0
    v_exp_f32 v1, v1
    v_exp_f32 v2, v2
    v_exp_f32 v3, v3
    v_mfma_f32_32x32x8_bf16 v[16:31], a[204:205], a[68:69], v[16:31]
    v_exp_f32 v4, v4
    v_exp_f32 v5, v5
    v_exp_f32 v6, v6
    v_exp_f32 v7, v7
    v_smfmac_f32_32x32x32_bf16 a[32:47], a[248:251], v[32:39], v63
    global_load_dwordx4 v[132:135], v53, s[70:71] offset:-3072 sc1
    v_exp_f32 v8, v8
    v_exp_f32 v9, v9
    v_exp_f32 v10, v10
    v_exp_f32 v11, v11
    v_smfmac_f32_32x32x32_bf16 a[32:47], a[252:255], v[40:47], v63
    global_load_dwordx4 v[136:139], v53, s[70:71] offset:-2048 sc1
    v_exp_f32 v12, v12
    v_exp_f32 v13, v13
    v_exp_f32 v14, v14
    v_exp_f32 v15, v15
    v_mfma_f32_32x32x16_bf16 v[32:47], a[200:203], a[70:73], 0
    v_exp_f32 v16, v16
    v_exp_f32 v17, v17
    v_exp_f32 v18, v18
    v_exp_f32 v19, v19
    v_mfma_f32_32x32x8_bf16 v[32:47], a[204:205], a[74:75], v[32:47]
    v_exp_f32 v20, v20
    v_exp_f32 v21, v21
    v_exp_f32 v22, v22
    v_exp_f32 v23, v23
    v_smfmac_f32_32x32x32_bf16 a[48:63], a[248:251], v[0:7], v63
    global_load_dwordx4 a[242:245], v48, s[64:65] offset:3584 sc1
    v_exp_f32 v24, v24
    v_exp_f32 v25, v25
    v_exp_f32 v26, v26
    v_exp_f32 v27, v27
    v_smfmac_f32_32x32x32_bf16 a[48:63], a[252:255], v[8:15], v63
    global_load_dwordx2 a[246:247], v50, s[64:65] offset:3584 sc1
    v_exp_f32 v28, v28
    v_exp_f32 v29, v29
    v_exp_f32 v30, v30
    v_exp_f32 v31, v31
    v_mfma_f32_32x32x16_bf16 v[0:15], a[200:203], a[76:79], 0
    v_exp_f32 v32, v32
    v_exp_f32 v33, v33
    v_exp_f32 v34, v34
    v_exp_f32 v35, v35
    v_mfma_f32_32x32x8_bf16 v[0:15], a[204:205], a[80:81], v[0:15]
    v_exp_f32 v36, v36
    v_exp_f32 v37, v37
    v_exp_f32 v38, v38
    v_exp_f32 v39, v39
    v_smfmac_f32_32x32x32_bf16 a[0:15], a[206:209], v[16:23], v63
    global_load_dwordx4 a[248:251], v52, s[66:67] offset:3840 sc1
    v_exp_f32 v40, v40
    v_exp_f32 v41, v41
    v_exp_f32 v42, v42
    v_exp_f32 v43, v43
    v_smfmac_f32_32x32x32_bf16 a[0:15], a[210:213], v[24:31], v63
    global_load_dwordx4 a[252:255], v52, s[66:67] offset:3968 sc1
    v_exp_f32 v44, v44
    v_exp_f32 v45, v45
    v_exp_f32 v46, v46
    v_exp_f32 v47, v47
    v_mfma_f32_32x32x16_bf16 v[16:31], a[200:203], a[82:85], 0
    global_load_dwordx4 v[140:143], v53, s[70:71] offset:-1024 sc1
    v_exp_f32 v0, v0
    v_exp_f32 v1, v1
    v_exp_f32 v2, v2
    v_exp_f32 v3, v3
    v_mfma_f32_32x32x8_bf16 v[16:31], a[204:205], a[86:87], v[16:31]
    v_exp_f32 v4, v4
    v_exp_f32 v5, v5
    v_exp_f32 v6, v6
    v_exp_f32 v7, v7
    v_smfmac_f32_32x32x32_bf16 a[16:31], a[206:209], v[32:39], v63
    global_load_dwordx4 v[144:147], v53, s[70:71] offset:0 sc1
    v_exp_f32 v8, v8
    v_exp_f32 v9, v9
    v_exp_f32 v10, v10
    v_exp_f32 v11, v11
    v_smfmac_f32_32x32x32_bf16 a[16:31], a[210:213], v[40:47], v63
    s_waitcnt vmcnt(21)
    global_load_dwordx4 v[148:151], v53, s[70:71] offset:1024 sc1
    v_exp_f32 v12, v12
    v_exp_f32 v13, v13
    v_exp_f32 v14, v14
    v_exp_f32 v15, v15
    v_mfma_f32_32x32x16_bf16 v[32:47], a[214:217], a[64:67], 0
    v_exp_f32 v16, v16
    v_exp_f32 v17, v17
    v_exp_f32 v18, v18
    v_exp_f32 v19, v19
    v_mfma_f32_32x32x8_bf16 v[32:47], a[218:219], a[68:69], v[32:47]
    v_exp_f32 v20, v20
    v_exp_f32 v21, v21
    v_exp_f32 v22, v22
    v_exp_f32 v23, v23
    v_smfmac_f32_32x32x32_bf16 a[32:47], a[206:209], v[0:7], v63
    global_load_dwordx4 v[152:155], v54, s[72:73] offset:1024 sc1
    v_exp_f32 v24, v24
    v_exp_f32 v25, v25
    v_exp_f32 v26, v26
    v_exp_f32 v27, v27
    v_smfmac_f32_32x32x32_bf16 a[32:47], a[210:213], v[8:15], v63
    global_load_dwordx4 v[156:159], v55, s[72:73] offset:1024 sc1
    v_exp_f32 v28, v28
    v_exp_f32 v29, v29
    v_exp_f32 v30, v30
    v_exp_f32 v31, v31
    v_mfma_f32_32x32x16_bf16 v[0:15], a[214:217], a[70:73], 0
    v_exp_f32 v32, v32
    v_exp_f32 v33, v33
    v_exp_f32 v34, v34
    v_exp_f32 v35, v35
    v_mfma_f32_32x32x8_bf16 v[0:15], a[218:219], a[74:75], v[0:15]
    v_exp_f32 v36, v36
    v_exp_f32 v37, v37
    v_exp_f32 v38, v38
    v_exp_f32 v39, v39
    v_smfmac_f32_32x32x32_bf16 a[48:63], a[206:209], v[16:23], v63
    global_load_dwordx4 v[160:163], v56, s[72:73] offset:1024 sc1
    v_exp_f32 v40, v40
    v_exp_f32 v41, v41
    v_exp_f32 v42, v42
    v_exp_f32 v43, v43
    v_smfmac_f32_32x32x32_bf16 a[48:63], a[210:213], v[24:31], v63
    global_load_dwordx4 v[164:167], v57, s[72:73] offset:1024 sc1
    v_exp_f32 v44, v44
    v_exp_f32 v45, v45
    v_exp_f32 v46, v46
    v_exp_f32 v47, v47
    v_mfma_f32_32x32x16_bf16 v[16:31], a[214:217], a[76:79], 0
    v_exp_f32 v0, v0
    v_exp_f32 v1, v1
    v_exp_f32 v2, v2
    v_exp_f32 v3, v3
    v_mfma_f32_32x32x8_bf16 v[16:31], a[218:219], a[80:81], v[16:31]
    v_exp_f32 v4, v4
    v_exp_f32 v5, v5
    v_exp_f32 v6, v6
    v_exp_f32 v7, v7
    v_smfmac_f32_32x32x32_bf16 a[0:15], a[220:223], v[32:39], v63
    global_load_dwordx4 v[168:171], v53, s[70:71] offset:2048 sc1
    v_exp_f32 v8, v8
    v_exp_f32 v9, v9
    v_exp_f32 v10, v10
    v_exp_f32 v11, v11
    v_smfmac_f32_32x32x32_bf16 a[0:15], a[224:227], v[40:47], v63
    global_load_dwordx4 v[172:175], v53, s[70:71] offset:3072 sc1
    s_add_u32 s70, s74, 36864
    v_exp_f32 v12, v12
    v_exp_f32 v13, v13
    v_exp_f32 v14, v14
    v_exp_f32 v15, v15
    v_mfma_f32_32x32x16_bf16 v[32:47], a[214:217], a[82:85], 0
    s_add_u32 s70, s24, s70
    v_exp_f32 v16, v16
    v_exp_f32 v17, v17
    v_exp_f32 v18, v18
    v_exp_f32 v19, v19
    v_mfma_f32_32x32x8_bf16 v[32:47], a[218:219], a[86:87], v[32:47]
    v_exp_f32 v20, v20
    v_exp_f32 v21, v21
    v_exp_f32 v22, v22
    v_exp_f32 v23, v23
    v_smfmac_f32_32x32x32_bf16 a[16:31], a[220:223], v[0:7], v63
    s_addc_u32 s71, s25, 0
    global_load_dwordx4 v[176:179], v53, s[70:71] offset:-4096 sc1
    v_exp_f32 v24, v24
    v_exp_f32 v25, v25
    v_exp_f32 v26, v26
    v_exp_f32 v27, v27
    v_smfmac_f32_32x32x32_bf16 a[16:31], a[224:227], v[8:15], v63
    s_waitcnt vmcnt(20)
    global_load_dwordx4 v[180:183], v53, s[70:71] offset:-3072 sc1
    v_exp_f32 v28, v28
    v_exp_f32 v29, v29
    v_exp_f32 v30, v30
    v_exp_f32 v31, v31
    v_mfma_f32_32x32x16_bf16 v[0:15], a[228:231], a[64:67], 0
    v_exp_f32 v32, v32
    v_exp_f32 v33, v33
    v_exp_f32 v34, v34
    v_exp_f32 v35, v35
    v_mfma_f32_32x32x8_bf16 v[0:15], a[232:233], a[68:69], v[0:15]
    v_exp_f32 v36, v36
    v_exp_f32 v37, v37
    v_exp_f32 v38, v38
    v_exp_f32 v39, v39
    v_smfmac_f32_32x32x32_bf16 a[32:47], a[220:223], v[16:23], v63
    global_load_dwordx4 v[184:187], v53, s[70:71] offset:-2048 sc1
    v_exp_f32 v40, v40
    v_exp_f32 v41, v41
    v_exp_f32 v42, v42
    v_exp_f32 v43, v43
    v_smfmac_f32_32x32x32_bf16 a[32:47], a[224:227], v[24:31], v63
    global_load_dwordx4 v[188:191], v54, s[72:73] offset:2048 sc1
    v_exp_f32 v44, v44
    v_exp_f32 v45, v45
    v_exp_f32 v46, v46
    v_exp_f32 v47, v47
    v_mfma_f32_32x32x16_bf16 v[16:31], a[228:231], a[70:73], 0
    v_exp_f32 v0, v0
    v_exp_f32 v1, v1
    v_exp_f32 v2, v2
    v_exp_f32 v3, v3
    v_mfma_f32_32x32x8_bf16 v[16:31], a[232:233], a[74:75], v[16:31]
    v_exp_f32 v4, v4
    v_exp_f32 v5, v5
    v_exp_f32 v6, v6
    v_exp_f32 v7, v7
    v_smfmac_f32_32x32x32_bf16 a[48:63], a[220:223], v[32:39], v63
    global_load_dwordx4 v[192:195], v55, s[72:73] offset:2048 sc1
    v_exp_f32 v8, v8
    v_exp_f32 v9, v9
    v_exp_f32 v10, v10
    v_exp_f32 v11, v11
    v_smfmac_f32_32x32x32_bf16 a[48:63], a[224:227], v[40:47], v63
    global_load_dwordx4 v[196:199], v56, s[72:73] offset:2048 sc1
    v_exp_f32 v12, v12
    v_exp_f32 v13, v13
    v_exp_f32 v14, v14
    v_exp_f32 v15, v15
    v_mfma_f32_32x32x16_bf16 v[32:47], a[228:231], a[76:79], 0
    v_exp_f32 v16, v16
    v_exp_f32 v17, v17
    v_exp_f32 v18, v18
    v_exp_f32 v19, v19
    v_mfma_f32_32x32x8_bf16 v[32:47], a[232:233], a[80:81], v[32:47]
    v_exp_f32 v20, v20
    v_exp_f32 v21, v21
    v_exp_f32 v22, v22
    v_exp_f32 v23, v23
    v_smfmac_f32_32x32x32_bf16 a[0:15], a[234:237], v[0:7], v63
    global_load_dwordx4 v[200:203], v57, s[72:73] offset:2048 sc1
    v_exp_f32 v24, v24
    v_exp_f32 v25, v25
    v_exp_f32 v26, v26
    v_exp_f32 v27, v27
    v_smfmac_f32_32x32x32_bf16 a[0:15], a[238:241], v[8:15], v63
    global_load_dwordx4 v[204:207], v53, s[70:71] offset:-1024 sc1
    v_exp_f32 v28, v28
    v_exp_f32 v29, v29
    v_exp_f32 v30, v30
    v_exp_f32 v31, v31
    v_mfma_f32_32x32x16_bf16 v[0:15], a[228:231], a[82:85], 0
    v_exp_f32 v32, v32
    v_exp_f32 v33, v33
    v_exp_f32 v34, v34
    v_exp_f32 v35, v35
    v_mfma_f32_32x32x8_bf16 v[0:15], a[232:233], a[86:87], v[0:15]
    v_exp_f32 v36, v36
    v_exp_f32 v37, v37
    v_exp_f32 v38, v38
    v_exp_f32 v39, v39
    v_smfmac_f32_32x32x32_bf16 a[16:31], a[234:237], v[16:23], v63
    global_load_dwordx4 v[208:211], v53, s[70:71] offset:0 sc1
    v_exp_f32 v40, v40
    v_exp_f32 v41, v41
    v_exp_f32 v42, v42
    v_exp_f32 v43, v43
    v_smfmac_f32_32x32x32_bf16 a[16:31], a[238:241], v[24:31], v63
    s_waitcnt vmcnt(18)
    global_load_dwordx4 v[212:215], v53, s[70:71] offset:1024 sc1
    v_exp_f32 v44, v44
    v_exp_f32 v45, v45
    v_exp_f32 v46, v46
    v_exp_f32 v47, v47
    v_mfma_f32_32x32x16_bf16 v[16:31], a[242:245], a[64:67], 0
    v_exp_f32 v0, v0
    v_exp_f32 v1, v1
    v_exp_f32 v2, v2
    v_exp_f32 v3, v3
    v_mfma_f32_32x32x8_bf16 v[16:31], a[246:247], a[68:69], v[16:31]
    v_exp_f32 v4, v4
    v_exp_f32 v5, v5
    v_exp_f32 v6, v6
    v_exp_f32 v7, v7
    v_smfmac_f32_32x32x32_bf16 a[32:47], a[234:237], v[32:39], v63
    global_load_dwordx4 v[216:219], v53, s[70:71] offset:2048 sc1
    v_exp_f32 v8, v8
    v_exp_f32 v9, v9
    v_exp_f32 v10, v10
    v_exp_f32 v11, v11
    v_smfmac_f32_32x32x32_bf16 a[32:47], a[238:241], v[40:47], v63
    global_load_dwordx4 v[220:223], v53, s[70:71] offset:3072 sc1
    v_exp_f32 v12, v12
    v_exp_f32 v13, v13
    v_exp_f32 v14, v14
    v_exp_f32 v15, v15
    v_mfma_f32_32x32x16_bf16 v[32:47], a[242:245], a[70:73], 0
    v_exp_f32 v16, v16
    v_exp_f32 v17, v17
    v_exp_f32 v18, v18
    v_exp_f32 v19, v19
    v_mfma_f32_32x32x8_bf16 v[32:47], a[246:247], a[74:75], v[32:47]
    v_exp_f32 v20, v20
    v_exp_f32 v21, v21
    v_exp_f32 v22, v22
    v_exp_f32 v23, v23
    v_smfmac_f32_32x32x32_bf16 a[48:63], a[234:237], v[0:7], v63
    global_load_dwordx4 v[224:227], v54, s[72:73] offset:3072 sc1
    v_exp_f32 v24, v24
    v_exp_f32 v25, v25
    v_exp_f32 v26, v26
    v_exp_f32 v27, v27
    v_smfmac_f32_32x32x32_bf16 a[48:63], a[238:241], v[8:15], v63
    global_load_dwordx4 v[228:231], v55, s[72:73] offset:3072 sc1
    v_exp_f32 v28, v28
    v_exp_f32 v29, v29
    v_exp_f32 v30, v30
    v_exp_f32 v31, v31
    v_mfma_f32_32x32x16_bf16 v[0:15], a[242:245], a[76:79], 0
    v_exp_f32 v32, v32
    v_exp_f32 v33, v33
    v_exp_f32 v34, v34
    v_exp_f32 v35, v35
    v_mfma_f32_32x32x8_bf16 v[0:15], a[246:247], a[80:81], v[0:15]
    v_exp_f32 v36, v36
    v_exp_f32 v37, v37
    v_exp_f32 v38, v38
    v_exp_f32 v39, v39
    v_smfmac_f32_32x32x32_bf16 a[0:15], a[248:251], v[16:23], v63
    global_load_dwordx4 v[232:235], v56, s[72:73] offset:3072 sc1
    v_exp_f32 v40, v40
    v_exp_f32 v41, v41
    v_exp_f32 v42, v42
    v_exp_f32 v43, v43
    v_smfmac_f32_32x32x32_bf16 a[0:15], a[252:255], v[24:31], v63
    global_load_dwordx4 v[236:239], v57, s[72:73] offset:3072 sc1
    s_add_u32 s70, s74, 45056
    v_exp_f32 v44, v44
    v_exp_f32 v45, v45
    v_exp_f32 v46, v46
    v_exp_f32 v47, v47
    v_mfma_f32_32x32x16_bf16 v[16:31], a[242:245], a[82:85], 0
    s_add_u32 s70, s24, s70
    v_exp_f32 v0, v0
    v_exp_f32 v1, v1
    v_exp_f32 v2, v2
    v_exp_f32 v3, v3
    v_mfma_f32_32x32x8_bf16 v[16:31], a[246:247], a[86:87], v[16:31]
    v_exp_f32 v4, v4
    v_exp_f32 v5, v5
    v_exp_f32 v6, v6
    v_exp_f32 v7, v7
    v_smfmac_f32_32x32x32_bf16 a[16:31], a[248:251], v[32:39], v63
    s_addc_u32 s71, s25, 0
    global_load_dwordx4 v[240:243], v53, s[70:71] offset:-4096 sc1
    v_exp_f32 v8, v8
    v_exp_f32 v9, v9
    v_exp_f32 v10, v10
    v_exp_f32 v11, v11
    v_smfmac_f32_32x32x32_bf16 a[16:31], a[252:255], v[40:47], v63
    global_load_dwordx4 v[244:247], v53, s[70:71] offset:-3072 sc1
    v_exp_f32 v12, v12
    v_exp_f32 v13, v13
    v_exp_f32 v14, v14
    v_exp_f32 v15, v15
    v_exp_f32 v16, v16
    v_exp_f32 v17, v17
    v_exp_f32 v18, v18
    v_exp_f32 v19, v19
    v_exp_f32 v20, v20
    v_exp_f32 v21, v21
    v_exp_f32 v22, v22
    v_exp_f32 v23, v23
    v_smfmac_f32_32x32x32_bf16 a[32:47], a[248:251], v[0:7], v63
    global_load_dwordx4 v[248:251], v53, s[70:71] offset:-2048 sc1
    v_exp_f32 v24, v24
    v_exp_f32 v25, v25
    v_exp_f32 v26, v26
    v_exp_f32 v27, v27
    v_smfmac_f32_32x32x32_bf16 a[32:47], a[252:255], v[8:15], v63
    global_load_dwordx4 v[252:255], v53, s[70:71] offset:-1024 sc1
    v_exp_f32 v28, v28
    v_exp_f32 v29, v29
    v_exp_f32 v30, v30
    v_exp_f32 v31, v31
    v_smfmac_f32_32x32x32_bf16 a[48:63], a[248:251], v[16:23], v63
    s_nop 0
    v_smfmac_f32_32x32x32_bf16 a[48:63], a[252:255], v[24:31], v63
    s_waitcnt vmcnt(63)
    v_mfma_f32_16x16x32_bf16 a[64:67], a[88:91], a[108:111], 0
    ds_write_b128 v60, a[32:35] offset:0
    v_mfma_f32_16x16x32_bf16 a[68:71], a[92:95], a[108:111], 0
    v_accvgpr_read_b32 v0, a0
    v_accvgpr_read_b32 v1, a1
    v_mfma_f32_16x16x32_bf16 a[72:75], a[96:99], a[108:111], 0
    v_accvgpr_read_b32 v2, a2
    v_accvgpr_read_b32 v3, a3
    v_mfma_f32_16x16x32_bf16 a[76:79], a[100:103], a[108:111], 0
    global_load_dwordx4 a[12:15], v53, s[70:71] offset:0 sc1
    v_accvgpr_read_b32 v4, a4
    v_accvgpr_read_b32 v5, a5
    v_mfma_f32_16x16x32_bf16 a[80:83], a[104:107], a[108:111], 0
    ds_write_b128 v60, a[36:39] offset:1024
    v_mfma_f32_16x16x32_bf16 a[84:87], a[88:91], a[112:115], 0
    v_accvgpr_read_b32 v6, a6
    v_accvgpr_read_b32 v7, a7
    v_mfma_f32_16x16x32_bf16 a[200:203], a[92:95], a[112:115], 0
    v_accvgpr_read_b32 v8, a8
    v_accvgpr_read_b32 v9, a9
    v_mfma_f32_16x16x32_bf16 a[204:207], a[96:99], a[112:115], 0
    v_accvgpr_read_b32 v10, a10
    v_accvgpr_read_b32 v11, a11
    v_mfma_f32_16x16x32_bf16 a[208:211], a[100:103], a[112:115], 0
    ds_write_b128 v60, a[40:43] offset:2048
    v_mfma_f32_16x16x32_bf16 a[212:215], a[104:107], a[112:115], 0
    s_add_u32 s72, s75, 12288
    v_accvgpr_read_b32 v12, a16
    v_accvgpr_read_b32 v13, a17
    v_mfma_f32_16x16x32_bf16 a[216:219], a[88:91], a[116:119], 0
    s_add_u32 s72, s24, s72
    s_addc_u32 s73, s25, 0
    global_load_dwordx4 a[28:31], v54, s[72:73] offset:-4096 sc1
    v_accvgpr_read_b32 v14, a18
    v_accvgpr_read_b32 v15, a19
    v_mfma_f32_16x16x32_bf16 a[220:223], a[92:95], a[116:119], 0
    v_accvgpr_read_b32 v16, a20
    v_accvgpr_read_b32 v17, a21
    v_mfma_f32_16x16x32_bf16 a[224:227], a[96:99], a[116:119], 0
    ds_write_b128 v60, a[48:51] offset:3072
    v_mfma_f32_16x16x32_bf16 a[228:231], a[100:103], a[116:119], 0
    v_accvgpr_read_b32 v18, a22
    v_accvgpr_read_b32 v19, a23
    v_mfma_f32_16x16x32_bf16 a[232:235], a[104:107], a[116:119], 0
    v_accvgpr_read_b32 v20, a24
    v_accvgpr_read_b32 v21, a25
    v_mfma_f32_16x16x32_bf16 a[236:239], a[88:91], a[120:123], 0
    v_accvgpr_read_b32 v22, a26
    v_accvgpr_read_b32 v23, a27
    v_mfma_f32_16x16x32_bf16 a[240:243], a[92:95], a[120:123], 0
    ds_write_b128 v60, a[52:55] offset:4096
    v_mfma_f32_16x16x32_bf16 a[244:247], a[96:99], a[120:123], 0
    global_load_dwordx4 a[44:47], v55, s[72:73] offset:-4096 sc1
    v_mfma_f32_16x16x32_bf16 a[248:251], a[100:103], a[120:123], 0
    v_mfma_f32_16x16x32_bf16 a[252:255], a[104:107], a[120:123], 0
    s_waitcnt vmcnt(63)
    v_mfma_f32_16x16x32_bf16 a[64:67], a[124:127], a[144:147], a[64:67]
    ds_write_b128 v60, a[56:59] offset:5120
    v_mfma_f32_16x16x32_bf16 a[68:71], a[128:131], a[144:147], a[68:71]
    v_mfma_f32_16x16x32_bf16 a[72:75], a[132:135], a[144:147], a[72:75]
    s_waitcnt lgkmcnt(0)
    s_barrier
    v_mfma_f32_16x16x32_bf16 a[76:79], a[136:139], a[144:147], a[76:79]
    ds_read_b128 v[32:35], v61 offset:2048
    global_load_dwordx4 a[60:63], v56, s[72:73] offset:-4096 sc1
    v_mfma_f32_16x16x32_bf16 a[80:83], a[140:143], a[144:147], a[80:83]
    ds_read_b128 v[44:47], v61 offset:5120
    v_mfma_f32_16x16x32_bf16 a[84:87], a[124:127], a[148:151], a[84:87]
    ds_read_b128 v[24:27], v61 offset:0
    v_mfma_f32_16x16x32_bf16 a[200:203], a[128:131], a[148:151], a[200:203]
    ds_read_b128 v[28:31], v61 offset:1024
    v_mfma_f32_16x16x32_bf16 a[204:207], a[132:135], a[148:151], a[204:207]
    ds_read_b128 v[36:39], v61 offset:3072
    v_mfma_f32_16x16x32_bf16 a[208:211], a[136:139], a[148:151], a[208:211]
    ds_read_b128 v[40:43], v61 offset:4096
    global_load_dwordx4 a[0:3], v57, s[72:73] offset:-4096 sc1
    v_mfma_f32_16x16x32_bf16 a[212:215], a[140:143], a[148:151], a[212:215]
    v_mfma_f32_16x16x32_bf16 a[216:219], a[124:127], a[152:155], a[216:219]
    v_mfma_f32_16x16x32_bf16 a[220:223], a[128:131], a[152:155], a[220:223]
    v_mfma_f32_16x16x32_bf16 a[224:227], a[132:135], a[152:155], a[224:227]
    v_mfma_f32_16x16x32_bf16 a[228:231], a[136:139], a[152:155], a[228:231]
    global_load_dwordx4 a[4:7], v53, s[70:71] offset:1024 sc1
    v_mfma_f32_16x16x32_bf16 a[232:235], a[140:143], a[152:155], a[232:235]
    s_waitcnt lgkmcnt(4)
    v_add_f32 v8, v8, v32
    v_add_f32 v9, v9, v33
    v_mfma_f32_16x16x32_bf16 a[236:239], a[124:127], a[156:159], a[236:239]
    v_add_f32 v10, v10, v34
    v_add_f32 v11, v11, v35
    v_mfma_f32_16x16x32_bf16 a[240:243], a[128:131], a[156:159], a[240:243]
    v_add_f32 v20, v20, v44
    v_add_f32 v21, v21, v45
    v_mfma_f32_16x16x32_bf16 a[244:247], a[132:135], a[156:159], a[244:247]
    v_add_f32 v22, v22, v46
    v_add_f32 v23, v23, v47
    v_mfma_f32_16x16x32_bf16 a[248:251], a[136:139], a[156:159], a[248:251]
    v_mov_b32 v32, v8
    v_mov_b32 v34, v8
    v_mfma_f32_16x16x32_bf16 a[252:255], a[140:143], a[156:159], a[252:255]
    v_mov_b32 v33, v20
    v_mov_b32 v35, v20
    s_waitcnt vmcnt(63)
    v_mfma_f32_16x16x32_bf16 a[64:67], a[160:163], a[180:183], a[64:67]
    s_waitcnt lgkmcnt(2)
    global_load_dwordx4 a[8:11], v53, s[70:71] offset:2048 sc1
    v_add_f32 v0, v0, v24
    v_add_f32 v1, v1, v25
    v_mfma_f32_16x16x32_bf16 a[68:71], a[164:167], a[180:183], a[68:71]
    v_add_f32 v2, v2, v26
    v_add_f32 v3, v3, v27
    v_mfma_f32_16x16x32_bf16 a[72:75], a[168:171], a[180:183], a[72:75]
    v_permlane32_swap_b32 v34, v32
    v_mfma_f32_16x16x32_bf16 a[76:79], a[172:175], a[180:183], a[76:79]
    v_permlane32_swap_b32 v35, v33
    v_mfma_f32_16x16x32_bf16 a[80:83], a[176:179], a[180:183], a[80:83]
    v_add_f32 v4, v4, v28
    v_add_f32 v5, v5, v29
    v_mfma_f32_16x16x32_bf16 a[84:87], a[160:163], a[184:187], a[84:87]
    v_add_f32 v6, v6, v30
    v_add_f32 v7, v7, v31
    v_mfma_f32_16x16x32_bf16 a[200:203], a[164:167], a[184:187], a[200:203]
    v_rcp_f32 v34, v32
    v_mfma_f32_16x16x32_bf16 a[204:207], a[168:171], a[184:187], a[204:207]
    global_load_dwordx4 a[32:35], v53, s[70:71] offset:3072 sc1
    v_rcp_f32 v35, v33
    v_mfma_f32_16x16x32_bf16 a[208:211], a[172:175], a[184:187], a[208:211]
    s_mov_b32 s85, 562036736
    s_mov_b32 s86, 1568669696
    s_mov_b32 s87, 0x7f000000
    v_mfma_f32_16x16x32_bf16 a[212:215], a[176:179], a[184:187], a[212:215]
    v_min_f32 v46, v32, v33
    v_max_f32 v47, v32, v33
    v_mfma_f32_16x16x32_bf16 a[216:219], a[160:163], a[188:191], a[216:219]
    v_add_f32 v44, |v0|, |v1|
    v_add_f32 v45, |v20|, |v21|
    v_mfma_f32_16x16x32_bf16 a[220:223], a[164:167], a[188:191], a[220:223]
    s_waitcnt lgkmcnt(0)
    v_add_f32 v12, v12, v36
    v_add_f32 v13, v13, v37
    v_mfma_f32_16x16x32_bf16 a[224:227], a[168:171], a[188:191], a[224:227]
    s_add_u32 s70, s74, 53248
    v_add_f32 v14, v14, v38
    v_add_f32 v15, v15, v39
    v_mfma_f32_16x16x32_bf16 a[228:231], a[172:175], a[188:191], a[228:231]
    s_add_u32 s70, s24, s70
    v_add_f32 v16, v16, v40
    v_add_f32 v17, v17, v41
    v_mfma_f32_16x16x32_bf16 a[232:235], a[176:179], a[188:191], a[232:235]
    s_addc_u32 s71, s25, 0
    global_load_dwordx4 a[36:39], v53, s[70:71] offset:-4096 sc1
    v_add_f32 v18, v18, v42
    v_add_f32 v19, v19, v43
    v_mfma_f32_16x16x32_bf16 a[236:239], a[160:163], a[192:195], a[236:239]
    v_cmp_nge_f32 vcc, v46, s85
    v_cmp_nle_f32 s[98:99], v47, s86
    v_mfma_f32_16x16x32_bf16 a[240:243], a[164:167], a[192:195], a[240:243]
    v_add_f32 v44, v44, |v2|
    v_add_f32 v45, v45, |v22|
    v_mfma_f32_16x16x32_bf16 a[244:247], a[168:171], a[192:195], a[244:247]
    v_add_f32 v44, v44, |v3|
    v_add_f32 v45, v45, |v23|
    v_mfma_f32_16x16x32_bf16 a[248:251], a[172:175], a[192:195], a[248:251]
    v_add_f32 v44, v44, |v4|
    v_add_f32 v45, v45, |v12|
    v_mfma_f32_16x16x32_bf16 a[252:255], a[176:179], a[192:195], a[252:255]
    v_add_f32 v44, v44, |v5|
    v_add_f32 v45, v45, |v13|
    s_waitcnt vmcnt(61)
    v_mfma_f32_16x16x32_bf16 a[64:67], a[196:199], v[80:83], a[64:67]
    v_add_f32 v44, v44, |v6|
    v_add_f32 v45, v45, |v14|
    v_mfma_f32_16x16x32_bf16 a[68:71], v[64:67], v[80:83], a[68:71]
    global_load_dwordx4 a[40:43], v53, s[70:71] offset:-3072 sc1
    v_add_f32 v44, v44, |v7|
    v_add_f32 v45, v45, |v15|
    v_mfma_f32_16x16x32_bf16 a[72:75], v[68:71], v[80:83], a[72:75]
    v_add_f32 v44, v44, |v8|
    v_add_f32 v45, v45, |v16|
    v_mfma_f32_16x16x32_bf16 a[76:79], v[72:75], v[80:83], a[76:79]
    v_add_f32 v44, v44, |v9|
    v_add_f32 v45, v45, |v17|
    v_mfma_f32_16x16x32_bf16 a[80:83], v[76:79], v[80:83], a[80:83]
    v_add_f32 v44, v44, |v10|
    v_add_f32 v45, v45, |v18|
    v_mfma_f32_16x16x32_bf16 a[84:87], a[196:199], v[84:87], a[84:87]
    v_add_f32 v44, v44, |v11|
    v_add_f32 v45, v45, |v19|
    v_mfma_f32_16x16x32_bf16 a[200:203], v[64:67], v[84:87], a[200:203]
    v_mul_f32 v24, v34, v0
    v_mul_f32 v25, v34, v1
    v_mfma_f32_16x16x32_bf16 a[204:207], v[68:71], v[84:87], a[204:207]
    v_mul_f32 v26, v34, v2
    v_mul_f32 v27, v34, v3
    v_mfma_f32_16x16x32_bf16 a[208:211], v[72:75], v[84:87], a[208:211]
    global_load_dwordx4 a[16:19], v54, s[72:73] offset:-3072 sc1
    v_mul_f32 v28, v34, v4
    v_mul_f32 v29, v34, v5
    v_mfma_f32_16x16x32_bf16 a[212:215], v[76:79], v[84:87], a[212:215]
    v_mul_f32 v30, v34, v6
    v_mul_f32 v31, v34, v7
    v_mfma_f32_16x16x32_bf16 a[216:219], a[196:199], v[88:91], a[216:219]
    v_add_f32 v44, v44, v45
    v_cvt_pk_bf16_f32 v24, v24, v25
    v_mfma_f32_16x16x32_bf16 a[220:223], v[64:67], v[88:91], a[220:223]
    v_cvt_pk_bf16_f32 v25, v26, v27
    v_cvt_pk_bf16_f32 v26, v28, v29
    v_mfma_f32_16x16x32_bf16 a[224:227], v[68:71], v[88:91], a[224:227]
    v_cvt_pk_bf16_f32 v27, v30, v31
    v_cmp_nlt_f32 s[100:101], v44, s87
    v_mfma_f32_16x16x32_bf16 a[228:231], v[72:75], v[88:91], a[228:231]
    v_mul_f32 v36, v35, v12
    v_mul_f32 v37, v35, v13
    v_mfma_f32_16x16x32_bf16 a[232:235], v[76:79], v[88:91], a[232:235]
    v_mul_f32 v38, v35, v14
    v_mul_f32 v39, v35, v15
    v_mfma_f32_16x16x32_bf16 a[236:239], a[196:199], v[92:95], a[236:239]
    global_load_dwordx4 a[20:23], v55, s[72:73] offset:-3072 sc1
    v_mul_f32 v40, v35, v16
    v_mul_f32 v41, v35, v17
    v_mfma_f32_16x16x32_bf16 a[240:243], v[64:67], v[92:95], a[240:243]
    v_mul_f32 v42, v35, v18
    v_mul_f32 v43, v35, v19
    v_mfma_f32_16x16x32_bf16 a[244:247], v[68:71], v[92:95], a[244:247]
    s_or_b64 vcc, vcc, s[98:99]
    s_or_b64 vcc, vcc, s[100:101]
    s_cselect_b32 s85, 1, 0
    v_mfma_f32_16x16x32_bf16 a[248:251], v[72:75], v[92:95], a[248:251]
    s_andn2_b32 s86, s85, s43
    s_lshl_b32 s86, s86, 30
    v_or_b32 v32, s86, v58
    v_mfma_f32_16x16x32_bf16 a[252:255], v[76:79], v[92:95], a[252:255]
    v_or_b32 v33, s86, v53
    s_waitcnt vmcnt(47)
    v_mfma_f32_16x16x32_bf16 a[64:67], v[96:99], v[116:119], a[64:67]
    buffer_store_dwordx4 v[24:27], v32, s[24:27], s77 offen sc1
    v_mfma_f32_16x16x32_bf16 a[68:71], v[100:103], v[116:119], a[68:71]
    v_cvt_pk_bf16_f32 v36, v36, v37
    v_cvt_pk_bf16_f32 v37, v38, v39
    v_mfma_f32_16x16x32_bf16 a[72:75], v[104:107], v[116:119], a[72:75]
    global_load_dwordx4 a[24:27], v56, s[72:73] offset:-3072 sc1
    v_cvt_pk_bf16_f32 v38, v40, v41
    v_cvt_pk_bf16_f32 v39, v42, v43
    v_mfma_f32_16x16x32_bf16 a[76:79], v[108:111], v[116:119], a[76:79]
    buffer_store_dwordx4 v[36:39], v32, s[24:27], s77 offen offset:512 sc1
    v_mfma_f32_16x16x32_bf16 a[80:83], v[112:115], v[116:119], a[80:83]
    v_mul_f32 v28, v34, v8
    v_mul_f32 v29, v34, v9
    v_mfma_f32_16x16x32_bf16 a[84:87], v[96:99], v[120:123], a[84:87]
    v_mul_f32 v30, v34, v10
    v_mul_f32 v31, v34, v11
    v_mfma_f32_16x16x32_bf16 a[200:203], v[100:103], v[120:123], a[200:203]
    v_mul_f32 v40, v35, v20
    v_mul_f32 v41, v35, v21
    v_mfma_f32_16x16x32_bf16 a[204:207], v[104:107], v[120:123], a[204:207]
    v_mul_f32 v42, v35, v22
    v_mul_f32 v43, v35, v23
    v_mfma_f32_16x16x32_bf16 a[208:211], v[108:111], v[120:123], a[208:211]
    v_cvt_pk_bf16_f32 v44, v28, v29
    v_cvt_pk_bf16_f32 v46, v40, v41
    v_mfma_f32_16x16x32_bf16 a[212:215], v[112:115], v[120:123], a[212:215]
    global_load_dwordx4 a[100:103], v57, s[72:73] offset:-3072 sc1
    v_cvt_pk_bf16_f32 v45, v30, v31
    v_cvt_pk_bf16_f32 v47, v42, v43
    v_mfma_f32_16x16x32_bf16 a[216:219], v[96:99], v[124:127], a[216:219]
    v_mov_b32 v30, s85
    v_mfma_f32_16x16x32_bf16 a[220:223], v[100:103], v[124:127], a[220:223]
    v_permlane32_swap_b32 v44, v46
    v_mfma_f32_16x16x32_bf16 a[224:227], v[104:107], v[124:127], a[224:227]
    v_permlane32_swap_b32 v45, v47
    v_mfma_f32_16x16x32_bf16 a[228:231], v[108:111], v[124:127], a[228:231]
    buffer_store_dwordx2 v[44:45], v33, s[24:27], s83 offen sc1
    v_mfma_f32_16x16x32_bf16 a[232:235], v[112:115], v[124:127], a[232:235]
    s_lshl_b32 s86, s3, 2
    s_add_u32 s86, s86, 39936
    v_mov_b32 v31, s86
    v_mfma_f32_16x16x32_bf16 a[236:239], v[96:99], v[128:131], a[236:239]
    ds_write_b32 v31, v30
    v_mfma_f32_16x16x32_bf16 a[240:243], v[100:103], v[128:131], a[240:243]
    global_load_dwordx4 a[104:107], v53, s[70:71] offset:-2048 sc1
    v_mov_b32 v31, 39936
    v_mfma_f32_16x16x32_bf16 a[244:247], v[104:107], v[128:131], a[244:247]
    v_mfma_f32_16x16x32_bf16 a[248:251], v[108:111], v[128:131], a[248:251]
    v_mfma_f32_16x16x32_bf16 a[252:255], v[112:115], v[128:131], a[252:255]
    s_waitcnt vmcnt(40)
    v_mfma_f32_16x16x32_bf16 a[64:67], v[132:135], v[152:155], a[64:67]
    s_waitcnt lgkmcnt(0)
    s_barrier
    v_mfma_f32_16x16x32_bf16 a[68:71], v[136:139], v[152:155], a[68:71]
    ds_read_b128 v[28:31], v31
    global_load_dwordx4 a[108:111], v53, s[70:71] offset:-1024 sc1
    v_mfma_f32_16x16x32_bf16 a[72:75], v[140:143], v[152:155], a[72:75]
    v_mfma_f32_16x16x32_bf16 a[76:79], v[144:147], v[152:155], a[76:79]
    v_mfma_f32_16x16x32_bf16 a[80:83], v[148:151], v[152:155], a[80:83]
    v_mfma_f32_16x16x32_bf16 a[84:87], v[132:135], v[156:159], a[84:87]
    v_mfma_f32_16x16x32_bf16 a[200:203], v[136:139], v[156:159], a[200:203]
    global_load_dwordx4 a[112:115], v54, s[72:73] offset:-2048 sc1
    v_mfma_f32_16x16x32_bf16 a[204:207], v[140:143], v[156:159], a[204:207]
    s_waitcnt lgkmcnt(0)
    v_or3_b32 v28, v28, v29, v30
    v_or_b32 v28, v28, v31
    s_nop 0
    v_readfirstlane_b32 s85, v28
    s_nop 0
    s_andn2_b32 s85, s85, s43
    s_cbranch_scc1 L_fallback
    v_mfma_f32_16x16x32_bf16 a[208:211], v[144:147], v[156:159], a[208:211]
    s_lshl_b32 s85, s81, 2
    v_add_u32 v48, 131072, v49
    v_add_u32 v50, 262144, v49
    v_mfma_f32_16x16x32_bf16 a[212:215], v[148:151], v[156:159], a[212:215]
    s_add_u32 s85, s85, s3
    v_add_u32 v51, 393216, v49
    v_add_u32 v52, 524288, v49
    v_mfma_f32_16x16x32_bf16 a[216:219], v[132:135], v[160:163], a[216:219]
    s_mul_i32 s85, s85, 20480
    s_mul_i32 s86, s82, 160
    v_add_u32 v2, s45, v53
    v_mfma_f32_16x16x32_bf16 a[220:223], v[136:139], v[160:163], a[220:223]
    s_waitcnt vmcnt(63)
    s_add_u32 s79, s85, s86
    global_load_dwordx4 a[116:119], v55, s[72:73] offset:-2048 sc1
    v_mfma_f32_16x16x32_bf16 a[224:227], v[140:143], v[160:163], a[224:227]
    s_mov_b32 m0, s45
    v_lshrrev_b32 v38, 4, v53
    v_add_u32 v39, 0, v38
    v_mfma_f32_16x16x32_bf16 a[228:231], v[144:147], v[160:163], a[228:231]
    v_mul_u32_u24 v40, 6554, v39
    v_lshrrev_b32 v40, 16, v40
    v_mfma_f32_16x16x32_bf16 a[232:235], v[148:151], v[160:163], a[232:235]
    v_mul_u32_u24 v40, 1120, v40
    v_lshl_add_u32 v41, v39, 4, v40
    v_mfma_f32_16x16x32_bf16 a[236:239], v[132:135], v[164:167], a[236:239]
    buffer_load_dwordx4 v41, s[8:11], s79 offen lds
    v_mfma_f32_16x16x32_bf16 a[240:243], v[136:139], v[164:167], a[240:243]
    global_load_dwordx4 a[120:123], v56, s[72:73] offset:-2048 sc1
    v_add_u32 v39, 64, v38
    v_mfma_f32_16x16x32_bf16 a[244:247], v[140:143], v[164:167], a[244:247]
    v_mul_u32_u24 v40, 6554, v39
    v_lshrrev_b32 v40, 16, v40
    v_mfma_f32_16x16x32_bf16 a[248:251], v[144:147], v[164:167], a[248:251]
    v_mul_u32_u24 v40, 1120, v40
    v_lshl_add_u32 v42, v39, 4, v40
    v_mfma_f32_16x16x32_bf16 a[252:255], v[148:151], v[164:167], a[252:255]
    s_add_u32 m0, s45, 1024
    s_nop 0
    buffer_load_dwordx4 v42, s[8:11], s79 offen lds
    s_waitcnt vmcnt(37)
    v_mfma_f32_16x16x32_bf16 a[64:67], v[168:171], v[188:191], a[64:67]
    v_add_u32 v39, 128, v38
    v_mul_u32_u24 v40, 6554, v39
    v_mfma_f32_16x16x32_bf16 a[68:71], v[172:175], v[188:191], a[68:71]
    global_load_dwordx4 a[88:91], v57, s[72:73] offset:-2048 sc1
    v_lshrrev_b32 v40, 16, v40
    v_mfma_f32_16x16x32_bf16 a[72:75], v[176:179], v[188:191], a[72:75]
    v_mul_u32_u24 v40, 1120, v40
    v_lshl_add_u32 v43, v39, 4, v40
    v_mfma_f32_16x16x32_bf16 a[76:79], v[180:183], v[188:191], a[76:79]
    v_cmp_gt_u32 vcc, 32, v38
    v_mov_b32 v39, 1073741824
    v_mfma_f32_16x16x32_bf16 a[80:83], v[184:187], v[188:191], a[80:83]
    v_cndmask_b32 v43, v39, v43, vcc
    v_mfma_f32_16x16x32_bf16 a[84:87], v[168:171], v[192:195], a[84:87]
    s_add_u32 m0, s45, 2048
    s_nop 0
    buffer_load_dwordx4 v43, s[8:11], s79 offen lds
    v_mfma_f32_16x16x32_bf16 a[200:203], v[172:175], v[192:195], a[200:203]
    global_load_dwordx4 a[92:95], v54, s[72:73] offset:-1024 sc1
    v_and_b32 v39, 15, v38
    v_mfma_f32_16x16x32_bf16 a[204:207], v[176:179], v[192:195], a[204:207]
    v_mul_u32_u24 v39, 160, v39
    v_lshrrev_b32 v38, 4, v38
    v_mfma_f32_16x16x32_bf16 a[208:211], v[180:183], v[192:195], a[208:211]
    v_lshl_add_u32 v38, v38, 3, v39
    v_add_u32 v0, s45, v38
    v_mfma_f32_16x16x32_bf16 a[212:215], v[184:187], v[192:195], a[212:215]
    s_add_u32 s85, s3, 3
    s_and_b32 s85, s85, 3
    s_mul_i32 s85, s85, 40960
    v_mfma_f32_16x16x32_bf16 a[216:219], v[168:171], v[196:199], a[216:219]
    v_add_u32 v3, s85, v53
    v_mfma_f32_16x16x32_bf16 a[220:223], v[172:175], v[196:199], a[220:223]
    s_add_u32 s85, s3, 2
    s_and_b32 s85, s85, 3
    global_load_dwordx4 a[96:99], v55, s[72:73] offset:-1024 sc1
    v_mfma_f32_16x16x32_bf16 a[224:227], v[176:179], v[196:199], a[224:227]
    s_mul_i32 s85, s85, 40960
    v_add_u32 v4, s85, v53
    v_mfma_f32_16x16x32_bf16 a[228:231], v[180:183], v[196:199], a[228:231]
    s_add_u32 s85, s3, 1
    s_and_b32 s85, s85, 3
    s_mul_i32 s85, s85, 40960
    v_mfma_f32_16x16x32_bf16 a[232:235], v[184:187], v[196:199], a[232:235]
    v_add_u32 v5, s85, v53
    v_mfma_f32_16x16x32_bf16 a[236:239], v[168:171], v[200:203], a[236:239]
    v_mfma_f32_16x16x32_bf16 a[240:243], v[172:175], v[200:203], a[240:243]
    global_load_dwordx4 a[48:51], v56, s[72:73] offset:-1024 sc1
    v_mfma_f32_16x16x32_bf16 a[244:247], v[176:179], v[200:203], a[244:247]
    v_mfma_f32_16x16x32_bf16 a[248:251], v[180:183], v[200:203], a[248:251]
    v_mfma_f32_16x16x32_bf16 a[252:255], v[184:187], v[200:203], a[252:255]
    s_waitcnt vmcnt(33)
    v_mfma_f32_16x16x32_bf16 a[64:67], v[204:207], v[224:227], a[64:67]
    ds_read_b128 a[56:59], v2 offset:6144
    v_mfma_f32_16x16x32_bf16 a[68:71], v[208:211], v[224:227], a[68:71]
    global_load_dwordx4 a[52:55], v57, s[72:73] offset:-1024 sc1
    v_mfma_f32_16x16x32_bf16 a[72:75], v[212:215], v[224:227], a[72:75]
    ds_read_b128 a[124:127], v2 offset:7168
    v_mfma_f32_16x16x32_bf16 a[76:79], v[216:219], v[224:227], a[76:79]
    v_mfma_f32_16x16x32_bf16 a[80:83], v[220:223], v[224:227], a[80:83]
    ds_read_b128 a[128:131], v2 offset:8192
    v_mfma_f32_16x16x32_bf16 a[84:87], v[204:207], v[228:231], a[84:87]
    v_mfma_f32_16x16x32_bf16 a[200:203], v[208:211], v[228:231], a[200:203]
    ds_read_b128 a[132:135], v2 offset:9216
    v_mfma_f32_16x16x32_bf16 a[204:207], v[212:215], v[228:231], a[204:207]
    v_mfma_f32_16x16x32_bf16 a[208:211], v[216:219], v[228:231], a[208:211]
    ds_read_b128 a[136:139], v2 offset:10240
    v_mfma_f32_16x16x32_bf16 a[212:215], v[220:223], v[228:231], a[212:215]
    v_mfma_f32_16x16x32_bf16 a[216:219], v[204:207], v[232:235], a[216:219]
    ds_read_b128 a[140:143], v2 offset:11264
    v_mfma_f32_16x16x32_bf16 a[220:223], v[208:211], v[232:235], a[220:223]
    v_mfma_f32_16x16x32_bf16 a[224:227], v[212:215], v[232:235], a[224:227]
    ds_read_b128 a[144:147], v2 offset:12288
    v_mfma_f32_16x16x32_bf16 a[228:231], v[216:219], v[232:235], a[228:231]
    v_mfma_f32_16x16x32_bf16 a[232:235], v[220:223], v[232:235], a[232:235]
    ds_read_b128 a[148:151], v2 offset:13312
    v_mfma_f32_16x16x32_bf16 a[236:239], v[204:207], v[236:239], a[236:239]
    v_mfma_f32_16x16x32_bf16 a[240:243], v[208:211], v[236:239], a[240:243]
    ds_read_b128 a[152:155], v2 offset:14336
    v_mfma_f32_16x16x32_bf16 a[244:247], v[212:215], v[236:239], a[244:247]
    v_mfma_f32_16x16x32_bf16 a[248:251], v[216:219], v[236:239], a[248:251]
    ds_read_b128 a[156:159], v2 offset:15360
    v_mfma_f32_16x16x32_bf16 a[252:255], v[220:223], v[236:239], a[252:255]
    s_waitcnt vmcnt(25)
    v_mfma_f32_16x16x32_bf16 a[64:67], v[240:243], a[28:31], a[64:67]
    ds_read_b128 a[160:163], v2 offset:16384
    v_mfma_f32_16x16x32_bf16 a[68:71], v[244:247], a[28:31], a[68:71]
    v_mfma_f32_16x16x32_bf16 a[72:75], v[248:251], a[28:31], a[72:75]
    ds_read_b128 a[164:167], v2 offset:17408
    v_mfma_f32_16x16x32_bf16 a[76:79], v[252:255], a[28:31], a[76:79]
    v_mfma_f32_16x16x32_bf16 a[80:83], a[12:15], a[28:31], a[80:83]
    ds_read_b128 a[168:171], v2 offset:18432
    v_mfma_f32_16x16x32_bf16 a[84:87], v[240:243], a[44:47], a[84:87]
    v_mfma_f32_16x16x32_bf16 a[200:203], v[244:247], a[44:47], a[200:203]
    ds_read_b128 a[172:175], v2 offset:19456
    v_mfma_f32_16x16x32_bf16 a[204:207], v[248:251], a[44:47], a[204:207]
    v_mfma_f32_16x16x32_bf16 a[208:211], v[252:255], a[44:47], a[208:211]
    ds_read_b128 a[176:179], v2 offset:20480
    v_mfma_f32_16x16x32_bf16 a[212:215], a[12:15], a[44:47], a[212:215]
    v_mfma_f32_16x16x32_bf16 a[216:219], v[240:243], a[60:63], a[216:219]
    ds_read_b128 a[180:183], v2 offset:21504
    v_mfma_f32_16x16x32_bf16 a[220:223], v[244:247], a[60:63], a[220:223]
    v_mfma_f32_16x16x32_bf16 a[224:227], v[248:251], a[60:63], a[224:227]
    ds_read_b128 a[184:187], v2 offset:22528
    v_mfma_f32_16x16x32_bf16 a[228:231], v[252:255], a[60:63], a[228:231]
    v_mfma_f32_16x16x32_bf16 a[232:235], a[12:15], a[60:63], a[232:235]
    ds_read_b128 a[188:191], v2 offset:23552
    v_mfma_f32_16x16x32_bf16 a[236:239], v[240:243], a[0:3], a[236:239]
    v_mfma_f32_16x16x32_bf16 a[240:243], v[244:247], a[0:3], a[240:243]
    ds_read_b128 a[192:195], v2 offset:24576
    v_mfma_f32_16x16x32_bf16 a[244:247], v[248:251], a[0:3], a[244:247]
    v_mfma_f32_16x16x32_bf16 a[248:251], v[252:255], a[0:3], a[248:251]
    ds_read_b128 a[196:199], v2 offset:25600
    v_mfma_f32_16x16x32_bf16 a[252:255], a[12:15], a[0:3], a[252:255]
    s_waitcnt vmcnt(14)
    v_mfma_f32_16x16x32_bf16 a[64:67], a[4:7], a[16:19], a[64:67]
    ds_read_b128 a[0:3], v2 offset:26624
    v_mfma_f32_16x16x32_bf16 a[68:71], a[8:11], a[16:19], a[68:71]
    v_mfma_f32_16x16x32_bf16 a[72:75], a[32:35], a[16:19], a[72:75]
    ds_read_b128 a[12:15], v2 offset:27648
    v_mfma_f32_16x16x32_bf16 a[76:79], a[36:39], a[16:19], a[76:79]
    v_mfma_f32_16x16x32_bf16 a[80:83], a[40:43], a[16:19], a[80:83]
    ds_read_b128 a[28:31], v2 offset:28672
    v_mfma_f32_16x16x32_bf16 a[84:87], a[4:7], a[20:23], a[84:87]
    v_mfma_f32_16x16x32_bf16 a[200:203], a[8:11], a[20:23], a[200:203]
    ds_read_b128 a[44:47], v2 offset:29696
    v_mfma_f32_16x16x32_bf16 a[204:207], a[32:35], a[20:23], a[204:207]
    v_mfma_f32_16x16x32_bf16 a[208:211], a[36:39], a[20:23], a[208:211]
    ds_read_b128 a[60:63], v2 offset:30720
    v_mfma_f32_16x16x32_bf16 a[212:215], a[40:43], a[20:23], a[212:215]
    v_mfma_f32_16x16x32_bf16 a[216:219], a[4:7], a[24:27], a[216:219]
    s_add_u32 s72, s12, 4096
    ds_read_b128 v[144:147], v2 offset:31744
    v_mfma_f32_16x16x32_bf16 a[220:223], a[8:11], a[24:27], a[220:223]
    s_add_u32 s72, s24, s72
    v_mfma_f32_16x16x32_bf16 a[224:227], a[32:35], a[24:27], a[224:227]
    s_addc_u32 s73, s25, 0
    ds_read_b128 v[148:151], v2 offset:32768
    v_mfma_f32_16x16x32_bf16 a[228:231], a[36:39], a[24:27], a[228:231]
    global_load_dwordx4 v[64:67], v49, s[72:73] offset:-4096 sc1
    v_mfma_f32_16x16x32_bf16 a[232:235], a[40:43], a[24:27], a[232:235]
    ds_read_b128 v[152:155], v2 offset:33792
    v_mfma_f32_16x16x32_bf16 a[236:239], a[4:7], a[100:103], a[236:239]
    v_mfma_f32_16x16x32_bf16 a[240:243], a[8:11], a[100:103], a[240:243]
    ds_read_b128 v[156:159], v2 offset:34816
    v_mfma_f32_16x16x32_bf16 a[244:247], a[32:35], a[100:103], a[244:247]
    global_load_dwordx4 v[68:71], v48, s[72:73] offset:-4096 sc1
    v_mfma_f32_16x16x32_bf16 a[248:251], a[36:39], a[100:103], a[248:251]
    ds_read_b128 v[160:163], v2 offset:35840
    v_mfma_f32_16x16x32_bf16 a[252:255], a[40:43], a[100:103], a[252:255]
    s_waitcnt vmcnt(7) lgkmcnt(15)
    v_mfma_f32_16x16x32_bf16 a[64:67], a[104:107], a[112:115], a[64:67]
    s_waitcnt vmcnt(6)
    ds_read_b128 a[100:103], v2 offset:36864
    ds_read_b64 v[8:9], v0 offset:0
    v_mfma_f32_16x16x32_bf16 a[68:71], a[108:111], a[112:115], a[68:71]
    global_load_dwordx4 v[72:75], v50, s[72:73] offset:-4096 sc1
    ds_read_b64 v[10:11], v0 offset:32
    v_mfma_f32_16x16x32_bf16 a[72:75], a[56:59], a[112:115], a[72:75]
    ds_read_b128 a[16:19], v2 offset:37888
    ds_read_b64 v[12:13], v0 offset:64
    v_mfma_f32_16x16x32_bf16 a[76:79], a[124:127], a[112:115], a[76:79]
    ds_read_b64 v[14:15], v0 offset:96
    ds_read_b64 v[16:17], v0 offset:128
    v_mfma_f32_16x16x32_bf16 a[80:83], a[128:131], a[112:115], a[80:83]
    ds_read_b128 a[20:23], v2 offset:38912
    v_mfma_f32_16x16x32_bf16 a[84:87], a[104:107], a[116:119], a[84:87]
    global_load_dwordx4 v[76:79], v51, s[72:73] offset:-4096 sc1
    v_mfma_f32_16x16x32_bf16 a[200:203], a[108:111], a[116:119], a[200:203]
    v_mfma_f32_16x16x32_bf16 a[204:207], a[56:59], a[116:119], a[204:207]
    v_mfma_f32_16x16x32_bf16 a[208:211], a[124:127], a[116:119], a[208:211]
    v_mfma_f32_16x16x32_bf16 a[212:215], a[128:131], a[116:119], a[212:215]
    global_load_dwordx4 v[80:83], v52, s[72:73] offset:-4096 sc1
    v_mfma_f32_16x16x32_bf16 a[216:219], a[104:107], a[120:123], a[216:219]
    v_mfma_f32_16x16x32_bf16 a[220:223], a[108:111], a[120:123], a[220:223]
    s_waitcnt lgkmcnt(1)
    v_lshlrev_b32 v18, 16, v8
    v_and_b32 v19, 0xffff0000, v8
    v_mfma_f32_16x16x32_bf16 a[224:227], a[56:59], a[120:123], a[224:227]
    v_lshlrev_b32 v20, 16, v9
    v_and_b32 v21, 0xffff0000, v9
    v_mfma_f32_16x16x32_bf16 a[228:231], a[124:127], a[120:123], a[228:231]
    v_lshlrev_b32 v22, 16, v10
    v_and_b32 v23, 0xffff0000, v10
    v_mfma_f32_16x16x32_bf16 a[232:235], a[128:131], a[120:123], a[232:235]
    v_lshlrev_b32 v24, 16, v11
    v_and_b32 v25, 0xffff0000, v11
    v_mfma_f32_16x16x32_bf16 a[236:239], a[104:107], a[88:91], a[236:239]
    s_add_u32 s72, s13, 4096
    v_lshlrev_b32 v26, 16, v12
    v_and_b32 v27, 0xffff0000, v12
    v_mfma_f32_16x16x32_bf16 a[240:243], a[108:111], a[88:91], a[240:243]
    s_add_u32 s72, s24, s72
    v_lshlrev_b32 v28, 16, v13
    v_and_b32 v29, 0xffff0000, v13
    v_mfma_f32_16x16x32_bf16 a[244:247], a[56:59], a[88:91], a[244:247]
    s_addc_u32 s73, s25, 0
    v_lshlrev_b32 v30, 16, v14
    v_and_b32 v31, 0xffff0000, v14
    v_mfma_f32_16x16x32_bf16 a[248:251], a[124:127], a[88:91], a[248:251]
    global_load_dwordx4 v[84:87], v49, s[72:73] offset:-4096 sc1
    v_lshlrev_b32 v32, 16, v15
    v_mfma_f32_16x16x32_bf16 a[252:255], a[128:131], a[88:91], a[252:255]
    v_and_b32 v33, 0xffff0000, v15
    v_lshlrev_b32 v34, 16, v16
    s_waitcnt vmcnt(6) lgkmcnt(15)
    v_mfma_f32_16x16x32_bf16 a[64:67], a[132:135], a[92:95], a[64:67]
    v_and_b32 v35, 0xffff0000, v16
    v_lshlrev_b32 v36, 16, v17
    v_mfma_f32_16x16x32_bf16 a[68:71], a[136:139], a[92:95], a[68:71]
    v_and_b32 v37, 0xffff0000, v17
    v_mfma_f32_16x16x32_bf16 a[72:75], a[140:143], a[92:95], a[72:75]
    global_load_dwordx4 v[88:91], v48, s[72:73] offset:-4096 sc1
    v_mfma_f32_16x16x32_bf16 a[76:79], a[144:147], a[92:95], a[76:79]
    v_mfma_f32_16x16x32_bf16 a[80:83], a[148:151], a[92:95], a[80:83]
    v_mfma_f32_16x16x32_bf16 a[84:87], a[132:135], a[96:99], a[84:87]
    v_mfma_f32_16x16x32_bf16 a[200:203], a[136:139], a[96:99], a[200:203]
    global_load_dwordx4 v[92:95], v50, s[72:73] offset:-4096 sc1
    v_mfma_f32_16x16x32_bf16 a[204:207], a[140:143], a[96:99], a[204:207]
    v_mfma_f32_16x16x32_bf16 a[208:211], a[144:147], a[96:99], a[208:211]
    v_mfma_f32_16x16x32_bf16 a[212:215], a[148:151], a[96:99], a[212:215]
    v_mfma_f32_16x16x32_bf16 a[216:219], a[132:135], a[48:51], a[216:219]
    global_load_dwordx4 v[100:103], v51, s[72:73] offset:-4096 sc1
    v_mfma_f32_16x16x32_bf16 a[220:223], a[136:139], a[48:51], a[220:223]
    v_mfma_f32_16x16x32_bf16 a[224:227], a[140:143], a[48:51], a[224:227]
    v_mfma_f32_16x16x32_bf16 a[228:231], a[144:147], a[48:51], a[228:231]
    v_mfma_f32_16x16x32_bf16 a[232:235], a[148:151], a[48:51], a[232:235]
    global_load_dwordx4 v[104:107], v52, s[72:73] offset:-4096 sc1
    v_mfma_f32_16x16x32_bf16 a[236:239], a[132:135], a[52:55], a[236:239]
    v_mfma_f32_16x16x32_bf16 a[240:243], a[136:139], a[52:55], a[240:243]
    v_mfma_f32_16x16x32_bf16 a[244:247], a[140:143], a[52:55], a[244:247]
    s_waitcnt vmcnt(5)
    v_max3_u32 v6, v64, v66, v68
    v_max3_u32 v7, v70, v72, v76
    v_mfma_f32_16x16x32_bf16 a[248:251], a[144:147], a[52:55], a[248:251]
    v_max3_u32 v6, v6, v78, v80
    v_max3_u32 v6, v6, v7, v82
    v_mfma_f32_16x16x32_bf16 a[252:255], a[148:151], a[52:55], a[252:255]
    v_cmp_eq_u32 vcc, -1, v6
    s_nop 0
    s_cbranch_vccnz L_oretry0
L_oback0:
    s_waitcnt lgkmcnt(0)
    v_mfma_f32_16x16x32_bf16 a[64:67], a[152:155], v[64:67], a[64:67]
    s_add_u32 s72, s14, 4096
    v_mfma_f32_16x16x32_bf16 a[64:67], a[172:175], v[68:71], a[64:67]
    s_add_u32 s72, s24, s72
    v_mfma_f32_16x16x32_bf16 a[64:67], a[192:195], v[72:75], a[64:67]
    s_addc_u32 s73, s25, 0
    v_mfma_f32_16x16x32_bf16 a[64:67], a[44:47], v[76:79], a[64:67]
    global_load_dwordx4 v[108:111], v49, s[72:73] offset:-4096 sc1
    v_accvgpr_read_b32 v44, a236
    v_mfma_f32_16x16x32_bf16 a[64:67], v[156:159], v[80:83], a[64:67]
    v_accvgpr_read_b32 v45, a237
    v_accvgpr_read_b32 v46, a238
    v_mfma_f32_16x16x32_bf16 a[68:71], a[156:159], v[64:67], a[68:71]
    v_accvgpr_read_b32 v47, a239
    v_add_f32 v18, v18, v44
    v_mfma_f32_16x16x32_bf16 a[68:71], a[176:179], v[68:71], a[68:71]
    v_add_f32 v19, v19, v45
    v_add_f32 v20, v20, v46
    v_mfma_f32_16x16x32_bf16 a[68:71], a[196:199], v[72:75], a[68:71]
    global_load_dwordx4 v[112:115], v48, s[72:73] offset:-4096 sc1
    ds_write_b128 v2, a[64:67] offset:6144
    v_add_f32 v21, v21, v47
    v_mfma_f32_16x16x32_bf16 a[68:71], a[60:63], v[76:79], a[68:71]
    v_accvgpr_read_b32 v44, a240
    v_accvgpr_read_b32 v45, a241
    v_mfma_f32_16x16x32_bf16 a[68:71], v[160:163], v[80:83], a[68:71]
    v_accvgpr_read_b32 v46, a242
    v_accvgpr_read_b32 v47, a243
    v_mfma_f32_16x16x32_bf16 a[72:75], a[160:163], v[64:67], a[72:75]
    v_add_f32 v22, v22, v44
    v_add_f32 v23, v23, v45
    v_mfma_f32_16x16x32_bf16 a[72:75], a[180:183], v[68:71], a[72:75]
    global_load_dwordx4 v[116:119], v50, s[72:73] offset:-4096 sc1
    v_add_f32 v24, v24, v46
    v_mfma_f32_16x16x32_bf16 a[72:75], a[0:3], v[72:75], a[72:75]
    ds_write_b128 v2, a[68:71] offset:7168
    v_add_f32 v25, v25, v47
    v_accvgpr_read_b32 v44, a244
    v_mfma_f32_16x16x32_bf16 a[72:75], v[144:147], v[76:79], a[72:75]
    v_accvgpr_read_b32 v45, a245
    v_accvgpr_read_b32 v46, a246
    v_mfma_f32_16x16x32_bf16 a[72:75], a[100:103], v[80:83], a[72:75]
    v_accvgpr_read_b32 v47, a247
    v_add_f32 v26, v26, v44
    v_mfma_f32_16x16x32_bf16 a[76:79], a[164:167], v[64:67], a[76:79]
    global_load_dwordx4 v[120:123], v51, s[72:73] offset:-4096 sc1
    v_add_f32 v27, v27, v45
    v_mfma_f32_16x16x32_bf16 a[76:79], a[184:187], v[68:71], a[76:79]
    v_add_f32 v28, v28, v46
    v_add_f32 v29, v29, v47
    v_mfma_f32_16x16x32_bf16 a[76:79], a[12:15], v[72:75], a[76:79]
    ds_write_b128 v2, a[72:75] offset:8192
    v_accvgpr_read_b32 v44, a248
    v_accvgpr_read_b32 v45, a249
    v_mfma_f32_16x16x32_bf16 a[76:79], v[148:151], v[76:79], a[76:79]
    v_accvgpr_read_b32 v46, a250
    v_accvgpr_read_b32 v47, a251
    v_mfma_f32_16x16x32_bf16 a[76:79], a[16:19], v[80:83], a[76:79]
    global_load_dwordx4 v[124:127], v52, s[72:73] offset:-4096 sc1
    v_add_f32 v30, v30, v44
    v_mfma_f32_16x16x32_bf16 a[80:83], a[168:171], v[64:67], a[80:83]
    v_add_f32 v31, v31, v45
    v_add_f32 v32, v32, v46
    v_mfma_f32_16x16x32_bf16 a[80:83], a[188:191], v[68:71], a[80:83]
    v_add_f32 v33, v33, v47
    v_accvgpr_read_b32 v44, a252
    v_mfma_f32_16x16x32_bf16 a[80:83], a[28:31], v[72:75], a[80:83]
    s_waitcnt vmcnt(5)
    ds_write_b128 v2, a[76:79] offset:9216
    v_max3_u32 v6, v84, v86, v88
    v_max3_u32 v7, v90, v92, v100
    v_mfma_f32_16x16x32_bf16 a[80:83], v[152:155], v[76:79], a[80:83]
    v_max3_u32 v6, v6, v102, v104
    v_max3_u32 v6, v6, v7, v106
    v_mfma_f32_16x16x32_bf16 a[80:83], a[20:23], v[80:83], a[80:83]
    v_cmp_eq_u32 vcc, -1, v6
    s_nop 0
    s_cbranch_vccnz L_oretry1
L_oback1:
    v_mfma_f32_16x16x32_bf16 a[84:87], a[152:155], v[84:87], a[84:87]
    s_add_u32 s72, s15, 4096
    v_accvgpr_read_b32 v45, a253
    v_accvgpr_read_b32 v46, a254
    v_mfma_f32_16x16x32_bf16 a[84:87], a[172:175], v[88:91], a[84:87]
    s_add_u32 s72, s24, s72
    v_accvgpr_read_b32 v47, a255
    v_add_f32 v34, v34, v44
    v_mfma_f32_16x16x32_bf16 a[84:87], a[192:195], v[92:95], a[84:87]
    s_addc_u32 s73, s25, 0
    ds_write_b128 v2, a[80:83] offset:10240
    v_add_f32 v35, v35, v45
    v_add_f32 v36, v36, v46
    v_mfma_f32_16x16x32_bf16 a[84:87], a[44:47], v[100:103], a[84:87]
    global_load_dwordx4 v[128:131], v49, s[72:73] offset:-4096 sc1
    v_add_f32 v37, v37, v47
    v_mfma_f32_16x16x32_bf16 a[84:87], v[156:159], v[104:107], a[84:87]
    v_mfma_f32_16x16x32_bf16 a[200:203], a[156:159], v[84:87], a[200:203]
    v_mfma_f32_16x16x32_bf16 a[200:203], a[176:179], v[88:91], a[200:203]
    v_mfma_f32_16x16x32_bf16 a[200:203], a[196:199], v[92:95], a[200:203]
    global_load_dwordx4 v[96:99], v48, s[72:73] offset:-4096 sc1
    ds_write_b128 v2, a[84:87] offset:11264
    v_mfma_f32_16x16x32_bf16 a[200:203], a[60:63], v[100:103], a[200:203]
    v_mfma_f32_16x16x32_bf16 a[200:203], v[160:163], v[104:107], a[200:203]
    v_mfma_f32_16x16x32_bf16 a[204:207], a[160:163], v[84:87], a[204:207]
    v_mfma_f32_16x16x32_bf16 a[204:207], a[180:183], v[88:91], a[204:207]
    global_load_dwordx4 v[132:135], v50, s[72:73] offset:-4096 sc1
    v_mfma_f32_16x16x32_bf16 a[204:207], a[0:3], v[92:95], a[204:207]
    ds_write_b128 v2, a[200:203] offset:12288
    v_mfma_f32_16x16x32_bf16 a[204:207], v[144:147], v[100:103], a[204:207]
    v_mfma_f32_16x16x32_bf16 a[204:207], a[100:103], v[104:107], a[204:207]
    v_mfma_f32_16x16x32_bf16 a[208:211], a[164:167], v[84:87], a[208:211]
    global_load_dwordx4 v[136:139], v51, s[72:73] offset:-4096 sc1
    v_mfma_f32_16x16x32_bf16 a[208:211], a[184:187], v[88:91], a[208:211]
    v_mfma_f32_16x16x32_bf16 a[208:211], a[12:15], v[92:95], a[208:211]
    ds_write_b128 v2, a[204:207] offset:13312
    v_mfma_f32_16x16x32_bf16 a[208:211], v[148:151], v[100:103], a[208:211]
    v_mfma_f32_16x16x32_bf16 a[208:211], a[16:19], v[104:107], a[208:211]
    global_load_dwordx4 v[140:143], v52, s[72:73] offset:-4096 sc1
    v_mfma_f32_16x16x32_bf16 a[212:215], a[168:171], v[84:87], a[212:215]
    v_mfma_f32_16x16x32_bf16 a[212:215], a[188:191], v[88:91], a[212:215]
    v_mfma_f32_16x16x32_bf16 a[212:215], a[28:31], v[92:95], a[212:215]
    s_waitcnt vmcnt(5)
    ds_write_b128 v2, a[208:211] offset:14336
    v_max3_u32 v6, v108, v110, v112
    v_max3_u32 v7, v114, v116, v120
    v_mfma_f32_16x16x32_bf16 a[212:215], v[152:155], v[100:103], a[212:215]
    v_max3_u32 v6, v6, v122, v124
    v_max3_u32 v6, v6, v7, v126
    v_mfma_f32_16x16x32_bf16 a[212:215], a[20:23], v[104:107], a[212:215]
    v_cmp_eq_u32 vcc, -1, v6
    s_nop 0
    s_cbranch_vccnz L_oretry2
L_oback2:
    v_mfma_f32_16x16x32_bf16 a[216:219], a[152:155], v[108:111], a[216:219]
    v_mfma_f32_16x16x32_bf16 a[216:219], a[172:175], v[112:115], a[216:219]
    v_mfma_f32_16x16x32_bf16 a[216:219], a[192:195], v[116:119], a[216:219]
    ds_write_b128 v2, a[212:215] offset:15360
    v_mfma_f32_16x16x32_bf16 a[216:219], a[44:47], v[120:123], a[216:219]
    v_mfma_f32_16x16x32_bf16 a[216:219], v[156:159], v[124:127], a[216:219]
    v_mfma_f32_16x16x32_bf16 a[220:223], a[156:159], v[108:111], a[220:223]
    s_waitcnt lgkmcnt(0)
    s_barrier
    ds_read_b128 v[164:167], v3 offset:6144
    v_mfma_f32_16x16x32_bf16 a[220:223], a[176:179], v[112:115], a[220:223]
    ds_read_b128 v[168:171], v4 offset:11264
    v_mfma_f32_16x16x32_bf16 a[220:223], a[196:199], v[116:119], a[220:223]
    ds_read_b128 v[172:175], v3 offset:7168
    ds_write_b128 v2, a[216:219] offset:16384
    v_mfma_f32_16x16x32_bf16 a[220:223], a[60:63], v[120:123], a[220:223]
    ds_read_b128 v[176:179], v4 offset:12288
    v_mfma_f32_16x16x32_bf16 a[220:223], v[160:163], v[124:127], a[220:223]
    ds_read_b128 v[180:183], v3 offset:8192
    v_mfma_f32_16x16x32_bf16 a[224:227], a[160:163], v[108:111], a[224:227]
    s_waitcnt lgkmcnt(4)
    ds_read_b128 v[184:187], v4 offset:13312
    v_add_f32 v18, v18, v164
    v_mfma_f32_16x16x32_bf16 a[224:227], a[180:183], v[112:115], a[224:227]
    ds_read_b128 v[188:191], v3 offset:9216
    v_add_f32 v19, v19, v165
    v_mfma_f32_16x16x32_bf16 a[224:227], a[0:3], v[116:119], a[224:227]
    ds_read_b128 v[192:195], v4 offset:14336
    ds_write_b128 v2, a[220:223] offset:17408
    v_add_f32 v20, v20, v166
    v_mfma_f32_16x16x32_bf16 a[224:227], v[144:147], v[120:123], a[224:227]
    ds_read_b128 v[196:199], v3 offset:10240
    v_add_f32 v21, v21, v167
    v_mfma_f32_16x16x32_bf16 a[224:227], a[100:103], v[124:127], a[224:227]
    ds_read_b128 v[200:203], v4 offset:15360
    v_add_f32 v18, v18, v168
    v_mfma_f32_16x16x32_bf16 a[228:231], a[164:167], v[108:111], a[228:231]
    v_add_f32 v19, v19, v169
    v_add_f32 v20, v20, v170
    v_mfma_f32_16x16x32_bf16 a[228:231], a[184:187], v[112:115], a[228:231]
    v_add_f32 v21, v21, v171
    v_mfma_f32_16x16x32_bf16 a[228:231], a[12:15], v[116:119], a[228:231]
    s_waitcnt lgkmcnt(7)
    ds_write_b128 v2, a[224:227] offset:18432
    v_add_f32 v22, v22, v172
    v_add_f32 v23, v23, v173
    v_mfma_f32_16x16x32_bf16 a[228:231], v[148:151], v[120:123], a[228:231]
    v_add_f32 v24, v24, v174
    v_add_f32 v25, v25, v175
    v_mfma_f32_16x16x32_bf16 a[228:231], a[16:19], v[124:127], a[228:231]
    v_add_f32 v22, v22, v176
    v_add_f32 v23, v23, v177
    v_mfma_f32_16x16x32_bf16 a[232:235], a[168:171], v[108:111], a[232:235]
    v_add_f32 v24, v24, v178
    v_add_f32 v25, v25, v179
    v_mfma_f32_16x16x32_bf16 a[232:235], a[188:191], v[112:115], a[232:235]
    s_waitcnt lgkmcnt(6)
    v_add_f32 v26, v26, v180
    v_add_f32 v27, v27, v181
    v_mfma_f32_16x16x32_bf16 a[232:235], a[28:31], v[116:119], a[232:235]
    s_waitcnt vmcnt(0)
    ds_write_b128 v2, a[228:231] offset:19456
    v_max3_u32 v6, v128, v130, v96
    v_max3_u32 v7, v98, v132, v136
    v_mfma_f32_16x16x32_bf16 a[232:235], v[152:155], v[120:123], a[232:235]
    v_max3_u32 v6, v6, v138, v140
    v_max3_u32 v6, v6, v7, v142
    v_mfma_f32_16x16x32_bf16 a[232:235], a[20:23], v[124:127], a[232:235]
    v_cmp_eq_u32 vcc, -1, v6
    s_nop 0
    s_cbranch_vccnz L_oretry3
L_oback3:
    v_mfma_f32_16x16x32_bf16 v[18:21], a[152:155], v[128:131], v[18:21]
    v_add_f32 v28, v28, v182
    v_add_f32 v29, v29, v183
    v_mfma_f32_16x16x32_bf16 v[18:21], a[172:175], v[96:99], v[18:21]
    v_add_f32 v26, v26, v184
    v_add_f32 v27, v27, v185
    v_mfma_f32_16x16x32_bf16 v[18:21], a[192:195], v[132:135], v[18:21]
    ds_write_b128 v2, a[232:235] offset:20480
    v_add_f32 v28, v28, v186
    v_add_f32 v29, v29, v187
    v_mfma_f32_16x16x32_bf16 v[18:21], a[44:47], v[136:139], v[18:21]
    s_waitcnt lgkmcnt(6)
    v_add_f32 v30, v30, v188
    v_add_f32 v31, v31, v189
    v_mfma_f32_16x16x32_bf16 v[18:21], v[156:159], v[140:143], v[18:21]
    v_add_f32 v32, v32, v190
    v_add_f32 v33, v33, v191
    v_mfma_f32_16x16x32_bf16 v[22:25], a[156:159], v[128:131], v[22:25]
    s_waitcnt lgkmcnt(0)
    s_barrier
    ds_read_b128 v[204:207], v5 offset:16384
    v_add_f32 v30, v30, v192
    v_add_f32 v31, v31, v193
    v_mfma_f32_16x16x32_bf16 v[22:25], a[176:179], v[96:99], v[22:25]
    ds_read_b128 v[208:211], v5 offset:17408
    v_add_f32 v32, v32, v194
    v_add_f32 v33, v33, v195
    v_mfma_f32_16x16x32_bf16 v[22:25], a[196:199], v[132:135], v[22:25]
    s_waitcnt lgkmcnt(5)
    ds_read_b128 v[212:215], v5 offset:18432
    v_add_f32 v34, v34, v196
    v_add_f32 v35, v35, v197
    v_mfma_f32_16x16x32_bf16 v[22:25], a[60:63], v[136:139], v[22:25]
    ds_read_b128 v[216:219], v5 offset:19456
    v_add_f32 v36, v36, v198
    v_add_f32 v37, v37, v199
    v_mfma_f32_16x16x32_bf16 v[22:25], v[160:163], v[140:143], v[22:25]
    ds_read_b128 v[220:223], v5 offset:20480
    v_add_f32 v34, v34, v200
    v_add_f32 v35, v35, v201
    v_mfma_f32_16x16x32_bf16 v[26:29], a[160:163], v[128:131], v[26:29]
    v_add_f32 v36, v36, v202
    v_add_f32 v37, v37, v203
    v_mfma_f32_16x16x32_bf16 v[26:29], a[180:183], v[96:99], v[26:29]
    s_waitcnt lgkmcnt(4)
    v_add_f32 v18, v18, v204
    v_add_f32 v19, v19, v205
    v_mfma_f32_16x16x32_bf16 v[26:29], a[0:3], v[132:135], v[26:29]
    v_add_f32 v20, v20, v206
    v_add_f32 v21, v21, v207
    v_mfma_f32_16x16x32_bf16 v[26:29], v[144:147], v[136:139], v[26:29]
    v_cvt_pk_bf16_f32 v8, v18, v19
    v_cvt_pk_bf16_f32 v9, v20, v21
    v_mfma_f32_16x16x32_bf16 v[26:29], a[100:103], v[140:143], v[26:29]
    ds_write_b64 v0, v[8:9] offset:0
    v_mfma_f32_16x16x32_bf16 v[30:33], a[164:167], v[128:131], v[30:33]
    s_waitcnt lgkmcnt(4)
    v_add_f32 v22, v22, v208
    v_add_f32 v23, v23, v209
    v_mfma_f32_16x16x32_bf16 v[30:33], a[184:187], v[96:99], v[30:33]
    v_add_f32 v24, v24, v210
    v_add_f32 v25, v25, v211
    v_mfma_f32_16x16x32_bf16 v[30:33], a[12:15], v[132:135], v[30:33]
    v_cvt_pk_bf16_f32 v10, v22, v23
    v_cvt_pk_bf16_f32 v11, v24, v25
    v_mfma_f32_16x16x32_bf16 v[30:33], v[148:151], v[136:139], v[30:33]
    ds_write_b64 v0, v[10:11] offset:32
    v_mfma_f32_16x16x32_bf16 v[30:33], a[16:19], v[140:143], v[30:33]
    s_waitcnt lgkmcnt(4)
    v_add_f32 v26, v26, v212
    v_add_f32 v27, v27, v213
    v_mfma_f32_16x16x32_bf16 v[34:37], a[168:171], v[128:131], v[34:37]
    v_add_f32 v28, v28, v214
    v_add_f32 v29, v29, v215
    v_mfma_f32_16x16x32_bf16 v[34:37], a[188:191], v[96:99], v[34:37]
    v_cvt_pk_bf16_f32 v12, v26, v27
    v_cvt_pk_bf16_f32 v13, v28, v29
    v_mfma_f32_16x16x32_bf16 v[34:37], a[28:31], v[132:135], v[34:37]
    ds_write_b64 v0, v[12:13] offset:64
    v_mfma_f32_16x16x32_bf16 v[34:37], v[152:155], v[136:139], v[34:37]
    s_waitcnt lgkmcnt(4)
    v_add_f32 v30, v30, v216
    v_add_f32 v31, v31, v217
    v_mfma_f32_16x16x32_bf16 v[34:37], a[20:23], v[140:143], v[34:37]
    v_add_f32 v32, v32, v218
    v_add_f32 v33, v33, v219
    v_cvt_pk_bf16_f32 v14, v30, v31
    v_cvt_pk_bf16_f32 v15, v32, v33
    ds_write_b64 v0, v[14:15] offset:96
    s_waitcnt lgkmcnt(4)
    s_nop 1
    v_add_f32 v34, v34, v220
    v_add_f32 v35, v35, v221
    v_add_f32 v36, v36, v222
    v_add_f32 v37, v37, v223
    v_cvt_pk_bf16_f32 v16, v34, v35
    v_cvt_pk_bf16_f32 v17, v36, v37
    ds_write_b64 v0, v[16:17] offset:128
    ds_read_b128 v[18:21], v2 offset:0
    ds_read_b128 v[22:25], v2 offset:1024
    ds_read_b128 v[26:29], v2 offset:2048
    s_waitcnt lgkmcnt(2)
    buffer_store_dwordx4 v[18:21], v41, s[28:31], s79 offen nt
    s_waitcnt lgkmcnt(1)
    buffer_store_dwordx4 v[22:25], v42, s[28:31], s79 offen nt
    s_waitcnt lgkmcnt(0)
    buffer_store_dwordx4 v[26:29], v43, s[28:31], s79 offen nt
L_end:
    s_endpgm
L_fallback:
    s_mov_b32 s43, 1
    s_waitcnt vmcnt(0) lgkmcnt(0)
    s_barrier
    s_add_u32 s70, s24, s46
    s_addc_u32 s71, s25, 0
    global_load_dwordx4 a[64:67], v59, s[68:69] offset:0 sc1
    global_load_dwordx2 a[68:69], v51, s[68:69] offset:0 sc1
    global_load_dwordx4 a[70:73], v59, s[68:69] offset:512 sc1
    global_load_dwordx2 a[74:75], v51, s[68:69] offset:512 sc1
    global_load_dwordx4 a[76:79], v59, s[70:71] offset:0 sc1
    global_load_dwordx2 a[80:81], v51, s[70:71] offset:0 sc1
    global_load_dwordx4 a[82:85], v59, s[70:71] offset:512 sc1
    global_load_dwordx2 a[86:87], v51, s[70:71] offset:512 sc1
    v_mov_b32 v32, 0xff800000
    v_mov_b32 v33, 0xff800000
    v_mov_b32 v34, 0xff800000
    v_mov_b32 v35, 0xff800000
    s_sub_u32 s64, s64, 8192
    s_subb_u32 s65, s65, 0
    s_sub_u32 s72, s64, 4096
    s_subb_u32 s73, s65, 0
    s_mov_b32 s86, 32
L_fbloop:
    global_load_dwordx4 a[200:203], v48, s[72:73] sc1
    global_load_dwordx2 a[204:205], v50, s[72:73] sc1
    s_waitcnt vmcnt(0)
    v_mfma_f32_32x32x16_bf16 v[0:15], a[200:203], a[64:67], 0
    v_mfma_f32_32x32x8_bf16 v[0:15], a[204:205], a[68:69], v[0:15]
    s_nop 11
    v_max3_f32 v32, v0, v1, v32
    v_max3_f32 v32, v2, v3, v32
    v_max3_f32 v32, v4, v5, v32
    v_max3_f32 v32, v6, v7, v32
    v_max3_f32 v32, v8, v9, v32
    v_max3_f32 v32, v10, v11, v32
    v_max3_f32 v32, v12, v13, v32
    v_max3_f32 v32, v14, v15, v32
    v_mfma_f32_32x32x16_bf16 v[0:15], a[200:203], a[70:73], 0
    v_mfma_f32_32x32x8_bf16 v[0:15], a[204:205], a[74:75], v[0:15]
    s_nop 11
    v_max3_f32 v33, v0, v1, v33
    v_max3_f32 v33, v2, v3, v33
    v_max3_f32 v33, v4, v5, v33
    v_max3_f32 v33, v6, v7, v33
    v_max3_f32 v33, v8, v9, v33
    v_max3_f32 v33, v10, v11, v33
    v_max3_f32 v33, v12, v13, v33
    v_max3_f32 v33, v14, v15, v33
    v_mfma_f32_32x32x16_bf16 v[0:15], a[200:203], a[76:79], 0
    v_mfma_f32_32x32x8_bf16 v[0:15], a[204:205], a[80:81], v[0:15]
    s_nop 11
    v_max3_f32 v34, v0, v1, v34
    v_max3_f32 v34, v2, v3, v34
    v_max3_f32 v34, v4, v5, v34
    v_max3_f32 v34, v6, v7, v34
    v_max3_f32 v34, v8, v9, v34
    v_max3_f32 v34, v10, v11, v34
    v_max3_f32 v34, v12, v13, v34
    v_max3_f32 v34, v14, v15, v34
    v_mfma_f32_32x32x16_bf16 v[0:15], a[200:203], a[82:85], 0
    v_mfma_f32_32x32x8_bf16 v[0:15], a[204:205], a[86:87], v[0:15]
    s_nop 11
    v_max3_f32 v35, v0, v1, v35
    v_max3_f32 v35, v2, v3, v35
    v_max3_f32 v35, v4, v5, v35
    v_max3_f32 v35, v6, v7, v35
    v_max3_f32 v35, v8, v9, v35
    v_max3_f32 v35, v10, v11, v35
    v_max3_f32 v35, v12, v13, v35
    v_max3_f32 v35, v14, v15, v35
    s_add_u32 s72, s72, 512
    s_addc_u32 s73, s73, 0
    s_sub_u32 s86, s86, 1
    s_cmp_lg_u32 s86, 0
    s_cbranch_scc1 L_fbloop
    v_mov_b32 v36, v32
    v_mov_b32 v37, v33
    v_mov_b32 v38, v34
    v_mov_b32 v39, v35
    v_permlane32_swap_b32 v32, v36
    v_permlane32_swap_b32 v33, v37
    v_permlane32_swap_b32 v34, v38
    v_permlane32_swap_b32 v35, v39
    v_max_f32 v32, v32, v36
    v_max_f32 v33, v33, v37
    v_max_f32 v34, v34, v38
    v_max_f32 v35, v35, v39
    ds_write_b128 v60, v[32:35]
    s_waitcnt lgkmcnt(0)
    s_barrier
    ds_read_b128 v[36:39], v61
    s_waitcnt lgkmcnt(0)
    v_cmp_lt_u32 vcc, 511, v53
    v_max_f32 v32, v32, v38
    v_sub_f32 v32, 0, v32
    v_cvt_pk_bf16_f32 v0, v32, v32
    v_lshlrev_b32 v1, 16, v0
    v_sub_f32 v32, v32, v1
    v_cvt_pk_bf16_f32 v2, v32, v32
    v_lshlrev_b32 v3, 16, v2
    v_sub_f32 v32, v32, v3
    v_cvt_pk_bf16_f32 v4, v1, v3
    v_mov_b32 v6, 0
    v_cvt_pk_bf16_f32 v5, v32, v6
    v_accvgpr_read_b32 v6, a68
    v_accvgpr_read_b32 v7, a69
    v_cndmask_b32 v6, v6, v4, vcc
    v_cndmask_b32 v7, v7, v5, vcc
    v_accvgpr_write_b32 a68, v6
    v_accvgpr_write_b32 a69, v7
    v_max_f32 v33, v33, v39
    v_sub_f32 v33, 0, v33
    v_cvt_pk_bf16_f32 v0, v33, v33
    v_lshlrev_b32 v1, 16, v0
    v_sub_f32 v33, v33, v1
    v_cvt_pk_bf16_f32 v2, v33, v33
    v_lshlrev_b32 v3, 16, v2
    v_sub_f32 v33, v33, v3
    v_cvt_pk_bf16_f32 v4, v1, v3
    v_mov_b32 v6, 0
    v_cvt_pk_bf16_f32 v5, v33, v6
    v_accvgpr_read_b32 v6, a74
    v_accvgpr_read_b32 v7, a75
    v_cndmask_b32 v6, v6, v4, vcc
    v_cndmask_b32 v7, v7, v5, vcc
    v_accvgpr_write_b32 a74, v6
    v_accvgpr_write_b32 a75, v7
    v_max_f32 v34, v34, v36
    v_sub_f32 v34, 0, v34
    v_cvt_pk_bf16_f32 v0, v34, v34
    v_lshlrev_b32 v1, 16, v0
    v_sub_f32 v34, v34, v1
    v_cvt_pk_bf16_f32 v2, v34, v34
    v_lshlrev_b32 v3, 16, v2
    v_sub_f32 v34, v34, v3
    v_cvt_pk_bf16_f32 v4, v1, v3
    v_mov_b32 v6, 0
    v_cvt_pk_bf16_f32 v5, v34, v6
    v_accvgpr_read_b32 v6, a80
    v_accvgpr_read_b32 v7, a81
    v_cndmask_b32 v6, v6, v4, vcc
    v_cndmask_b32 v7, v7, v5, vcc
    v_accvgpr_write_b32 a80, v6
    v_accvgpr_write_b32 a81, v7
    v_max_f32 v35, v35, v37
    v_sub_f32 v35, 0, v35
    v_cvt_pk_bf16_f32 v0, v35, v35
    v_lshlrev_b32 v1, 16, v0
    v_sub_f32 v35, v35, v1
    v_cvt_pk_bf16_f32 v2, v35, v35
    v_lshlrev_b32 v3, 16, v2
    v_sub_f32 v35, v35, v3
    v_cvt_pk_bf16_f32 v4, v1, v3
    v_mov_b32 v6, 0
    v_cvt_pk_bf16_f32 v5, v35, v6
    v_accvgpr_read_b32 v6, a86
    v_accvgpr_read_b32 v7, a87
    v_cndmask_b32 v6, v6, v4, vcc
    v_cndmask_b32 v7, v7, v5, vcc
    v_accvgpr_write_b32 a86, v6
    v_accvgpr_write_b32 a87, v7
    global_load_dwordx4 a[200:203], v48, s[64:65] offset:-4096 sc1
    global_load_dwordx2 a[204:205], v50, s[64:65] offset:-4096 sc1
    global_load_dwordx4 a[206:209], v52, s[66:67] offset:-4096 sc1
    global_load_dwordx4 a[210:213], v52, s[66:67] offset:-3968 sc1
    global_load_dwordx4 a[214:217], v48, s[64:65] offset:-3584 sc1
    global_load_dwordx2 a[218:219], v50, s[64:65] offset:-3584 sc1
    global_load_dwordx4 a[220:223], v52, s[66:67] offset:-3840 sc1
    global_load_dwordx4 a[224:227], v52, s[66:67] offset:-3712 sc1
    global_load_dwordx4 a[228:231], v48, s[64:65] offset:-3072 sc1
    global_load_dwordx2 a[232:233], v50, s[64:65] offset:-3072 sc1
    global_load_dwordx4 a[234:237], v52, s[66:67] offset:-3584 sc1
    global_load_dwordx4 a[238:241], v52, s[66:67] offset:-3456 sc1
    v_mov_b32 v156, 1073741824
    v_mov_b32 v157, 0
    v_mov_b32 v158, 1073741824
    s_mov_b32 s72, 0
    s_mov_b32 s73, 0
    s_mov_b32 s79, 0
    s_mov_b32 s55, 0
    v_mov_b32 v46, 0
    v_mov_b32 v47, 0
    s_nop 1
    v_mfma_f32_32x32x8_bf16 a[0:15], v[46:47], v[46:47], 0
    v_mfma_f32_32x32x8_bf16 a[16:31], v[46:47], v[46:47], 0
    v_mfma_f32_32x32x8_bf16 a[32:47], v[46:47], v[46:47], 0
    v_mfma_f32_32x32x8_bf16 a[48:63], v[46:47], v[46:47], 0
    s_waitcnt vmcnt(0)
    s_barrier
    s_branch L_att1
L_oretry0:
    s_mov_b32 s44, 0x400000
L_osp0:
    s_add_u32 s98, s12, 0
    s_add_u32 s98, s24, s98
    s_addc_u32 s99, s25, 0
    global_load_dwordx4 v[64:67], v49, s[98:99] sc1
    s_add_u32 s98, s12, 131072
    s_add_u32 s98, s24, s98
    s_addc_u32 s99, s25, 0
    global_load_dwordx4 v[68:71], v49, s[98:99] sc1
    s_add_u32 s98, s12, 262144
    s_add_u32 s98, s24, s98
    s_addc_u32 s99, s25, 0
    global_load_dwordx4 v[72:75], v49, s[98:99] sc1
    s_add_u32 s98, s12, 393216
    s_add_u32 s98, s24, s98
    s_addc_u32 s99, s25, 0
    global_load_dwordx4 v[76:79], v49, s[98:99] sc1
    s_add_u32 s98, s12, 524288
    s_add_u32 s98, s24, s98
    s_addc_u32 s99, s25, 0
    global_load_dwordx4 v[80:83], v49, s[98:99] sc1
    s_waitcnt vmcnt(0)
    v_max3_u32 v6, v64, v66, v68
    v_max3_u32 v7, v70, v72, v76
    v_max3_u32 v6, v6, v78, v80
    v_max3_u32 v6, v6, v7, v82
    v_cmp_eq_u32 vcc, -1, v6
    s_nop 0
    s_cbranch_vccz L_ook0
    s_sub_u32 s44, s44, 1
    s_cbranch_scc0 L_osp0
L_ook0:
    s_add_u32 s98, s13, 0
    s_add_u32 s98, s24, s98
    s_addc_u32 s99, s25, 0
    global_load_dwordx4 v[84:87], v49, s[98:99] sc1
    s_add_u32 s98, s13, 131072
    s_add_u32 s98, s24, s98
    s_addc_u32 s99, s25, 0
    global_load_dwordx4 v[88:91], v49, s[98:99] sc1
    s_add_u32 s98, s13, 262144
    s_add_u32 s98, s24, s98
    s_addc_u32 s99, s25, 0
    global_load_dwordx4 v[92:95], v49, s[98:99] sc1
    s_add_u32 s98, s13, 393216
    s_add_u32 s98, s24, s98
    s_addc_u32 s99, s25, 0
    global_load_dwordx4 v[100:103], v49, s[98:99] sc1
    s_add_u32 s98, s13, 524288
    s_add_u32 s98, s24, s98
    s_addc_u32 s99, s25, 0
    global_load_dwordx4 v[104:107], v49, s[98:99] sc1
    s_branch L_oback0
L_oretry1:
    s_mov_b32 s44, 0x400000
L_osp1:
    s_add_u32 s98, s13, 0
    s_add_u32 s98, s24, s98
    s_addc_u32 s99, s25, 0
    global_load_dwordx4 v[84:87], v49, s[98:99] sc1
    s_add_u32 s98, s13, 131072
    s_add_u32 s98, s24, s98
    s_addc_u32 s99, s25, 0
    global_load_dwordx4 v[88:91], v49, s[98:99] sc1
    s_add_u32 s98, s13, 262144
    s_add_u32 s98, s24, s98
    s_addc_u32 s99, s25, 0
    global_load_dwordx4 v[92:95], v49, s[98:99] sc1
    s_add_u32 s98, s13, 393216
    s_add_u32 s98, s24, s98
    s_addc_u32 s99, s25, 0
    global_load_dwordx4 v[100:103], v49, s[98:99] sc1
    s_add_u32 s98, s13, 524288
    s_add_u32 s98, s24, s98
    s_addc_u32 s99, s25, 0
    global_load_dwordx4 v[104:107], v49, s[98:99] sc1
    s_waitcnt vmcnt(0)
    v_max3_u32 v6, v84, v86, v88
    v_max3_u32 v7, v90, v92, v100
    v_max3_u32 v6, v6, v102, v104
    v_max3_u32 v6, v6, v7, v106
    v_cmp_eq_u32 vcc, -1, v6
    s_nop 0
    s_cbranch_vccz L_ook1
    s_sub_u32 s44, s44, 1
    s_cbranch_scc0 L_osp1
L_ook1:
    s_branch L_oback1
L_oretry2:
    s_mov_b32 s44, 0x400000
L_osp2:
    s_add_u32 s98, s14, 0
    s_add_u32 s98, s24, s98
    s_addc_u32 s99, s25, 0
    global_load_dwordx4 v[108:111], v49, s[98:99] sc1
    s_add_u32 s98, s14, 131072
    s_add_u32 s98, s24, s98
    s_addc_u32 s99, s25, 0
    global_load_dwordx4 v[112:115], v49, s[98:99] sc1
    s_add_u32 s98, s14, 262144
    s_add_u32 s98, s24, s98
    s_addc_u32 s99, s25, 0
    global_load_dwordx4 v[116:119], v49, s[98:99] sc1
    s_add_u32 s98, s14, 393216
    s_add_u32 s98, s24, s98
    s_addc_u32 s99, s25, 0
    global_load_dwordx4 v[120:123], v49, s[98:99] sc1
    s_add_u32 s98, s14, 524288
    s_add_u32 s98, s24, s98
    s_addc_u32 s99, s25, 0
    global_load_dwordx4 v[124:127], v49, s[98:99] sc1
    s_waitcnt vmcnt(0)
    v_max3_u32 v6, v108, v110, v112
    v_max3_u32 v7, v114, v116, v120
    v_max3_u32 v6, v6, v122, v124
    v_max3_u32 v6, v6, v7, v126
    v_cmp_eq_u32 vcc, -1, v6
    s_nop 0
    s_cbranch_vccz L_ook2
    s_sub_u32 s44, s44, 1
    s_cbranch_scc0 L_osp2
L_ook2:
    s_branch L_oback2
L_oretry3:
    s_mov_b32 s44, 0x400000
L_osp3:
    s_add_u32 s98, s15, 0
    s_add_u32 s98, s24, s98
    s_addc_u32 s99, s25, 0
    global_load_dwordx4 v[128:131], v49, s[98:99] sc1
    s_add_u32 s98, s15, 131072
    s_add_u32 s98, s24, s98
    s_addc_u32 s99, s25, 0
    global_load_dwordx4 v[96:99], v49, s[98:99] sc1
    s_add_u32 s98, s15, 262144
    s_add_u32 s98, s24, s98
    s_addc_u32 s99, s25, 0
    global_load_dwordx4 v[132:135], v49, s[98:99] sc1
    s_add_u32 s98, s15, 393216
    s_add_u32 s98, s24, s98
    s_addc_u32 s99, s25, 0
    global_load_dwordx4 v[136:139], v49, s[98:99] sc1
    s_add_u32 s98, s15, 524288
    s_add_u32 s98, s24, s98
    s_addc_u32 s99, s25, 0
    global_load_dwordx4 v[140:143], v49, s[98:99] sc1
    s_waitcnt vmcnt(0)
    v_max3_u32 v6, v128, v130, v96
    v_max3_u32 v7, v98, v132, v136
    v_max3_u32 v6, v6, v138, v140
    v_max3_u32 v6, v6, v7, v142
    v_cmp_eq_u32 vcc, -1, v6
    s_nop 0
    s_cbranch_vccz L_ook3
    s_sub_u32 s44, s44, 1
    s_cbranch_scc0 L_osp3
L_ook3:
    s_branch L_oback3
L_codeend:
.section .rodata,"a"
.p2align 6
.amdhsa_kernel parallel_sum__mha_block__glu_gated_glu__prompt_kernel
  .amdhsa_next_free_vgpr 512
  .amdhsa_next_free_sgpr 102
  .amdhsa_accum_offset 256
  .amdhsa_group_segment_fixed_size 0
  .amdhsa_kernarg_size 80
  .amdhsa_user_sgpr_count 2
  .amdhsa_user_sgpr_kernarg_segment_ptr 1
  .amdhsa_system_sgpr_workgroup_id_x 1
.end_amdhsa_kernel
```
